```python
import torch

def _softmax(x, axis=-1):
    return torch.softmax(x, dim=axis)

def _gelu(x):
    return torch.nn.functional.gelu(x, approximate='tanh')

def _silu(x):
    return torch.nn.functional.silu(x)

def _sigmoid(x):
    return torch.sigmoid(x)

def _layernorm(x, axis=-1, eps=1e-05):
    m = x.mean(dim=axis, keepdim=True)
    v = x.var(dim=axis, keepdim=True, unbiased=False)
    return (x - m) / torch.sqrt(v + eps)

def _scatter_add(tgt, idx, src, axis=0):
    return tgt.clone().index_add_(axis, idx, src)

def _segment_sum(src, seg, n):
    out = torch.zeros((n,) + src.shape[1:], dtype=src.dtype)
    return out.index_add_(0, seg, src)

def _pad(x, pw):
    flat = tuple((v for pair in reversed(pw) for v in pair))
    return torch.nn.functional.pad(x, flat)
kernel_name = 'adaLN_cond__gqa_block_cached__glu_gated_swiglu__decode'

def setup_inputs():

    _w = lambda a: (lambda t: t.to(torch.bfloat16) if t.is_floating_point() else t)(torch.as_tensor(a))

    def _A_setup():
        B, Sq, D = (4, 1, 1024)
        Hq, Hkv, Sk, Dh = (32, 4, 16384, 128)
        assert Hq % Hkv == 0, (Hq, Hkv)
        return {'x': _w((lambda *s: torch.randn(*s, dtype=torch.bfloat16) * 0.1)(B, Sq, D)), 'k_cache': _w((lambda *s: torch.randn(*s, dtype=torch.bfloat16) * 0.8)(B, Hkv, Sk, Dh)), 'v_cache': _w((lambda *s: torch.randn(*s, dtype=torch.bfloat16) * 3.2)(B, Hkv, Sk, Dh)), 'wq': _w((lambda *s: torch.randn(*s, dtype=torch.bfloat16) * 0.8)(D, Hq * Dh) * D ** (-0.5)), 'wo': _w((lambda *s: torch.randn(*s, dtype=torch.bfloat16) * 3.2)(Hq * Dh, D) * (Hq * Dh) ** (-0.5))}
    _A_in = _A_setup()

    def _B_setup():
        B, S, D, F = (4, 1, 1024, 3584)
        return {'x': _w((lambda *s: torch.randn(*s, dtype=torch.bfloat16) * 0.1)(B, S, D)), 'w1': _w((lambda *s: torch.randn(*s, dtype=torch.bfloat16) * 3.2)(D, F) * (2.0 / D) ** 0.5), 'w3': _w((lambda *s: torch.randn(*s, dtype=torch.bfloat16) * 3.2)(D, F) * (2.0 / D) ** 0.5), 'w2': _w((lambda *s: torch.randn(*s, dtype=torch.bfloat16) * 3.2)(F, D) * (2.0 / F) ** 0.5)}
    _B_in = _B_setup()
    return {'A_x': _A_in['x'], 'A_k_cache': _A_in['k_cache'], 'A_v_cache': _A_in['v_cache'], 'A_wq': _A_in['wq'], 'A_wo': _A_in['wo'], 'B_x': _B_in['x'], 'B_w1': _B_in['w1'], 'B_w3': _B_in['w3'], 'B_w2': _B_in['w2'], 'c': _w((lambda *s: torch.randn(*s, dtype=torch.bfloat16) * 0.2)(4, 1024) * 8.0), 'w_mod': _w((lambda *s: torch.randn(*s, dtype=torch.bfloat16) * 0.2)(1024, 6 * 1024) * 1024 ** (-0.5) * 8.0)}

def reference(A_x, A_k_cache, A_v_cache, A_wq, A_wo, B_x, B_w1, B_w3, B_w2, c, w_mod):

    def _A_ref(x, k_cache, v_cache, wq, wo):
        B, Sq, D = x.shape
        Hq, Dh = (32, 128)
        Hkv = k_cache.shape[1]
        rep = Hq // Hkv
        q = (lambda x, *d: x.permute(*d))((x @ wq).reshape(B, Sq, Hq, Dh), 0, 2, 1, 3)
        k = (lambda x, n, axis: torch.repeat_interleave(x, n, dim=axis))(k_cache, rep, axis=1)
        v = (lambda x, n, axis: torch.repeat_interleave(x, n, dim=axis))(v_cache, rep, axis=1)
        scores = torch.einsum('bhqd,bhkd->bhqk', q, k) * Dh ** (-0.5)
        p = _softmax(scores, axis=-1)
        o = torch.einsum('bhqk,bhkd->bhqd', p, v)
        return (lambda x, *d: x.permute(*d))(o, 0, 2, 1, 3).reshape(B, Sq, Hq * Dh) @ wo

    def _B_ref(x, w1, w3, w2):
        gate = torch.einsum('bsd,df->bsf', x, w1)
        up = torch.einsum('bsd,df->bsf', x, w3)
        h = _silu(gate) * up
        out = torch.einsum('bsf,fd->bsd', h, w2)
        return out
    x = A_x
    mod = (_silu(c) @ w_mod).reshape(c.shape[0], 6, 1, -1)
    sa, ca, ga, sb, cb, gb = (mod[:, 0].clone(), mod[:, 1].clone(), mod[:, 2].clone(), mod[:, 3].clone(), mod[:, 4].clone(), mod[:, 5].clone())
    h = _layernorm(x, axis=-1) * (1 + ca) + sa
    x = x + ga * _A_ref(h, A_k_cache, A_v_cache, A_wq, A_wo)
    h = _layernorm(x, axis=-1) * (1 + cb) + sb
    x = x + gb * _B_ref(h, B_w1, B_w3, B_w2)
    return x
```

```asm
; @launch grid=(256,1,1) block=(512,1,1) lds=149504
.amdgcn_target "amdgcn-amd-amdhsa--gfx950"
.text
.globl adaLN_cond__gqa_block_cached__glu_gated_swiglu__decode_kernel
.p2align 8
.type adaLN_cond__gqa_block_cached__glu_gated_swiglu__decode_kernel,@function
adaLN_cond__gqa_block_cached__glu_gated_swiglu__decode_kernel:
s_cmp_ge_u32 s2, 256
s_cbranch_scc1 L_end
s_load_dwordx16 s[32:47], s[0:1], 0
s_load_dwordx8 s[48:55], s[0:1], 64
s_load_dwordx4 s[56:59], s[0:1], 96
v_lshrrev_b32 v2, 6, v0
v_and_b32 v1, 63, v0
s_lshr_b32 s4, s2, 3
v_readfirstlane_b32 s3, v2
v_lshlrev_b32 v0, 4, v1
s_getpc_b64 s[60:61]
L_E_pc1:
s_lshl_b32 s62, s4, 3
s_add_u32 s62, s62, s3
s_lshl_b32 s62, s62, 10
s_min_u32 s62, s62, L_code_end-adaLN_cond__gqa_block_cached__glu_gated_swiglu__decode_kernel-1024
s_sub_u32 s60, s60, L_E_pc1-adaLN_cond__gqa_block_cached__glu_gated_swiglu__decode_kernel
s_subb_u32 s61, s61, 0
s_add_u32 s60, s60, s62
s_addc_u32 s61, s61, 0
global_load_dwordx4 v[252:255], v0, s[60:61]
s_add_u32 s6, s4, s3
s_and_b32 s6, s6, 7
s_lshl_b32 s6, s6, 12
s_cmp_ge_u32 s2, 120
s_cselect_b32 s5, 40, 0
s_cmp_ge_u32 s2, 216
s_cselect_b32 s5, 0xffffffa0, s5
s_add_u32 s5, s5, s2
s_lshl_b32 s7, s5, 18
s_add_u32 s7, s7, s6
s_mov_b32 s10, 0x4000000
s_mov_b32 s11, 0x20000
s_sub_u32 s62, s2, 120
s_cmp_lt_u32 s62, 64
s_cbranch_scc1 L_class_Q
s_cmp_lt_u32 s62, 80
s_cbranch_scc1 L_class_P
s_cmp_lt_u32 s62, 96
s_cbranch_scc1 L_class_PR
s_waitcnt lgkmcnt(0)
s_mov_b32 s8, s34
s_mov_b32 s9, s35
buffer_load_dwordx4 v[128:131], v0, s[8:11], s7 offen offset:0 nt
buffer_load_dwordx4 v[132:135], v0, s[8:11], s7 offen offset:1024 nt
buffer_load_dwordx4 v[136:139], v0, s[8:11], s7 offen offset:2048 nt
buffer_load_dwordx4 v[140:143], v0, s[8:11], s7 offen offset:3072 nt
s_cmp_lt_u32 s2, 64
s_cbranch_scc1 L_class_O
s_cmp_lt_u32 s2, 120
s_cbranch_scc1 L_class_M
s_branch L_class_R
.p2align 6
L_class_O:
s_mov_b32 s16, s58
s_mov_b32 s17, s59
s_mov_b32 s18, 0x10000000
s_mov_b32 s19, 0x20000
v_mov_b32 v4, -1
v_mov_b32 v5, -1
v_mov_b32 v6, -1
v_mov_b32 v7, -1
s_mov_b32 s20, s52
s_mov_b32 s21, s53
s_mov_b32 s22, 0xc00000
s_mov_b32 s23, 0x20000
s_lshl_b32 s60, s2, 3
s_add_u32 s60, s60, s3
s_lshr_b32 s61, s60, 7
s_lshl_b32 s61, s61, 10
s_and_b32 s60, s60, 127
s_mul_i32 s60, s60, 98304
s_add_u32 s60, s60, s61
v_lshrrev_b32 v10, 3, v1
v_mul_u32_u24 v10, 12288, v10
v_and_b32 v3, 7, v1
v_lshl_add_u32 v10, v3, 4, v10
buffer_load_dwordx4 v[252:255], v10, s[20:23], s60 offen offset:384
s_and_b32 s72, s2, 7
s_lshl_b32 s73, s72, 13
s_lshl_b32 s60, s4, 8
s_add_u32 s73, s73, s60
s_add_u32 s73, s73, 196608
s_cmp_lg_u32 s3, 0
s_cbranch_scc1 L_O_clr1
s_setprio 3
v_lshrrev_b32 v2, 4, v1
v_lshlrev_b32 v2, 11, v2
v_and_b32 v3, 15, v1
v_lshl_add_u32 v2, v3, 4, v2
buffer_store_dwordx4 v[4:7], v2, s[16:19], s73 offen sc1
s_mov_b64 exec, -1
s_lshl_b32 s60, s5, 11
s_add_u32 s60, s60, 262144
buffer_store_dwordx4 v[4:7], v0, s[16:19], s60 offen sc1
buffer_store_dwordx4 v[4:7], v0, s[16:19], s60 offen offset:1024 sc1
s_lshl_b32 s60, s5, 7
s_add_u32 s60, s60, 131072
s_mov_b32 exec_lo, 0xff
s_mov_b32 exec_hi, 0x0
buffer_store_dwordx4 v[4:7], v0, s[16:19], s60 offen sc1
s_mov_b64 exec, -1
v_mov_b32 v8, 0
v_mov_b32 v9, 0
v_lshlrev_b32 v2, 3, v1
ds_write_b64 v2, v[8:9] offset:49152
ds_write_b32 v8, v8 offset:50176
s_setprio 0
L_O_clr1:
s_mov_b32 s12, s36
s_mov_b32 s13, s37
s_mov_b32 s14, 0x4000000
s_mov_b32 s15, 0x20000
s_mov_b32 s28, s56
s_mov_b32 s29, s57
s_mov_b32 s30, 0x100
s_mov_b32 s31, 0x20000
s_mov_b32 s64, 0x05040100
s_mov_b32 s65, 0x07060302
s_lshl_b32 s60, s3, 12
v_lshrrev_b32 v6, 4, v1
v_lshlrev_b32 v7, 2, v6
v_xor_b32 v7, v7, v1
v_and_b32 v7, 15, v7
v_lshlrev_b32 v7, 4, v7
v_lshl_add_u32 v2, v6, 8, v7
v_add_u32 v2, s60, v2
v_xor_b32 v3, 16, v2
v_xor_b32 v4, 32, v2
v_xor_b32 v5, 48, v2
v_xor_b32 v7, v6, v1
v_and_b32 v7, 15, v7
v_lshlrev_b32 v7, 4, v7
v_and_b32 v8, 3, v1
v_lshl_add_u32 v7, v8, 10, v7
v_bfe_u32 v8, v1, 2, 2
v_lshl_add_u32 v7, v8, 8, v7
v_add_u32 v6, s60, v7
v_xor_b32 v7, 64, v6
v_xor_b32 v8, 128, v6
v_xor_b32 v9, 192, v6
s_cmp_lg_u32 s3, 0
s_cbranch_scc1 L_O_arr2
s_waitcnt vmcnt(0) lgkmcnt(0)
L_O_arr2:
s_barrier
s_waitcnt vmcnt(1)
s_mov_b32 s24, s38
s_mov_b32 s25, s39
s_mov_b32 s26, 0x800000
s_mov_b32 s27, 0x20000
s_sub_u32 s62, s2, 0
s_lshl_b32 s62, s62, 3
s_add_u32 s62, s62, s3
s_mul_i32 s62, s62, 8192
s_add_u32 s62, s62, 384
v_lshrrev_b32 v15, 3, v1
v_lshlrev_b32 v15, 10, v15
v_and_b32 v252, 7, v1
v_lshl_add_u32 v15, v252, 4, v15
s_min_u32 s62, s62, 8380800
buffer_load_dwordx4 v[252:255], v15, s[24:27], s62 offen
ds_write_b128 v2, v[128:131] offset:0
ds_write_b128 v3, v[132:135] offset:1024
ds_write_b128 v4, v[136:139] offset:2048
ds_write_b128 v5, v[140:143] offset:3072
ds_read_b128 v[128:131], v6
ds_read_b128 v[132:135], v7
ds_read_b128 v[136:139], v8
ds_read_b128 v[140:143], v9
s_waitcnt vmcnt(1)
s_mov_b32 s24, s52
s_mov_b32 s25, s53
s_mov_b32 s26, 0xc00000
s_mov_b32 s27, 0x20000
s_sub_u32 s62, s2, 0
s_lshl_b32 s62, s62, 3
s_add_u32 s62, s62, s3
s_lshr_b32 s63, s62, 7
s_lshl_b32 s63, s63, 10
s_and_b32 s62, s62, 127
s_mul_i32 s62, s62, 98304
s_add_u32 s62, s62, s63
s_add_u32 s62, s62, 4096
v_lshrrev_b32 v15, 3, v1
v_mul_u32_u24 v15, 12288, v15
v_and_b32 v252, 7, v1
v_lshl_add_u32 v15, v252, 4, v15
buffer_load_dwordx4 v[252:255], v15, s[24:27], s62 offen offset:384
s_cmp_ge_u32 s63, 2048
s_cbranch_scc1 L_O_c33
s_add_u32 s62, s62, 4096
buffer_load_dwordx4 v[252:255], v15, s[24:27], s62 offen offset:384
L_O_c33:
s_waitcnt vmcnt(1)
s_add_u32 s63, s7, 32768
buffer_load_dwordx4 v[144:147], v0, s[8:11], s63 offen offset:0 nt
s_waitcnt vmcnt(1)
s_add_u32 s63, s7, 32768
buffer_load_dwordx4 v[148:151], v0, s[8:11], s63 offen offset:1024 nt
s_waitcnt vmcnt(1)
s_add_u32 s63, s7, 32768
buffer_load_dwordx4 v[152:155], v0, s[8:11], s63 offen offset:2048 nt
s_waitcnt vmcnt(1)
s_add_u32 s63, s7, 32768
buffer_load_dwordx4 v[156:159], v0, s[8:11], s63 offen offset:3072 nt
s_waitcnt vmcnt(1)
s_add_u32 s63, s7, 65536
buffer_load_dwordx4 v[160:163], v0, s[8:11], s63 offen offset:0 nt
s_waitcnt vmcnt(1)
s_add_u32 s63, s7, 65536
buffer_load_dwordx4 v[164:167], v0, s[8:11], s63 offen offset:1024 nt
ds_write_b128 v2, v[144:147] offset:0
ds_write_b128 v3, v[148:151] offset:1024
ds_write_b128 v4, v[152:155] offset:2048
ds_write_b128 v5, v[156:159] offset:3072
ds_read_b128 v[144:147], v6
ds_read_b128 v[148:151], v7
ds_read_b128 v[152:155], v8
ds_read_b128 v[156:159], v9
s_cmp_lg_u32 s3, 0
s_cbranch_scc1 L_O_arr4
s_mov_b32 s60, 1
s_atomic_add s60, s[56:57], 0
L_O_arr4:
s_add_u32 s63, s7, 65536
buffer_load_dwordx4 v[168:171], v0, s[8:11], s63 offen offset:2048 nt
s_add_u32 s63, s7, 65536
buffer_load_dwordx4 v[172:175], v0, s[8:11], s63 offen offset:3072 nt
s_waitcnt vmcnt(3)
s_add_u32 s63, s7, 98304
buffer_load_dwordx4 v[176:179], v0, s[8:11], s63 offen offset:0 nt
s_waitcnt vmcnt(3)
s_add_u32 s63, s7, 98304
buffer_load_dwordx4 v[180:183], v0, s[8:11], s63 offen offset:1024 nt
s_waitcnt vmcnt(3)
s_add_u32 s63, s7, 98304
buffer_load_dwordx4 v[184:187], v0, s[8:11], s63 offen offset:2048 nt
s_waitcnt vmcnt(3)
s_add_u32 s63, s7, 98304
buffer_load_dwordx4 v[188:191], v0, s[8:11], s63 offen offset:3072 nt
ds_write_b128 v2, v[160:163] offset:0
ds_write_b128 v3, v[164:167] offset:1024
ds_write_b128 v4, v[168:171] offset:2048
ds_write_b128 v5, v[172:175] offset:3072
ds_read_b128 v[160:163], v6
ds_read_b128 v[164:167], v7
ds_read_b128 v[168:171], v8
ds_read_b128 v[172:175], v9
s_waitcnt vmcnt(3)
s_add_u32 s63, s7, 131072
buffer_load_dwordx4 v[192:195], v0, s[8:11], s63 offen offset:0 nt
s_waitcnt vmcnt(3)
s_add_u32 s63, s7, 131072
buffer_load_dwordx4 v[196:199], v0, s[8:11], s63 offen offset:1024 nt
s_waitcnt vmcnt(3)
s_add_u32 s63, s7, 131072
buffer_load_dwordx4 v[200:203], v0, s[8:11], s63 offen offset:2048 nt
s_waitcnt vmcnt(3)
s_add_u32 s63, s7, 131072
buffer_load_dwordx4 v[204:207], v0, s[8:11], s63 offen offset:3072 nt
ds_write_b128 v2, v[176:179] offset:0
ds_write_b128 v3, v[180:183] offset:1024
ds_write_b128 v4, v[184:187] offset:2048
ds_write_b128 v5, v[188:191] offset:3072
ds_read_b128 v[176:179], v6
ds_read_b128 v[180:183], v7
ds_read_b128 v[184:187], v8
ds_read_b128 v[188:191], v9
s_waitcnt vmcnt(3)
s_mov_b32 s24, s46
s_mov_b32 s25, s47
s_mov_b32 s26, 0x700000
s_mov_b32 s27, 0x20000
s_sub_u32 s62, s2, 0
s_lshl_b32 s62, s62, 3
s_add_u32 s62, s62, s3
s_mul_i32 s62, s62, 8192
s_add_u32 s62, s62, 384
v_lshrrev_b32 v15, 3, v1
v_lshlrev_b32 v15, 10, v15
v_and_b32 v252, 7, v1
v_lshl_add_u32 v15, v252, 4, v15
s_min_u32 s62, s62, 7332224
buffer_load_dwordx4 v[252:255], v15, s[24:27], s62 offen
s_waitcnt vmcnt(3)
s_add_u32 s63, s7, 163840
buffer_load_dwordx4 v[208:211], v0, s[8:11], s63 offen offset:0 nt
s_waitcnt vmcnt(3)
s_add_u32 s63, s7, 163840
buffer_load_dwordx4 v[212:215], v0, s[8:11], s63 offen offset:1024 nt
s_waitcnt vmcnt(3)
s_add_u32 s63, s7, 163840
buffer_load_dwordx4 v[216:219], v0, s[8:11], s63 offen offset:2048 nt
ds_write_b128 v2, v[192:195] offset:0
ds_write_b128 v3, v[196:199] offset:1024
ds_write_b128 v4, v[200:203] offset:2048
ds_write_b128 v5, v[204:207] offset:3072
ds_read_b128 v[192:195], v6
ds_read_b128 v[196:199], v7
ds_read_b128 v[200:203], v8
ds_read_b128 v[204:207], v9
s_waitcnt vmcnt(3)
s_add_u32 s63, s7, 163840
buffer_load_dwordx4 v[220:223], v0, s[8:11], s63 offen offset:3072 nt
s_waitcnt vmcnt(3)
s_add_u32 s63, s7, 196608
buffer_load_dwordx4 v[224:227], v0, s[8:11], s63 offen offset:0 nt
s_waitcnt vmcnt(3)
s_add_u32 s63, s7, 196608
buffer_load_dwordx4 v[228:231], v0, s[8:11], s63 offen offset:1024 nt
s_waitcnt vmcnt(3)
s_add_u32 s63, s7, 196608
buffer_load_dwordx4 v[232:235], v0, s[8:11], s63 offen offset:2048 nt
s_waitcnt vmcnt(3)
s_add_u32 s63, s7, 196608
buffer_load_dwordx4 v[236:239], v0, s[8:11], s63 offen offset:3072 nt
ds_write_b128 v2, v[208:211] offset:0
ds_write_b128 v3, v[212:215] offset:1024
ds_write_b128 v4, v[216:219] offset:2048
ds_write_b128 v5, v[220:223] offset:3072
ds_read_b128 v[208:211], v6
ds_read_b128 v[212:215], v7
ds_read_b128 v[216:219], v8
ds_read_b128 v[220:223], v9
s_waitcnt vmcnt(3)
s_add_u32 s63, s7, 229376
buffer_load_dwordx4 v[240:243], v0, s[8:11], s63 offen offset:0 nt
s_waitcnt vmcnt(3)
s_add_u32 s63, s7, 229376
buffer_load_dwordx4 v[244:247], v0, s[8:11], s63 offen offset:1024 nt
s_waitcnt vmcnt(3)
s_add_u32 s63, s7, 229376
buffer_load_dwordx4 v[248:251], v0, s[8:11], s63 offen offset:2048 nt
s_waitcnt vmcnt(3)
s_add_u32 s63, s7, 229376
buffer_load_dwordx4 v[252:255], v0, s[8:11], s63 offen offset:3072 nt
ds_write_b128 v2, v[224:227] offset:0
ds_write_b128 v3, v[228:231] offset:1024
ds_write_b128 v4, v[232:235] offset:2048
ds_write_b128 v5, v[236:239] offset:3072
ds_read_b128 v[224:227], v6
ds_read_b128 v[228:231], v7
ds_read_b128 v[232:235], v8
ds_read_b128 v[236:239], v9
s_waitcnt vmcnt(3)
s_add_u32 s63, s7, 0
buffer_load_dwordx4 v[64:67], v0, s[12:15], s63 offen offset:0 nt
s_waitcnt vmcnt(3)
s_add_u32 s63, s7, 0
buffer_load_dwordx4 v[68:71], v0, s[12:15], s63 offen offset:1024 nt
s_waitcnt vmcnt(3)
s_add_u32 s63, s7, 0
buffer_load_dwordx4 v[72:75], v0, s[12:15], s63 offen offset:2048 nt
s_waitcnt vmcnt(3)
s_add_u32 s63, s7, 0
buffer_load_dwordx4 v[76:79], v0, s[12:15], s63 offen offset:3072 nt
ds_write_b128 v2, v[240:243] offset:0
ds_write_b128 v3, v[244:247] offset:1024
ds_write_b128 v4, v[248:251] offset:2048
ds_write_b128 v5, v[252:255] offset:3072
ds_read_b128 v[240:243], v6
ds_read_b128 v[244:247], v7
ds_read_b128 v[248:251], v8
ds_read_b128 v[252:255], v9
s_mov_b32 s20, s40
s_mov_b32 s21, s41
s_mov_b32 s22, 0x800000
s_mov_b32 s23, 0x20000
v_lshrrev_b32 v12, 4, v1
v_lshlrev_b32 v12, 14, v12
v_and_b32 v13, 15, v1
v_lshl_add_u32 v12, v13, 4, v12
s_lshl_b32 s74, s72, 3
s_add_u32 s74, s74, s3
s_lshl_b32 s74, s74, 17
s_lshl_b32 s60, s4, 8
s_add_u32 s74, s74, s60
s_waitcnt vmcnt(3)
s_add_u32 s63, s7, 32768
buffer_load_dwordx4 v[80:83], v0, s[12:15], s63 offen offset:0 nt
s_waitcnt vmcnt(3)
s_add_u32 s63, s7, 32768
buffer_load_dwordx4 v[84:87], v0, s[12:15], s63 offen offset:1024 nt
s_waitcnt vmcnt(3)
s_add_u32 s63, s7, 32768
buffer_load_dwordx4 v[88:91], v0, s[12:15], s63 offen offset:2048 nt
s_waitcnt vmcnt(3)
s_add_u32 s63, s7, 32768
buffer_load_dwordx4 v[92:95], v0, s[12:15], s63 offen offset:3072 nt
s_waitcnt vmcnt(3)
s_add_u32 s63, s7, 65536
buffer_load_dwordx4 v[96:99], v0, s[12:15], s63 offen offset:0 nt
s_waitcnt vmcnt(3)
s_add_u32 s63, s7, 65536
buffer_load_dwordx4 v[100:103], v0, s[12:15], s63 offen offset:1024 nt
s_waitcnt vmcnt(3)
s_add_u32 s63, s7, 65536
buffer_load_dwordx4 v[104:107], v0, s[12:15], s63 offen offset:2048 nt
s_waitcnt vmcnt(3)
s_add_u32 s63, s7, 65536
buffer_load_dwordx4 v[108:111], v0, s[12:15], s63 offen offset:3072 nt
s_waitcnt vmcnt(3)
s_add_u32 s63, s7, 98304
buffer_load_dwordx4 v[112:115], v0, s[12:15], s63 offen offset:0 nt
s_waitcnt vmcnt(3)
buffer_load_dword v10, off, s[28:31], 0 offset:0 sc1
s_waitcnt vmcnt(3)
s_add_u32 s63, s7, 98304
buffer_load_dwordx4 v[116:119], v0, s[12:15], s63 offen offset:1024 nt
s_waitcnt vmcnt(3)
s_add_u32 s63, s7, 98304
buffer_load_dwordx4 v[120:123], v0, s[12:15], s63 offen offset:2048 nt
s_waitcnt vmcnt(3)
s_add_u32 s63, s7, 98304
buffer_load_dwordx4 v[124:127], v0, s[12:15], s63 offen offset:3072 nt
s_waitcnt vmcnt(3)
s_lshl_b32 s42, s3, 13
s_add_u32 s42, s42, 83968
s_add_u32 m0, s42, 0
s_add_u32 s63, s7, 131072
buffer_load_dwordx4 v0, s[12:15], s63 offen nt lds
v_readfirstlane_b32 s60, v10
s_mov_b32 s70, 0
s_cmp_ge_u32 s60, 256
s_cbranch_scc1 L_O_cok5
L_O_cretry6:
buffer_load_dword v10, off, s[28:31], 0 offset:0 sc1
s_waitcnt vmcnt(0)
v_readfirstlane_b32 s60, v10
s_add_u32 s70, s70, 1
s_cmp_ge_u32 s70, 262144
s_cbranch_scc1 L_O_cok5
s_cmp_lt_u32 s60, 256
s_cbranch_scc1 L_O_cretry6
L_O_cok5:
s_cmp_lt_u32 s3, 4
s_cbranch_scc1 L_O_pr7
s_setprio 1
L_O_pr7:
s_lshl_b32 s60, s3, 12
v_and_b32 v10, 3, v1
v_lshlrev_b32 v10, 2, v10
v_bfe_u32 v11, v1, 2, 1
v_or_b32 v10, v10, v11
v_lshrrev_b32 v11, 4, v1
v_xor_b32 v10, v10, v11
v_lshlrev_b32 v10, 4, v10
v_and_b32 v11, 7, v1
v_lshl_add_u32 v10, v11, 8, v10
v_add_u32 v6, s60, v10
v_xor_b32 v7, 64, v6
v_xor_b32 v8, 128, v6
v_xor_b32 v9, 192, v6
s_waitcnt vmcnt(3)
s_add_u32 m0, s42, 1024
s_add_u32 s63, s7, 132096
buffer_load_dwordx4 v0, s[12:15], s63 offen nt lds
s_waitcnt vmcnt(3)
s_add_u32 m0, s42, 2048
s_add_u32 s63, s7, 133120
buffer_load_dwordx4 v0, s[12:15], s63 offen nt lds
s_waitcnt vmcnt(3)
s_lshr_b32 s75, s5, 4
s_lshl_b32 s75, s75, 11
s_add_u32 s75, s75, 65536
buffer_load_dwordx4 v[16:19], v0, s[16:19], s75 offen offset:0 sc1
buffer_load_dwordx4 v[20:23], v0, s[16:19], s75 offen offset:1024 sc1
s_waitcnt vmcnt(3)
s_add_u32 m0, s42, 3072
s_add_u32 s63, s7, 134144
buffer_load_dwordx4 v0, s[12:15], s63 offen nt lds
s_waitcnt vmcnt(3)
s_add_u32 m0, s42, 4096
s_add_u32 s63, s7, 163840
buffer_load_dwordx4 v0, s[12:15], s63 offen nt lds
s_waitcnt vmcnt(3)
s_add_u32 m0, s42, 5120
s_add_u32 s63, s7, 164864
buffer_load_dwordx4 v0, s[12:15], s63 offen nt lds
s_waitcnt vmcnt(3)
s_add_u32 m0, s42, 6144
s_add_u32 s63, s7, 165888
buffer_load_dwordx4 v0, s[12:15], s63 offen nt lds
v_max_u32 v10, v16, v17
v_max3_u32 v10, v10, v18, v19
v_max3_u32 v10, v10, v20, v21
v_max3_u32 v10, v10, v22, v23
v_cmp_eq_u32 vcc, -1, v10
s_cbranch_vccz L_O_ok8
s_mov_b32 s70, 0
L_O_retry9:
buffer_load_dwordx4 v[16:19], v0, s[16:19], s75 offen offset:0 sc1
buffer_load_dwordx4 v[20:23], v0, s[16:19], s75 offen offset:1024 sc1
s_waitcnt vmcnt(0)
v_max_u32 v10, v16, v17
v_max3_u32 v10, v10, v18, v19
v_max3_u32 v10, v10, v20, v21
v_max3_u32 v10, v10, v22, v23
s_add_u32 s70, s70, 1
s_cmp_ge_u32 s70, 262144
s_cbranch_scc1 L_O_ok8
v_cmp_eq_u32 vcc, -1, v10
s_cbranch_vccnz L_O_retry9
L_O_ok8:
ds_write_b128 v2, v[16:19] offset:0
ds_write_b128 v3, v[20:23] offset:1024
ds_read_b128 v[16:19], v6
ds_read_b128 v[20:23], v7
ds_read_b128 v[24:27], v8
ds_read_b128 v[28:31], v9
s_waitcnt lgkmcnt(0)
v_mfma_f32_16x16x32_bf16 v[32:35], v[128:131], v[16:19], 0
v_mfma_f32_16x16x32_bf16 v[32:35], v[132:135], v[20:23], v[32:35]
v_mfma_f32_16x16x32_bf16 v[32:35], v[136:139], v[24:27], v[32:35]
v_mfma_f32_16x16x32_bf16 v[32:35], v[140:143], v[28:31], v[32:35]
v_mfma_f32_16x16x32_bf16 v[36:39], v[144:147], v[16:19], 0
v_mfma_f32_16x16x32_bf16 v[36:39], v[148:151], v[20:23], v[36:39]
v_mfma_f32_16x16x32_bf16 v[36:39], v[152:155], v[24:27], v[36:39]
v_mfma_f32_16x16x32_bf16 v[36:39], v[156:159], v[28:31], v[36:39]
s_add_u32 m0, s42, 7168
s_add_u32 s63, s7, 166912
buffer_load_dwordx4 v0, s[12:15], s63 offen nt lds
s_add_u32 s63, s7, 196608
buffer_load_dwordx4 v[128:131], v0, s[12:15], s63 offen offset:0 nt
v_mfma_f32_16x16x32_bf16 v[40:43], v[160:163], v[16:19], 0
v_mfma_f32_16x16x32_bf16 v[40:43], v[164:167], v[20:23], v[40:43]
v_mfma_f32_16x16x32_bf16 v[40:43], v[168:171], v[24:27], v[40:43]
v_mfma_f32_16x16x32_bf16 v[40:43], v[172:175], v[28:31], v[40:43]
v_mfma_f32_16x16x32_bf16 v[44:47], v[176:179], v[16:19], 0
v_mfma_f32_16x16x32_bf16 v[44:47], v[180:183], v[20:23], v[44:47]
v_mfma_f32_16x16x32_bf16 v[44:47], v[184:187], v[24:27], v[44:47]
v_mfma_f32_16x16x32_bf16 v[44:47], v[188:191], v[28:31], v[44:47]
v_mfma_f32_16x16x32_bf16 v[48:51], v[192:195], v[16:19], 0
v_mfma_f32_16x16x32_bf16 v[48:51], v[196:199], v[20:23], v[48:51]
v_mfma_f32_16x16x32_bf16 v[48:51], v[200:203], v[24:27], v[48:51]
v_mfma_f32_16x16x32_bf16 v[48:51], v[204:207], v[28:31], v[48:51]
v_mfma_f32_16x16x32_bf16 v[52:55], v[208:211], v[16:19], 0
v_mfma_f32_16x16x32_bf16 v[52:55], v[212:215], v[20:23], v[52:55]
v_mfma_f32_16x16x32_bf16 v[52:55], v[216:219], v[24:27], v[52:55]
v_mfma_f32_16x16x32_bf16 v[52:55], v[220:223], v[28:31], v[52:55]
v_mfma_f32_16x16x32_bf16 v[56:59], v[224:227], v[16:19], 0
v_mfma_f32_16x16x32_bf16 v[56:59], v[228:231], v[20:23], v[56:59]
v_mfma_f32_16x16x32_bf16 v[56:59], v[232:235], v[24:27], v[56:59]
v_mfma_f32_16x16x32_bf16 v[56:59], v[236:239], v[28:31], v[56:59]
v_mfma_f32_16x16x32_bf16 v[60:63], v[240:243], v[16:19], 0
v_mfma_f32_16x16x32_bf16 v[60:63], v[244:247], v[20:23], v[60:63]
v_mfma_f32_16x16x32_bf16 v[60:63], v[248:251], v[24:27], v[60:63]
v_mfma_f32_16x16x32_bf16 v[60:63], v[252:255], v[28:31], v[60:63]
s_add_u32 s63, s7, 196608
buffer_load_dwordx4 v[132:135], v0, s[12:15], s63 offen offset:1024 nt
v_cvt_pk_bf16_f32 v2, v32, v33
v_lshlrev_b32 v32, 16, v2
v_and_b32 v33, 0xffff0000, v2
v_cvt_pk_bf16_f32 v3, v34, v35
v_lshlrev_b32 v34, 16, v3
v_and_b32 v35, 0xffff0000, v3
v_mul_f32 v32, 0x3db504f3, v32
v_mul_f32 v33, 0x3db504f3, v33
v_mul_f32 v34, 0x3db504f3, v34
v_mul_f32 v35, 0x3db504f3, v35
v_cvt_pk_bf16_f32 v2, v32, v33
v_lshlrev_b32 v32, 16, v2
v_and_b32 v33, 0xffff0000, v2
v_cvt_pk_bf16_f32 v3, v34, v35
v_lshlrev_b32 v34, 16, v3
v_and_b32 v35, 0xffff0000, v3
v_max_f32 v4, v32, v33
v_max3_f32 v4, v4, v34, v35
v_cvt_pk_bf16_f32 v2, v36, v37
v_lshlrev_b32 v36, 16, v2
v_and_b32 v37, 0xffff0000, v2
v_cvt_pk_bf16_f32 v3, v38, v39
v_lshlrev_b32 v38, 16, v3
v_and_b32 v39, 0xffff0000, v3
v_mul_f32 v36, 0x3db504f3, v36
v_mul_f32 v37, 0x3db504f3, v37
v_mul_f32 v38, 0x3db504f3, v38
v_mul_f32 v39, 0x3db504f3, v39
v_cvt_pk_bf16_f32 v2, v36, v37
v_lshlrev_b32 v36, 16, v2
v_and_b32 v37, 0xffff0000, v2
v_cvt_pk_bf16_f32 v3, v38, v39
v_lshlrev_b32 v38, 16, v3
v_and_b32 v39, 0xffff0000, v3
v_max3_f32 v4, v4, v36, v37
v_max3_f32 v4, v4, v38, v39
v_cvt_pk_bf16_f32 v2, v40, v41
v_lshlrev_b32 v40, 16, v2
v_and_b32 v41, 0xffff0000, v2
v_cvt_pk_bf16_f32 v3, v42, v43
v_lshlrev_b32 v42, 16, v3
v_and_b32 v43, 0xffff0000, v3
v_mul_f32 v40, 0x3db504f3, v40
v_mul_f32 v41, 0x3db504f3, v41
v_mul_f32 v42, 0x3db504f3, v42
v_mul_f32 v43, 0x3db504f3, v43
v_cvt_pk_bf16_f32 v2, v40, v41
v_lshlrev_b32 v40, 16, v2
v_and_b32 v41, 0xffff0000, v2
v_cvt_pk_bf16_f32 v3, v42, v43
v_lshlrev_b32 v42, 16, v3
v_and_b32 v43, 0xffff0000, v3
v_max3_f32 v4, v4, v40, v41
v_max3_f32 v4, v4, v42, v43
v_cvt_pk_bf16_f32 v2, v44, v45
v_lshlrev_b32 v44, 16, v2
v_and_b32 v45, 0xffff0000, v2
v_cvt_pk_bf16_f32 v3, v46, v47
v_lshlrev_b32 v46, 16, v3
v_and_b32 v47, 0xffff0000, v3
v_mul_f32 v44, 0x3db504f3, v44
v_mul_f32 v45, 0x3db504f3, v45
v_mul_f32 v46, 0x3db504f3, v46
v_mul_f32 v47, 0x3db504f3, v47
v_cvt_pk_bf16_f32 v2, v44, v45
v_lshlrev_b32 v44, 16, v2
v_and_b32 v45, 0xffff0000, v2
v_cvt_pk_bf16_f32 v3, v46, v47
v_lshlrev_b32 v46, 16, v3
v_and_b32 v47, 0xffff0000, v3
v_max3_f32 v4, v4, v44, v45
v_max3_f32 v4, v4, v46, v47
v_cvt_pk_bf16_f32 v2, v48, v49
v_lshlrev_b32 v48, 16, v2
v_and_b32 v49, 0xffff0000, v2
v_cvt_pk_bf16_f32 v3, v50, v51
v_lshlrev_b32 v50, 16, v3
v_and_b32 v51, 0xffff0000, v3
v_mul_f32 v48, 0x3db504f3, v48
v_mul_f32 v49, 0x3db504f3, v49
v_mul_f32 v50, 0x3db504f3, v50
v_mul_f32 v51, 0x3db504f3, v51
v_cvt_pk_bf16_f32 v2, v48, v49
v_lshlrev_b32 v48, 16, v2
v_and_b32 v49, 0xffff0000, v2
v_cvt_pk_bf16_f32 v3, v50, v51
v_lshlrev_b32 v50, 16, v3
v_and_b32 v51, 0xffff0000, v3
v_max3_f32 v4, v4, v48, v49
v_max3_f32 v4, v4, v50, v51
v_cvt_pk_bf16_f32 v2, v52, v53
v_lshlrev_b32 v52, 16, v2
v_and_b32 v53, 0xffff0000, v2
v_cvt_pk_bf16_f32 v3, v54, v55
v_lshlrev_b32 v54, 16, v3
v_and_b32 v55, 0xffff0000, v3
v_mul_f32 v52, 0x3db504f3, v52
v_mul_f32 v53, 0x3db504f3, v53
v_mul_f32 v54, 0x3db504f3, v54
v_mul_f32 v55, 0x3db504f3, v55
v_cvt_pk_bf16_f32 v2, v52, v53
v_lshlrev_b32 v52, 16, v2
v_and_b32 v53, 0xffff0000, v2
v_cvt_pk_bf16_f32 v3, v54, v55
v_lshlrev_b32 v54, 16, v3
v_and_b32 v55, 0xffff0000, v3
v_max3_f32 v4, v4, v52, v53
v_max3_f32 v4, v4, v54, v55
v_cvt_pk_bf16_f32 v2, v56, v57
v_lshlrev_b32 v56, 16, v2
v_and_b32 v57, 0xffff0000, v2
v_cvt_pk_bf16_f32 v3, v58, v59
v_lshlrev_b32 v58, 16, v3
v_and_b32 v59, 0xffff0000, v3
v_mul_f32 v56, 0x3db504f3, v56
v_mul_f32 v57, 0x3db504f3, v57
v_mul_f32 v58, 0x3db504f3, v58
v_mul_f32 v59, 0x3db504f3, v59
v_cvt_pk_bf16_f32 v2, v56, v57
v_lshlrev_b32 v56, 16, v2
v_and_b32 v57, 0xffff0000, v2
v_cvt_pk_bf16_f32 v3, v58, v59
v_lshlrev_b32 v58, 16, v3
v_and_b32 v59, 0xffff0000, v3
v_max3_f32 v4, v4, v56, v57
v_max3_f32 v4, v4, v58, v59
v_cvt_pk_bf16_f32 v2, v60, v61
v_lshlrev_b32 v60, 16, v2
v_and_b32 v61, 0xffff0000, v2
v_cvt_pk_bf16_f32 v3, v62, v63
v_lshlrev_b32 v62, 16, v3
v_and_b32 v63, 0xffff0000, v3
v_mul_f32 v60, 0x3db504f3, v60
v_mul_f32 v61, 0x3db504f3, v61
v_mul_f32 v62, 0x3db504f3, v62
v_mul_f32 v63, 0x3db504f3, v63
v_cvt_pk_bf16_f32 v2, v60, v61
v_lshlrev_b32 v60, 16, v2
v_and_b32 v61, 0xffff0000, v2
v_cvt_pk_bf16_f32 v3, v62, v63
v_lshlrev_b32 v62, 16, v3
v_and_b32 v63, 0xffff0000, v3
v_max3_f32 v4, v4, v60, v61
v_max3_f32 v4, v4, v62, v63
s_waitcnt vmcnt(4)
s_add_u32 s63, s7, 196608
buffer_load_dwordx4 v[136:139], v0, s[12:15], s63 offen offset:2048 nt
s_waitcnt vmcnt(4)
s_add_u32 s63, s7, 196608
buffer_load_dwordx4 v[140:143], v0, s[12:15], s63 offen offset:3072 nt
v_mov_b32 v5, v4
s_nop 1
v_permlane16_swap_b32 v4, v5
v_max_f32 v4, v4, v5
v_mov_b32 v5, v4
s_nop 1
v_permlane32_swap_b32 v4, v5
v_max_f32 v4, v4, v5
v_mul_f32 v6, 0xbfb8aa3b, v4
s_mov_b32 s60, 0x3fb8aa3b
s_mov_b32 s66, 0x00ff00ff
s_mov_b32 s67, 0x00ff00ff
v_mov_b32 v5, 0
v_fma_f32 v32, v32, s60, v6
v_fma_f32 v33, v33, s60, v6
v_fma_f32 v34, v34, s60, v6
v_fma_f32 v35, v35, s60, v6
v_exp_f32 v32, v32
v_exp_f32 v33, v33
v_exp_f32 v34, v34
v_exp_f32 v35, v35
v_add_f32 v7, v32, v33
v_add_f32 v8, v34, v35
v_cvt_pk_bf16_f32 v2, v32, v33
v_cvt_pk_bf16_f32 v3, v34, v35
v_add_f32 v5, v5, v7
v_add_f32 v5, v5, v8
v_cndmask_b32 v16, 0, v2, s[66:67]
v_cndmask_b32 v32, v2, 0, s[66:67]
v_cndmask_b32 v17, 0, v3, s[66:67]
v_cndmask_b32 v33, v3, 0, s[66:67]
v_fma_f32 v36, v36, s60, v6
v_fma_f32 v37, v37, s60, v6
v_fma_f32 v38, v38, s60, v6
v_fma_f32 v39, v39, s60, v6
v_exp_f32 v36, v36
v_exp_f32 v37, v37
v_exp_f32 v38, v38
v_exp_f32 v39, v39
v_add_f32 v7, v36, v37
v_add_f32 v8, v38, v39
v_cvt_pk_bf16_f32 v2, v36, v37
v_cvt_pk_bf16_f32 v3, v38, v39
v_add_f32 v5, v5, v7
v_add_f32 v5, v5, v8
v_cndmask_b32 v18, 0, v2, s[66:67]
v_cndmask_b32 v34, v2, 0, s[66:67]
v_cndmask_b32 v19, 0, v3, s[66:67]
v_cndmask_b32 v35, v3, 0, s[66:67]
v_fma_f32 v40, v40, s60, v6
v_fma_f32 v41, v41, s60, v6
v_fma_f32 v42, v42, s60, v6
v_fma_f32 v43, v43, s60, v6
v_exp_f32 v40, v40
v_exp_f32 v41, v41
v_exp_f32 v42, v42
v_exp_f32 v43, v43
v_add_f32 v7, v40, v41
v_add_f32 v8, v42, v43
v_cvt_pk_bf16_f32 v2, v40, v41
v_cvt_pk_bf16_f32 v3, v42, v43
v_add_f32 v5, v5, v7
v_add_f32 v5, v5, v8
v_cndmask_b32 v20, 0, v2, s[66:67]
v_cndmask_b32 v36, v2, 0, s[66:67]
v_cndmask_b32 v21, 0, v3, s[66:67]
v_cndmask_b32 v37, v3, 0, s[66:67]
v_fma_f32 v44, v44, s60, v6
v_fma_f32 v45, v45, s60, v6
v_fma_f32 v46, v46, s60, v6
v_fma_f32 v47, v47, s60, v6
v_exp_f32 v44, v44
v_exp_f32 v45, v45
v_exp_f32 v46, v46
v_exp_f32 v47, v47
v_add_f32 v7, v44, v45
v_add_f32 v8, v46, v47
v_cvt_pk_bf16_f32 v2, v44, v45
v_cvt_pk_bf16_f32 v3, v46, v47
v_add_f32 v5, v5, v7
v_add_f32 v5, v5, v8
v_cndmask_b32 v22, 0, v2, s[66:67]
v_cndmask_b32 v38, v2, 0, s[66:67]
v_cndmask_b32 v23, 0, v3, s[66:67]
v_cndmask_b32 v39, v3, 0, s[66:67]
v_fma_f32 v48, v48, s60, v6
v_fma_f32 v49, v49, s60, v6
v_fma_f32 v50, v50, s60, v6
v_fma_f32 v51, v51, s60, v6
v_exp_f32 v48, v48
v_exp_f32 v49, v49
v_exp_f32 v50, v50
v_exp_f32 v51, v51
v_add_f32 v7, v48, v49
v_add_f32 v8, v50, v51
v_cvt_pk_bf16_f32 v2, v48, v49
v_cvt_pk_bf16_f32 v3, v50, v51
v_add_f32 v5, v5, v7
v_add_f32 v5, v5, v8
v_cndmask_b32 v24, 0, v2, s[66:67]
v_cndmask_b32 v40, v2, 0, s[66:67]
v_cndmask_b32 v25, 0, v3, s[66:67]
v_cndmask_b32 v41, v3, 0, s[66:67]
v_fma_f32 v52, v52, s60, v6
v_fma_f32 v53, v53, s60, v6
v_fma_f32 v54, v54, s60, v6
v_fma_f32 v55, v55, s60, v6
v_exp_f32 v52, v52
v_exp_f32 v53, v53
v_exp_f32 v54, v54
v_exp_f32 v55, v55
v_add_f32 v7, v52, v53
v_add_f32 v8, v54, v55
v_cvt_pk_bf16_f32 v2, v52, v53
v_cvt_pk_bf16_f32 v3, v54, v55
v_add_f32 v5, v5, v7
v_add_f32 v5, v5, v8
v_cndmask_b32 v26, 0, v2, s[66:67]
v_cndmask_b32 v42, v2, 0, s[66:67]
v_cndmask_b32 v27, 0, v3, s[66:67]
v_cndmask_b32 v43, v3, 0, s[66:67]
v_fma_f32 v56, v56, s60, v6
v_fma_f32 v57, v57, s60, v6
v_fma_f32 v58, v58, s60, v6
v_fma_f32 v59, v59, s60, v6
v_exp_f32 v56, v56
v_exp_f32 v57, v57
v_exp_f32 v58, v58
v_exp_f32 v59, v59
v_add_f32 v7, v56, v57
v_add_f32 v8, v58, v59
v_cvt_pk_bf16_f32 v2, v56, v57
v_cvt_pk_bf16_f32 v3, v58, v59
v_add_f32 v5, v5, v7
v_add_f32 v5, v5, v8
v_cndmask_b32 v28, 0, v2, s[66:67]
v_cndmask_b32 v44, v2, 0, s[66:67]
v_cndmask_b32 v29, 0, v3, s[66:67]
v_cndmask_b32 v45, v3, 0, s[66:67]
v_fma_f32 v60, v60, s60, v6
v_fma_f32 v61, v61, s60, v6
v_fma_f32 v62, v62, s60, v6
v_fma_f32 v63, v63, s60, v6
v_exp_f32 v60, v60
v_exp_f32 v61, v61
v_exp_f32 v62, v62
v_exp_f32 v63, v63
v_add_f32 v7, v60, v61
v_add_f32 v8, v62, v63
v_cvt_pk_bf16_f32 v2, v60, v61
v_cvt_pk_bf16_f32 v3, v62, v63
v_add_f32 v5, v5, v7
v_add_f32 v5, v5, v8
v_cndmask_b32 v30, 0, v2, s[66:67]
v_cndmask_b32 v46, v2, 0, s[66:67]
v_cndmask_b32 v31, 0, v3, s[66:67]
v_cndmask_b32 v47, v3, 0, s[66:67]
v_mov_b32 v6, v5
s_nop 1
v_permlane16_swap_b32 v5, v6
v_add_f32 v5, v5, v6
v_mov_b32 v6, v5
s_nop 1
v_permlane32_swap_b32 v5, v6
v_add_f32 v5, v5, v6
s_lshl_b32 s60, s3, 6
s_add_u32 s60, s60, 49664
v_lshlrev_b32 v6, 3, v1
v_add_u32 v7, s60, v6
v_mov_b32 v8, 1
v_mov_b32 v9, 50176
s_mov_b32 exec_lo, 0xff
s_mov_b32 exec_hi, 0x0
ds_write_b64 v7, v[4:5]
s_mov_b64 exec, 1
ds_add_rtn_u32 v8, v9, v8
s_mov_b64 exec, -1
s_waitcnt lgkmcnt(0)
v_readfirstlane_b32 s60, v8
s_cmp_lg_u32 s60, 7
s_cbranch_scc1 L_O_ml10
ds_read_b64 v[8:9], v6 offset:49664
s_waitcnt lgkmcnt(0)
v_max_f32_dpp v2, v8, v8 row_ror:8 row_mask:0xf bank_mask:0xf
v_mov_b32 v7, v2
s_nop 1
v_permlane16_swap_b32 v2, v7
v_max_f32 v2, v2, v7
v_mov_b32 v7, v2
s_nop 1
v_permlane32_swap_b32 v2, v7
v_max_f32 v2, v2, v7
v_sub_f32 v7, v8, v2
v_mul_f32 v7, 0x3fb8aa3b, v7
v_exp_f32 v7, v7
s_nop 0
v_mul_f32 v3, v9, v7
s_nop 1
v_add_f32_dpp v3, v3, v3 row_ror:8 row_mask:0xf bank_mask:0xf
v_mov_b32 v7, v3
s_nop 1
v_permlane16_swap_b32 v3, v7
v_add_f32 v3, v3, v7
v_mov_b32 v7, v3
s_nop 1
v_permlane32_swap_b32 v3, v7
v_add_f32 v3, v3, v7
s_lshl_b32 s60, s5, 7
s_add_u32 s60, s60, 131072
s_mov_b32 exec_lo, 0xff
s_mov_b32 exec_hi, 0x0
buffer_store_dwordx2 v[2:3], v6, s[16:19], s60 offen sc1
s_mov_b64 exec, -1
L_O_ml10:
s_setprio 0
v_perm_b32 v160, v68, v64, s64
v_perm_b32 v161, v76, v72, s64
v_perm_b32 v162, v84, v80, s64
v_perm_b32 v163, v92, v88, s64
v_perm_b32 v164, v68, v64, s65
v_perm_b32 v165, v76, v72, s65
v_perm_b32 v166, v84, v80, s65
v_perm_b32 v167, v92, v88, s65
v_mfma_f32_16x16x32_bf16 v[48:51], v[160:163], v[16:19], 0
s_nop 0
v_mfma_f32_16x16x32_bf16 v[52:55], v[164:167], v[16:19], 0
v_perm_b32 v168, v69, v65, s64
v_perm_b32 v169, v77, v73, s64
v_perm_b32 v170, v85, v81, s64
v_perm_b32 v171, v93, v89, s64
v_perm_b32 v172, v69, v65, s65
v_perm_b32 v173, v77, v73, s65
v_perm_b32 v174, v85, v81, s65
v_perm_b32 v175, v93, v89, s65
v_mfma_f32_16x16x32_bf16 v[56:59], v[168:171], v[16:19], 0
s_nop 0
v_mfma_f32_16x16x32_bf16 v[60:63], v[172:175], v[16:19], 0
v_perm_b32 v160, v70, v66, s64
v_perm_b32 v161, v78, v74, s64
v_perm_b32 v162, v86, v82, s64
v_perm_b32 v163, v94, v90, s64
v_perm_b32 v164, v70, v66, s65
v_perm_b32 v165, v78, v74, s65
v_perm_b32 v166, v86, v82, s65
v_perm_b32 v167, v94, v90, s65
v_mfma_f32_16x16x32_bf16 v[48:51], v[160:163], v[32:35], v[48:51]
s_nop 0
v_mfma_f32_16x16x32_bf16 v[52:55], v[164:167], v[32:35], v[52:55]
v_perm_b32 v168, v71, v67, s64
v_perm_b32 v169, v79, v75, s64
v_perm_b32 v170, v87, v83, s64
v_perm_b32 v171, v95, v91, s64
v_perm_b32 v172, v71, v67, s65
v_perm_b32 v173, v79, v75, s65
v_perm_b32 v174, v87, v83, s65
v_perm_b32 v175, v95, v91, s65
v_mfma_f32_16x16x32_bf16 v[56:59], v[168:171], v[32:35], v[56:59]
s_nop 0
v_mfma_f32_16x16x32_bf16 v[60:63], v[172:175], v[32:35], v[60:63]
s_waitcnt vmcnt(4)
v_add_u32 v10, s42, v0
ds_read_b128 v[160:163], v10 offset:0
ds_read_b128 v[164:167], v10 offset:1024
ds_read_b128 v[168:171], v10 offset:2048
ds_read_b128 v[172:175], v10 offset:3072
ds_read_b128 v[176:179], v10 offset:4096
ds_read_b128 v[180:183], v10 offset:5120
ds_read_b128 v[184:187], v10 offset:6144
ds_read_b128 v[188:191], v10 offset:7168
v_perm_b32 v64, v100, v96, s64
v_perm_b32 v65, v108, v104, s64
v_perm_b32 v66, v116, v112, s64
v_perm_b32 v67, v124, v120, s64
v_perm_b32 v68, v100, v96, s65
v_perm_b32 v69, v108, v104, s65
v_perm_b32 v70, v116, v112, s65
v_perm_b32 v71, v124, v120, s65
v_mfma_f32_16x16x32_bf16 v[48:51], v[64:67], v[20:23], v[48:51]
s_nop 0
v_mfma_f32_16x16x32_bf16 v[52:55], v[68:71], v[20:23], v[52:55]
v_perm_b32 v72, v101, v97, s64
v_perm_b32 v73, v109, v105, s64
v_perm_b32 v74, v117, v113, s64
v_perm_b32 v75, v125, v121, s64
v_perm_b32 v76, v101, v97, s65
v_perm_b32 v77, v109, v105, s65
v_perm_b32 v78, v117, v113, s65
v_perm_b32 v79, v125, v121, s65
v_mfma_f32_16x16x32_bf16 v[56:59], v[72:75], v[20:23], v[56:59]
s_nop 0
v_mfma_f32_16x16x32_bf16 v[60:63], v[76:79], v[20:23], v[60:63]
v_perm_b32 v64, v102, v98, s64
v_perm_b32 v65, v110, v106, s64
v_perm_b32 v66, v118, v114, s64
v_perm_b32 v67, v126, v122, s64
v_perm_b32 v68, v102, v98, s65
v_perm_b32 v69, v110, v106, s65
v_perm_b32 v70, v118, v114, s65
v_perm_b32 v71, v126, v122, s65
v_mfma_f32_16x16x32_bf16 v[48:51], v[64:67], v[36:39], v[48:51]
s_nop 0
v_mfma_f32_16x16x32_bf16 v[52:55], v[68:71], v[36:39], v[52:55]
v_perm_b32 v72, v103, v99, s64
v_perm_b32 v73, v111, v107, s64
v_perm_b32 v74, v119, v115, s64
v_perm_b32 v75, v127, v123, s64
v_perm_b32 v76, v103, v99, s65
v_perm_b32 v77, v111, v107, s65
v_perm_b32 v78, v119, v115, s65
v_perm_b32 v79, v127, v123, s65
v_mfma_f32_16x16x32_bf16 v[56:59], v[72:75], v[36:39], v[56:59]
s_nop 0
v_mfma_f32_16x16x32_bf16 v[60:63], v[76:79], v[36:39], v[60:63]
s_waitcnt lgkmcnt(0)
v_perm_b32 v64, v164, v160, s64
v_perm_b32 v65, v172, v168, s64
v_perm_b32 v66, v180, v176, s64
v_perm_b32 v67, v188, v184, s64
v_perm_b32 v68, v164, v160, s65
v_perm_b32 v69, v172, v168, s65
v_perm_b32 v70, v180, v176, s65
v_perm_b32 v71, v188, v184, s65
v_mfma_f32_16x16x32_bf16 v[48:51], v[64:67], v[24:27], v[48:51]
s_nop 0
v_mfma_f32_16x16x32_bf16 v[52:55], v[68:71], v[24:27], v[52:55]
v_perm_b32 v72, v165, v161, s64
v_perm_b32 v73, v173, v169, s64
v_perm_b32 v74, v181, v177, s64
v_perm_b32 v75, v189, v185, s64
v_perm_b32 v76, v165, v161, s65
v_perm_b32 v77, v173, v169, s65
v_perm_b32 v78, v181, v177, s65
v_perm_b32 v79, v189, v185, s65
v_mfma_f32_16x16x32_bf16 v[56:59], v[72:75], v[24:27], v[56:59]
s_nop 0
v_mfma_f32_16x16x32_bf16 v[60:63], v[76:79], v[24:27], v[60:63]
v_perm_b32 v64, v166, v162, s64
v_perm_b32 v65, v174, v170, s64
v_perm_b32 v66, v182, v178, s64
v_perm_b32 v67, v190, v186, s64
v_perm_b32 v68, v166, v162, s65
v_perm_b32 v69, v174, v170, s65
v_perm_b32 v70, v182, v178, s65
v_perm_b32 v71, v190, v186, s65
v_mfma_f32_16x16x32_bf16 v[48:51], v[64:67], v[40:43], v[48:51]
s_nop 0
v_mfma_f32_16x16x32_bf16 v[52:55], v[68:71], v[40:43], v[52:55]
v_perm_b32 v72, v167, v163, s64
v_perm_b32 v73, v175, v171, s64
v_perm_b32 v74, v183, v179, s64
v_perm_b32 v75, v191, v187, s64
v_perm_b32 v76, v167, v163, s65
v_perm_b32 v77, v175, v171, s65
v_perm_b32 v78, v183, v179, s65
v_perm_b32 v79, v191, v187, s65
v_mfma_f32_16x16x32_bf16 v[56:59], v[72:75], v[40:43], v[56:59]
s_nop 0
v_mfma_f32_16x16x32_bf16 v[60:63], v[76:79], v[40:43], v[60:63]
s_waitcnt vmcnt(3)
s_add_u32 s63, s7, 229376
buffer_load_dwordx4 v[144:147], v0, s[12:15], s63 offen offset:0 nt
s_waitcnt vmcnt(3)
s_add_u32 s63, s7, 229376
buffer_load_dwordx4 v[148:151], v0, s[12:15], s63 offen offset:1024 nt
s_waitcnt vmcnt(3)
s_add_u32 s63, s7, 229376
buffer_load_dwordx4 v[152:155], v0, s[12:15], s63 offen offset:2048 nt
s_waitcnt vmcnt(3)
s_add_u32 s63, s7, 229376
buffer_load_dwordx4 v[156:159], v0, s[12:15], s63 offen offset:3072 nt
s_waitcnt vmcnt(3)
s_add_u32 s63, s74, 0
buffer_load_dwordx4 v[192:195], v12, s[20:23], s63 offen offset:0 nt
s_waitcnt vmcnt(3)
s_add_u32 s63, s74, 0
buffer_load_dwordx4 v[196:199], v12, s[20:23], s63 offen offset:2048 nt
s_waitcnt vmcnt(3)
s_add_u32 s63, s74, 4096
buffer_load_dwordx4 v[200:203], v12, s[20:23], s63 offen offset:0 nt
s_waitcnt vmcnt(3)
s_add_u32 s63, s74, 4096
buffer_load_dwordx4 v[204:207], v12, s[20:23], s63 offen offset:2048 nt
v_perm_b32 v64, v132, v128, s64
v_perm_b32 v65, v140, v136, s64
v_perm_b32 v66, v148, v144, s64
v_perm_b32 v67, v156, v152, s64
v_perm_b32 v68, v132, v128, s65
v_perm_b32 v69, v140, v136, s65
v_perm_b32 v70, v148, v144, s65
v_perm_b32 v71, v156, v152, s65
v_mfma_f32_16x16x32_bf16 v[48:51], v[64:67], v[28:31], v[48:51]
s_nop 0
v_mfma_f32_16x16x32_bf16 v[52:55], v[68:71], v[28:31], v[52:55]
v_perm_b32 v72, v133, v129, s64
v_perm_b32 v73, v141, v137, s64
v_perm_b32 v74, v149, v145, s64
v_perm_b32 v75, v157, v153, s64
v_perm_b32 v76, v133, v129, s65
v_perm_b32 v77, v141, v137, s65
v_perm_b32 v78, v149, v145, s65
v_perm_b32 v79, v157, v153, s65
v_mfma_f32_16x16x32_bf16 v[56:59], v[72:75], v[28:31], v[56:59]
s_nop 0
v_mfma_f32_16x16x32_bf16 v[60:63], v[76:79], v[28:31], v[60:63]
v_perm_b32 v64, v134, v130, s64
v_perm_b32 v65, v142, v138, s64
v_perm_b32 v66, v150, v146, s64
v_perm_b32 v67, v158, v154, s64
v_perm_b32 v68, v134, v130, s65
v_perm_b32 v69, v142, v138, s65
v_perm_b32 v70, v150, v146, s65
v_perm_b32 v71, v158, v154, s65
v_mfma_f32_16x16x32_bf16 v[48:51], v[64:67], v[44:47], v[48:51]
s_nop 0
v_mfma_f32_16x16x32_bf16 v[52:55], v[68:71], v[44:47], v[52:55]
v_perm_b32 v72, v135, v131, s64
v_perm_b32 v73, v143, v139, s64
v_perm_b32 v74, v151, v147, s64
v_perm_b32 v75, v159, v155, s64
v_perm_b32 v76, v135, v131, s65
v_perm_b32 v77, v143, v139, s65
v_perm_b32 v78, v151, v147, s65
v_perm_b32 v79, v159, v155, s65
v_mfma_f32_16x16x32_bf16 v[56:59], v[72:75], v[44:47], v[56:59]
s_nop 0
v_mfma_f32_16x16x32_bf16 v[60:63], v[76:79], v[44:47], v[60:63]
s_waitcnt vmcnt(3)
s_lshr_b32 s75, s5, 4
s_lshl_b32 s75, s75, 11
s_add_u32 s75, s75, 131072
v_lshrrev_b32 v2, 3, v1
v_lshlrev_b32 v2, 7, v2
v_and_b32 v3, 7, v1
v_lshl_add_u32 v2, v3, 3, v2
buffer_load_dwordx2 v[6:7], v2, s[16:19], s75 offen offset:0 sc1
buffer_load_dwordx2 v[8:9], v2, s[16:19], s75 offen offset:1024 sc1
s_waitcnt vmcnt(3)
s_add_u32 s63, s74, 8192
buffer_load_dwordx4 v[208:211], v12, s[20:23], s63 offen offset:0 nt
s_waitcnt vmcnt(3)
s_add_u32 s63, s74, 8192
buffer_load_dwordx4 v[212:215], v12, s[20:23], s63 offen offset:2048 nt
s_waitcnt vmcnt(3)
s_add_u32 s63, s74, 12288
buffer_load_dwordx4 v[216:219], v12, s[20:23], s63 offen offset:0 nt
s_waitcnt vmcnt(3)
s_add_u32 s63, s74, 12288
buffer_load_dwordx4 v[220:223], v12, s[20:23], s63 offen offset:2048 nt
v_max_u32 v3, v6, v7
v_max3_u32 v3, v3, v8, v9
v_cmp_eq_u32 vcc, -1, v3
s_cbranch_vccz L_O_ok11
s_mov_b32 s70, 0
L_O_retry12:
buffer_load_dwordx2 v[6:7], v2, s[16:19], s75 offen offset:0 sc1
buffer_load_dwordx2 v[8:9], v2, s[16:19], s75 offen offset:1024 sc1
s_waitcnt vmcnt(0)
v_max_u32 v3, v6, v7
v_max3_u32 v3, v3, v8, v9
s_add_u32 s70, s70, 1
s_cmp_ge_u32 s70, 262144
s_cbranch_scc1 L_O_ok11
v_cmp_eq_u32 vcc, -1, v3
s_cbranch_vccnz L_O_retry12
L_O_ok11:
v_max_f32 v3, v6, v8
v_sub_f32 v6, v6, v3
v_sub_f32 v8, v8, v3
v_mul_f32 v6, 0x3fb8aa3b, v6
v_mul_f32 v8, 0x3fb8aa3b, v8
v_exp_f32 v6, v6
v_exp_f32 v8, v8
v_mul_f32 v7, v7, v6
v_fmac_f32 v7, v9, v8
v_max_f32_dpp v6, v3, v3 row_ror:8 row_mask:0xf bank_mask:0xf
v_mov_b32 v9, v6
s_nop 1
v_permlane16_swap_b32 v6, v9
v_max_f32 v6, v6, v9
v_mov_b32 v9, v6
s_nop 1
v_permlane32_swap_b32 v6, v9
v_max_f32 v6, v6, v9
v_sub_f32 v9, v3, v6
v_mul_f32 v9, 0x3fb8aa3b, v9
v_exp_f32 v9, v9
s_nop 0
v_mul_f32 v8, v7, v9
s_nop 1
v_add_f32_dpp v8, v8, v8 row_ror:8 row_mask:0xf bank_mask:0xf
v_mov_b32 v9, v8
s_nop 1
v_permlane16_swap_b32 v8, v9
v_add_f32 v8, v8, v9
v_mov_b32 v9, v8
s_nop 1
v_permlane32_swap_b32 v8, v9
v_add_f32 v8, v8, v9
v_sub_f32 v4, v4, v6
v_mul_f32 v4, 0x3fb8aa3b, v4
v_exp_f32 v4, v4
v_rcp_f32 v8, v8
s_nop 0
v_mul_f32 v5, v4, v8
s_mul_i32 s60, s3, 4864
s_add_u32 s60, s60, 0
v_and_b32 v6, 7, v1
v_mul_u32_u24 v6, 592, v6
v_lshrrev_b32 v3, 4, v1
v_mul_u32_u24 v3, 144, v3
v_add_u32 v6, v3, v6
v_bfe_u32 v3, v1, 3, 1
v_lshl_add_u32 v6, v3, 6, v6
v_add_u32 v6, s60, v6
s_mul_i32 s60, s3, 592
s_add_u32 s60, s60, 0
v_lshrrev_b32 v7, 4, v1
v_mul_u32_u24 v7, 144, v7
v_bfe_u32 v3, v1, 1, 1
v_lshl_add_u32 v7, v3, 6, v7
v_and_b32 v3, 1, v1
v_lshl_add_u32 v7, v3, 5, v7
v_bfe_u32 v3, v1, 2, 2
v_lshl_add_u32 v7, v3, 2, v7
v_add_u32 v7, s60, v7
v_add_u32 v8, 16, v7
v_lshlrev_b32 v9, 2, v1
s_lshl_b32 s75, s5, 11
s_lshl_b32 s61, s3, 8
s_add_u32 s75, s75, s61
s_add_u32 s75, s75, 262144
s_add_u32 s63, s74, 65536
buffer_load_dwordx4 v[224:227], v12, s[20:23], s63 offen offset:0 nt
s_add_u32 s63, s74, 65536
buffer_load_dwordx4 v[228:231], v12, s[20:23], s63 offen offset:2048 nt
s_add_u32 s63, s74, 69632
buffer_load_dwordx4 v[232:235], v12, s[20:23], s63 offen offset:0 nt
s_add_u32 s63, s74, 69632
buffer_load_dwordx4 v[236:239], v12, s[20:23], s63 offen offset:2048 nt
v_pk_mul_f32 v[48:49], v[48:49], v[4:5] op_sel:[0,1] op_sel_hi:[1,1]
v_pk_mul_f32 v[50:51], v[50:51], v[4:5] op_sel:[0,1] op_sel_hi:[1,1]
ds_write_b128 v6, v[48:51] offset:0
v_pk_mul_f32 v[52:53], v[52:53], v[4:5] op_sel:[0,1] op_sel_hi:[1,1]
v_pk_mul_f32 v[54:55], v[54:55], v[4:5] op_sel:[0,1] op_sel_hi:[1,1]
ds_write_b128 v6, v[52:55] offset:16
v_pk_mul_f32 v[56:57], v[56:57], v[4:5] op_sel:[0,1] op_sel_hi:[1,1]
v_pk_mul_f32 v[58:59], v[58:59], v[4:5] op_sel:[0,1] op_sel_hi:[1,1]
ds_write_b128 v6, v[56:59] offset:32
v_pk_mul_f32 v[60:61], v[60:61], v[4:5] op_sel:[0,1] op_sel_hi:[1,1]
v_pk_mul_f32 v[62:63], v[62:63], v[4:5] op_sel:[0,1] op_sel_hi:[1,1]
ds_write_b128 v6, v[60:63] offset:48
s_waitcnt lgkmcnt(0)
s_barrier
ds_read2st64_b32 v[16:17], v7 offset0:0 offset1:19
ds_read2st64_b32 v[24:25], v8 offset0:0 offset1:19
ds_read2st64_b32 v[18:19], v7 offset0:38 offset1:57
ds_read2st64_b32 v[26:27], v8 offset0:38 offset1:57
ds_read2st64_b32 v[20:21], v7 offset0:76 offset1:95
ds_read2st64_b32 v[28:29], v8 offset0:76 offset1:95
ds_read2st64_b32 v[22:23], v7 offset0:114 offset1:133
ds_read2st64_b32 v[30:31], v8 offset0:114 offset1:133
s_waitcnt lgkmcnt(0)
v_pk_add_f32 v[16:17], v[16:17], v[20:21]
v_pk_add_f32 v[18:19], v[18:19], v[22:23]
v_pk_add_f32 v[24:25], v[24:25], v[28:29]
v_pk_add_f32 v[26:27], v[26:27], v[30:31]
v_pk_add_f32 v[16:17], v[16:17], v[18:19]
v_pk_add_f32 v[24:25], v[24:25], v[26:27]
v_add_f32 v16, v16, v17
v_add_f32 v24, v24, v25
v_cvt_pk_bf16_f32 v20, v16, v24
s_nop 1
v_mov_b32_dpp v21, v20 quad_perm:[1,1,1,1] row_mask:0xf bank_mask:0xf
v_mov_b32_dpp v22, v20 quad_perm:[2,2,2,2] row_mask:0xf bank_mask:0xf
v_mov_b32_dpp v23, v20 quad_perm:[3,3,3,3] row_mask:0xf bank_mask:0xf
s_mov_b32 exec_lo, 0x11111111
s_mov_b32 exec_hi, 0x11111111
buffer_store_dwordx4 v[20:23], v9, s[16:19], s75 offen sc1
s_mov_b64 exec, -1
s_waitcnt vmcnt(5)
v_perm_b32 v96, v196, v192, s64
v_perm_b32 v97, v204, v200, s64
v_perm_b32 v98, v212, v208, s64
v_perm_b32 v99, v220, v216, s64
v_perm_b32 v104, v196, v192, s65
v_perm_b32 v105, v204, v200, s65
v_perm_b32 v106, v212, v208, s65
v_perm_b32 v107, v220, v216, s65
v_perm_b32 v112, v197, v193, s64
v_perm_b32 v113, v205, v201, s64
v_perm_b32 v114, v213, v209, s64
v_perm_b32 v115, v221, v217, s64
v_perm_b32 v120, v197, v193, s65
v_perm_b32 v121, v205, v201, s65
v_perm_b32 v122, v213, v209, s65
v_perm_b32 v123, v221, v217, s65
v_perm_b32 v128, v198, v194, s64
v_perm_b32 v129, v206, v202, s64
v_perm_b32 v130, v214, v210, s64
v_perm_b32 v131, v222, v218, s64
v_perm_b32 v136, v198, v194, s65
v_perm_b32 v137, v206, v202, s65
v_perm_b32 v138, v214, v210, s65
v_perm_b32 v139, v222, v218, s65
v_perm_b32 v144, v199, v195, s64
v_perm_b32 v145, v207, v203, s64
v_perm_b32 v146, v215, v211, s64
v_perm_b32 v147, v223, v219, s64
v_perm_b32 v152, v199, v195, s65
v_perm_b32 v153, v207, v203, s65
v_perm_b32 v154, v215, v211, s65
v_perm_b32 v155, v223, v219, s65
s_waitcnt vmcnt(3)
s_add_u32 s63, s74, 73728
buffer_load_dwordx4 v[240:243], v12, s[20:23], s63 offen offset:0 nt
s_waitcnt vmcnt(3)
s_add_u32 s63, s74, 73728
buffer_load_dwordx4 v[244:247], v12, s[20:23], s63 offen offset:2048 nt
s_waitcnt vmcnt(3)
s_add_u32 s63, s74, 77824
buffer_load_dwordx4 v[248:251], v12, s[20:23], s63 offen offset:0 nt
s_waitcnt vmcnt(3)
s_add_u32 s63, s74, 77824
buffer_load_dwordx4 v[252:255], v12, s[20:23], s63 offen offset:2048 nt
v_and_b32 v10, 1, v1
v_cmp_eq_u32 vcc, 1, v10
v_mov_b32 v10, 0x3f80
v_mov_b32 v11, 1.0
v_cndmask_b32 v10, v10, v11, vcc
v_bfe_u32 v11, v1, 1, 3
v_cmp_eq_u32 vcc, 0, v11
s_nop 1
v_cndmask_b32 v16, 0, v10, vcc
v_cmp_eq_u32 vcc, 1, v11
s_nop 1
v_cndmask_b32 v17, 0, v10, vcc
v_cmp_eq_u32 vcc, 2, v11
s_nop 1
v_cndmask_b32 v18, 0, v10, vcc
v_cmp_eq_u32 vcc, 3, v11
s_nop 1
v_cndmask_b32 v19, 0, v10, vcc
v_cmp_eq_u32 vcc, 4, v11
s_nop 1
v_cndmask_b32 v20, 0, v10, vcc
v_cmp_eq_u32 vcc, 5, v11
s_nop 1
v_cndmask_b32 v21, 0, v10, vcc
v_cmp_eq_u32 vcc, 6, v11
s_nop 1
v_cndmask_b32 v22, 0, v10, vcc
v_cmp_eq_u32 vcc, 7, v11
s_nop 1
v_cndmask_b32 v23, 0, v10, vcc
v_bfe_u32 v13, v1, 3, 1
v_lshlrev_b32 v13, 17, v13
v_lshrrev_b32 v10, 4, v1
v_lshl_add_u32 v13, v10, 11, v13
v_and_b32 v10, 7, v1
v_lshl_add_u32 v13, v10, 4, v13
s_lshr_b32 s60, s72, 1
s_lshl_b32 s60, s60, 15
s_and_b32 s61, s72, 1
s_lshl_b32 s61, s61, 10
s_add_u32 s60, s60, s61
s_lshl_b32 s61, s3, 7
s_add_u32 s60, s60, s61
s_add_u32 s79, s60, 262144
s_lshl_b32 s60, s3, 10
s_add_u32 s60, s60, 40960
v_lshrrev_b32 v14, 5, v1
v_lshlrev_b32 v14, 8, v14
v_bfe_u32 v10, v1, 3, 1
v_lshl_add_u32 v14, v10, 7, v14
v_and_b32 v10, 7, v1
v_lshl_add_u32 v14, v10, 3, v14
v_bfe_u32 v10, v1, 4, 1
v_lshl_add_u32 v14, v10, 2, v14
v_add_u32 v14, s60, v14
v_bfe_u32 v10, v1, 2, 2
v_lshlrev_b32 v10, 7, v10
v_and_b32 v24, 1, v1
v_lshl_add_u32 v10, v24, 6, v10
v_lshrrev_b32 v24, 4, v1
v_lshl_add_u32 v10, v24, 4, v10
v_add_u32 v10, s60, v10
v_mov_b32 v11, 49152
s_mov_b32 s66, 0x33333333
s_mov_b32 s67, 0x33333333
v_cndmask_b32 v24, v11, v10, s[66:67]
v_cndmask_b32 v25, v10, v11, s[66:67]
s_mov_b32 s66, 0x55555555
s_mov_b32 s67, 0x55555555
v_mov_b32 v10, 0xeeee
v_mov_b32 v11, 0x4444
v_cndmask_b32 v26, v10, v11, s[66:67]
s_lshl_b32 s60, s3, 11
s_add_u32 s60, s60, 60416
v_lshrrev_b32 v15, 4, v1
v_lshlrev_b32 v15, 9, v15
v_and_b32 v10, 15, v1
v_lshl_add_u32 v15, v10, 5, v15
v_add_u32 v15, s60, v15
s_lshl_b32 s60, s3, 9
s_add_u32 s60, s60, 60416
v_lshlrev_b32 v28, 3, v1
v_add_u32 v28, s60, v28
s_lshl_b32 s60, s3, 11
s_add_u32 s73, s73, s60
v_mov_b32 v32, 0
v_mov_b32 v33, 0
v_mov_b32 v34, 0
v_mov_b32 v35, 0
v_mov_b32 v36, 0
v_mov_b32 v37, 0
v_mov_b32 v38, 0
v_mov_b32 v39, 0
v_mov_b32 v40, 0
v_mov_b32 v41, 0
v_mov_b32 v42, 0
v_mov_b32 v43, 0
v_mov_b32 v44, 0
v_mov_b32 v45, 0
v_mov_b32 v46, 0
v_mov_b32 v47, 0
v_mov_b32 v48, 0
v_mov_b32 v49, 0
v_mov_b32 v50, 0
v_mov_b32 v51, 0
s_add_u32 s63, s79, 0
buffer_load_dwordx4 v[64:67], v13, s[16:19], s63 offen sc1
s_add_u32 s63, s79, 8192
buffer_load_dwordx4 v[68:71], v13, s[16:19], s63 offen sc1
s_add_u32 s63, s79, 16384
buffer_load_dwordx4 v[72:75], v13, s[16:19], s63 offen sc1
s_add_u32 s63, s79, 24576
buffer_load_dwordx4 v[76:79], v13, s[16:19], s63 offen sc1
s_add_u32 s63, s79, 262144
buffer_load_dwordx4 v[80:83], v13, s[16:19], s63 offen sc1
s_add_u32 s63, s79, 270336
buffer_load_dwordx4 v[84:87], v13, s[16:19], s63 offen sc1
s_add_u32 s63, s79, 278528
buffer_load_dwordx4 v[88:91], v13, s[16:19], s63 offen sc1
s_add_u32 s63, s79, 286720
buffer_load_dwordx4 v[92:95], v13, s[16:19], s63 offen sc1
s_waitcnt vmcnt(8)
v_perm_b32 v100, v228, v224, s64
v_perm_b32 v101, v236, v232, s64
v_perm_b32 v102, v244, v240, s64
v_perm_b32 v103, v252, v248, s64
v_perm_b32 v108, v228, v224, s65
v_perm_b32 v109, v236, v232, s65
v_perm_b32 v110, v244, v240, s65
v_perm_b32 v111, v252, v248, s65
v_perm_b32 v116, v229, v225, s64
v_perm_b32 v117, v237, v233, s64
v_perm_b32 v118, v245, v241, s64
v_perm_b32 v119, v253, v249, s64
v_perm_b32 v124, v229, v225, s65
v_perm_b32 v125, v237, v233, s65
v_perm_b32 v126, v245, v241, s65
v_perm_b32 v127, v253, v249, s65
v_perm_b32 v132, v230, v226, s64
v_perm_b32 v133, v238, v234, s64
v_perm_b32 v134, v246, v242, s64
v_perm_b32 v135, v254, v250, s64
v_perm_b32 v140, v230, v226, s65
v_perm_b32 v141, v238, v234, s65
v_perm_b32 v142, v246, v242, s65
v_perm_b32 v143, v254, v250, s65
v_perm_b32 v148, v231, v227, s64
v_perm_b32 v149, v239, v235, s64
v_perm_b32 v150, v247, v243, s64
v_perm_b32 v151, v255, v251, s64
v_perm_b32 v156, v231, v227, s65
v_perm_b32 v157, v239, v235, s65
v_perm_b32 v158, v247, v243, s65
v_perm_b32 v159, v255, v251, s65
L_otail:
s_waitcnt vmcnt(0)
s_mov_b32 s71, 0
s_mov_b32 s70, 0
s_mov_b64 s[68:69], 0
s_branch L_O_prchk15
L_O_pr13:
s_bitcmp1_b32 s71, 0
s_cbranch_scc1 L_O_pi16
s_add_u32 s63, s79, 0
buffer_load_dwordx4 v[64:67], v13, s[16:19], s63 offen sc1
L_O_pi16:
s_bitcmp1_b32 s71, 1
s_cbranch_scc1 L_O_pi17
s_add_u32 s63, s79, 8192
buffer_load_dwordx4 v[68:71], v13, s[16:19], s63 offen sc1
L_O_pi17:
s_bitcmp1_b32 s71, 2
s_cbranch_scc1 L_O_pi18
s_add_u32 s63, s79, 16384
buffer_load_dwordx4 v[72:75], v13, s[16:19], s63 offen sc1
L_O_pi18:
s_bitcmp1_b32 s71, 3
s_cbranch_scc1 L_O_pi19
s_add_u32 s63, s79, 24576
buffer_load_dwordx4 v[76:79], v13, s[16:19], s63 offen sc1
L_O_pi19:
s_bitcmp1_b32 s71, 4
s_cbranch_scc1 L_O_pi20
s_add_u32 s63, s79, 262144
buffer_load_dwordx4 v[80:83], v13, s[16:19], s63 offen sc1
L_O_pi20:
s_bitcmp1_b32 s71, 5
s_cbranch_scc1 L_O_pi21
s_add_u32 s63, s79, 270336
buffer_load_dwordx4 v[84:87], v13, s[16:19], s63 offen sc1
L_O_pi21:
s_bitcmp1_b32 s71, 6
s_cbranch_scc1 L_O_pi22
s_add_u32 s63, s79, 278528
buffer_load_dwordx4 v[88:91], v13, s[16:19], s63 offen sc1
L_O_pi22:
s_bitcmp1_b32 s71, 7
s_cbranch_scc1 L_O_pi23
s_add_u32 s63, s79, 286720
buffer_load_dwordx4 v[92:95], v13, s[16:19], s63 offen sc1
L_O_pi23:
s_add_u32 s70, s70, 1
s_cmp_ge_u32 s70, 262144
s_cselect_b64 s[68:69], -1, 0
s_waitcnt vmcnt(0)
L_O_prchk15:
s_bitcmp1_b32 s71, 0
s_cbranch_scc1 L_O_pc24
v_max_u32 v10, v64, v65
v_max3_u32 v10, v10, v66, v67
v_cmp_ne_u32 vcc, -1, v10
s_or_b64 vcc, vcc, s[68:69]
s_cmp_eq_u64 vcc, -1
s_cbranch_scc0 L_O_pc24
v_mfma_f32_16x16x32_bf16 v[48:51], v[16:19], v[64:67], v[48:51]
s_bitset1_b32 s71, 0
L_O_pc24:
s_bitcmp1_b32 s71, 1
s_cbranch_scc1 L_O_pc25
v_max_u32 v10, v68, v69
v_max3_u32 v10, v10, v70, v71
v_cmp_ne_u32 vcc, -1, v10
s_or_b64 vcc, vcc, s[68:69]
s_cmp_eq_u64 vcc, -1
s_cbranch_scc0 L_O_pc25
v_mfma_f32_16x16x32_bf16 v[48:51], v[16:19], v[68:71], v[48:51]
s_bitset1_b32 s71, 1
L_O_pc25:
s_bitcmp1_b32 s71, 2
s_cbranch_scc1 L_O_pc26
v_max_u32 v10, v72, v73
v_max3_u32 v10, v10, v74, v75
v_cmp_ne_u32 vcc, -1, v10
s_or_b64 vcc, vcc, s[68:69]
s_cmp_eq_u64 vcc, -1
s_cbranch_scc0 L_O_pc26
v_mfma_f32_16x16x32_bf16 v[48:51], v[16:19], v[72:75], v[48:51]
s_bitset1_b32 s71, 2
L_O_pc26:
s_bitcmp1_b32 s71, 3
s_cbranch_scc1 L_O_pc27
v_max_u32 v10, v76, v77
v_max3_u32 v10, v10, v78, v79
v_cmp_ne_u32 vcc, -1, v10
s_or_b64 vcc, vcc, s[68:69]
s_cmp_eq_u64 vcc, -1
s_cbranch_scc0 L_O_pc27
v_mfma_f32_16x16x32_bf16 v[48:51], v[16:19], v[76:79], v[48:51]
s_bitset1_b32 s71, 3
L_O_pc27:
s_bitcmp1_b32 s71, 4
s_cbranch_scc1 L_O_pc28
v_max_u32 v10, v80, v81
v_max3_u32 v10, v10, v82, v83
v_cmp_ne_u32 vcc, -1, v10
s_or_b64 vcc, vcc, s[68:69]
s_cmp_eq_u64 vcc, -1
s_cbranch_scc0 L_O_pc28
v_mfma_f32_16x16x32_bf16 v[48:51], v[20:23], v[80:83], v[48:51]
s_bitset1_b32 s71, 4
L_O_pc28:
s_bitcmp1_b32 s71, 5
s_cbranch_scc1 L_O_pc29
v_max_u32 v10, v84, v85
v_max3_u32 v10, v10, v86, v87
v_cmp_ne_u32 vcc, -1, v10
s_or_b64 vcc, vcc, s[68:69]
s_cmp_eq_u64 vcc, -1
s_cbranch_scc0 L_O_pc29
v_mfma_f32_16x16x32_bf16 v[48:51], v[20:23], v[84:87], v[48:51]
s_bitset1_b32 s71, 5
L_O_pc29:
s_bitcmp1_b32 s71, 6
s_cbranch_scc1 L_O_pc30
v_max_u32 v10, v88, v89
v_max3_u32 v10, v10, v90, v91
v_cmp_ne_u32 vcc, -1, v10
s_or_b64 vcc, vcc, s[68:69]
s_cmp_eq_u64 vcc, -1
s_cbranch_scc0 L_O_pc30
v_mfma_f32_16x16x32_bf16 v[48:51], v[20:23], v[88:91], v[48:51]
s_bitset1_b32 s71, 6
L_O_pc30:
s_bitcmp1_b32 s71, 7
s_cbranch_scc1 L_O_pc31
v_max_u32 v10, v92, v93
v_max3_u32 v10, v10, v94, v95
v_cmp_ne_u32 vcc, -1, v10
s_or_b64 vcc, vcc, s[68:69]
s_cmp_eq_u64 vcc, -1
s_cbranch_scc0 L_O_pc31
v_mfma_f32_16x16x32_bf16 v[48:51], v[20:23], v[92:95], v[48:51]
s_bitset1_b32 s71, 7
L_O_pc31:
s_cmp_lg_u32 s71, 0xff
s_cbranch_scc1 L_O_pr13
L_O_prdone14:
s_nop 4
v_cvt_pk_bf16_f32 v48, v48, v49
v_cvt_pk_bf16_f32 v49, v50, v51
ds_write2_b32 v14, v48, v49 offset0:0 offset1:16
ds_read_b128 v[160:163], v24
ds_read_b128 v[164:167], v25
s_waitcnt lgkmcnt(0)
v_smfmac_f32_16x16x64_bf16 v[32:35], v[160:163], v[96:103], v26
v_smfmac_f32_16x16x64_bf16 v[36:39], v[160:163], v[104:111], v26
v_smfmac_f32_16x16x64_bf16 v[40:43], v[160:163], v[112:119], v26
v_smfmac_f32_16x16x64_bf16 v[44:47], v[160:163], v[120:127], v26
v_smfmac_f32_16x16x64_bf16 v[32:35], v[164:167], v[128:135], v26
v_smfmac_f32_16x16x64_bf16 v[36:39], v[164:167], v[136:143], v26
v_smfmac_f32_16x16x64_bf16 v[40:43], v[164:167], v[144:151], v26
v_smfmac_f32_16x16x64_bf16 v[44:47], v[164:167], v[152:159], v26
s_nop 4
v_add_f32 v52, v32, v33
v_add_f32 v53, v36, v37
v_add_f32 v54, v40, v41
v_add_f32 v55, v44, v45
v_add_f32 v56, v34, v35
v_add_f32 v57, v38, v39
v_add_f32 v58, v42, v43
v_add_f32 v59, v46, v47
ds_write_b128 v15, v[52:55]
ds_write_b128 v15, v[56:59] offset:16
s_waitcnt lgkmcnt(0)
s_barrier
s_cmp_ge_u32 s3, 4
s_cbranch_scc1 L_O_ofin32
ds_read2st64_b64 v[168:171], v28 offset0:0 offset1:4
ds_read2st64_b64 v[172:175], v28 offset0:8 offset1:12
ds_read2st64_b64 v[176:179], v28 offset0:16 offset1:20
ds_read2st64_b64 v[180:183], v28 offset0:24 offset1:28
s_waitcnt lgkmcnt(0)
v_pk_add_f32 v[168:169], v[168:169], v[176:177]
v_pk_add_f32 v[170:171], v[170:171], v[178:179]
v_pk_add_f32 v[172:173], v[172:173], v[180:181]
v_pk_add_f32 v[174:175], v[174:175], v[182:183]
v_pk_add_f32 v[168:169], v[168:169], v[172:173]
v_pk_add_f32 v[170:171], v[170:171], v[174:175]
v_pk_add_f32 v[168:169], v[168:169], v[170:171]
v_cvt_pk_bf16_f32 v172, v168, v169
s_nop 1
v_mov_b32_dpp v173, v172 quad_perm:[1,1,1,1] row_mask:0xf bank_mask:0xf
v_mov_b32_dpp v174, v172 quad_perm:[2,2,2,2] row_mask:0xf bank_mask:0xf
v_mov_b32_dpp v175, v172 quad_perm:[3,3,3,3] row_mask:0xf bank_mask:0xf
s_mov_b32 exec_lo, 0x11111111
s_mov_b32 exec_hi, 0x11111111
buffer_store_dwordx4 v[172:175], v9, s[16:19], s73 offen sc1
s_mov_b64 exec, -1
L_O_ofin32:
s_endpgm
.p2align 6
L_class_M:
s_mov_b32 s16, s58
s_mov_b32 s17, s59
s_mov_b32 s18, 0x10000000
s_mov_b32 s19, 0x20000
v_mov_b32 v4, -1
v_mov_b32 v5, -1
v_mov_b32 v6, -1
v_mov_b32 v7, -1
s_sub_u32 s72, s2, 63
s_cmp_ge_u32 s72, 56
s_cselect_b32 s60, 56, 0
s_sub_u32 s72, s72, s60
s_lshl_b32 s73, s72, 13
s_lshl_b32 s60, s3, 10
s_add_u32 s73, s73, s60
s_add_u32 s73, s73, 786432
s_cmp_lg_u32 s3, 0
s_cbranch_scc1 L_M_clr1
s_setprio 3
s_add_u32 s60, s73, 0
buffer_store_dwordx4 v[4:7], v0, s[16:19], s60 offen offset:0 sc1
buffer_store_dwordx4 v[4:7], v0, s[16:19], s60 offen offset:1024 sc1
buffer_store_dwordx4 v[4:7], v0, s[16:19], s60 offen offset:2048 sc1
buffer_store_dwordx4 v[4:7], v0, s[16:19], s60 offen offset:3072 sc1
s_add_u32 s60, s73, 4096
buffer_store_dwordx4 v[4:7], v0, s[16:19], s60 offen offset:0 sc1
buffer_store_dwordx4 v[4:7], v0, s[16:19], s60 offen offset:1024 sc1
buffer_store_dwordx4 v[4:7], v0, s[16:19], s60 offen offset:2048 sc1
buffer_store_dwordx4 v[4:7], v0, s[16:19], s60 offen offset:3072 sc1
s_lshl_b32 s60, s5, 11
s_add_u32 s60, s60, 262144
buffer_store_dwordx4 v[4:7], v0, s[16:19], s60 offen sc1
buffer_store_dwordx4 v[4:7], v0, s[16:19], s60 offen offset:1024 sc1
s_lshl_b32 s60, s5, 7
s_add_u32 s60, s60, 131072
s_mov_b32 exec_lo, 0xff
s_mov_b32 exec_hi, 0x0
buffer_store_dwordx4 v[4:7], v0, s[16:19], s60 offen sc1
s_mov_b64 exec, -1
v_mov_b32 v8, 0
v_mov_b32 v9, 0
v_lshlrev_b32 v2, 3, v1
ds_write_b64 v2, v[8:9] offset:49152
ds_write_b32 v8, v8 offset:50176
s_setprio 0
L_M_clr1:
s_mov_b32 s12, s36
s_mov_b32 s13, s37
s_mov_b32 s14, 0x4000000
s_mov_b32 s15, 0x20000
s_mov_b32 s28, s56
s_mov_b32 s29, s57
s_mov_b32 s30, 0x100
s_mov_b32 s31, 0x20000
s_mov_b32 s64, 0x05040100
s_mov_b32 s65, 0x07060302
s_lshl_b32 s60, s3, 12
v_lshrrev_b32 v6, 4, v1
v_lshlrev_b32 v7, 2, v6
v_xor_b32 v7, v7, v1
v_and_b32 v7, 15, v7
v_lshlrev_b32 v7, 4, v7
v_lshl_add_u32 v2, v6, 8, v7
v_add_u32 v2, s60, v2
v_xor_b32 v3, 16, v2
v_xor_b32 v4, 32, v2
v_xor_b32 v5, 48, v2
v_xor_b32 v7, v6, v1
v_and_b32 v7, 15, v7
v_lshlrev_b32 v7, 4, v7
v_and_b32 v8, 3, v1
v_lshl_add_u32 v7, v8, 10, v7
v_bfe_u32 v8, v1, 2, 2
v_lshl_add_u32 v7, v8, 8, v7
v_add_u32 v6, s60, v7
v_xor_b32 v7, 64, v6
v_xor_b32 v8, 128, v6
v_xor_b32 v9, 192, v6
s_cmp_lg_u32 s3, 0
s_cbranch_scc1 L_M_arr2
s_waitcnt vmcnt(0) lgkmcnt(0)
L_M_arr2:
s_barrier
s_waitcnt vmcnt(1)
s_add_u32 s63, s7, 32768
buffer_load_dwordx4 v[144:147], v0, s[8:11], s63 offen offset:0 nt
s_waitcnt vmcnt(1)
s_add_u32 s63, s7, 32768
buffer_load_dwordx4 v[148:151], v0, s[8:11], s63 offen offset:1024 nt
ds_write_b128 v2, v[128:131] offset:0
ds_write_b128 v3, v[132:135] offset:1024
ds_write_b128 v4, v[136:139] offset:2048
ds_write_b128 v5, v[140:143] offset:3072
ds_read_b128 v[128:131], v6
ds_read_b128 v[132:135], v7
ds_read_b128 v[136:139], v8
ds_read_b128 v[140:143], v9
s_waitcnt vmcnt(1)
s_add_u32 s63, s7, 32768
buffer_load_dwordx4 v[152:155], v0, s[8:11], s63 offen offset:2048 nt
s_waitcnt vmcnt(1)
s_add_u32 s63, s7, 32768
buffer_load_dwordx4 v[156:159], v0, s[8:11], s63 offen offset:3072 nt
s_waitcnt vmcnt(1)
s_add_u32 s63, s7, 65536
buffer_load_dwordx4 v[160:163], v0, s[8:11], s63 offen offset:0 nt
s_waitcnt vmcnt(1)
s_add_u32 s63, s7, 65536
buffer_load_dwordx4 v[164:167], v0, s[8:11], s63 offen offset:1024 nt
ds_write_b128 v2, v[144:147] offset:0
ds_write_b128 v3, v[148:151] offset:1024
ds_write_b128 v4, v[152:155] offset:2048
ds_write_b128 v5, v[156:159] offset:3072
ds_read_b128 v[144:147], v6
ds_read_b128 v[148:151], v7
ds_read_b128 v[152:155], v8
ds_read_b128 v[156:159], v9
s_cmp_lg_u32 s3, 0
s_cbranch_scc1 L_M_arr3
s_mov_b32 s60, 1
s_atomic_add s60, s[56:57], 0
L_M_arr3:
s_add_u32 s63, s7, 65536
buffer_load_dwordx4 v[168:171], v0, s[8:11], s63 offen offset:2048 nt
s_add_u32 s63, s7, 65536
buffer_load_dwordx4 v[172:175], v0, s[8:11], s63 offen offset:3072 nt
s_add_u32 s63, s7, 98304
buffer_load_dwordx4 v[176:179], v0, s[8:11], s63 offen offset:0 nt
s_add_u32 s63, s7, 98304
buffer_load_dwordx4 v[180:183], v0, s[8:11], s63 offen offset:1024 nt
s_waitcnt vmcnt(5)
s_add_u32 s63, s7, 98304
buffer_load_dwordx4 v[184:187], v0, s[8:11], s63 offen offset:2048 nt
s_waitcnt vmcnt(5)
s_add_u32 s63, s7, 98304
buffer_load_dwordx4 v[188:191], v0, s[8:11], s63 offen offset:3072 nt
s_waitcnt vmcnt(5)
s_mov_b32 s24, s44
s_mov_b32 s25, s45
s_mov_b32 s26, 0x700000
s_mov_b32 s27, 0x20000
s_sub_u32 s62, s2, 64
s_lshl_b32 s62, s62, 3
s_add_u32 s62, s62, s3
s_mul_i32 s62, s62, 16384
s_add_u32 s62, s62, 384
v_lshrrev_b32 v15, 3, v1
v_lshlrev_b32 v15, 10, v15
v_and_b32 v252, 7, v1
v_lshl_add_u32 v15, v252, 4, v15
s_min_u32 s62, s62, 7324032
buffer_load_dwordx4 v[252:255], v15, s[24:27], s62 offen
s_add_u32 s62, s62, 8192
buffer_load_dwordx4 v[252:255], v15, s[24:27], s62 offen
s_waitcnt vmcnt(6)
ds_write_b128 v2, v[160:163] offset:0
ds_write_b128 v3, v[164:167] offset:1024
ds_write_b128 v4, v[168:171] offset:2048
ds_write_b128 v5, v[172:175] offset:3072
ds_read_b128 v[160:163], v6
ds_read_b128 v[164:167], v7
ds_read_b128 v[168:171], v8
ds_read_b128 v[172:175], v9
s_waitcnt vmcnt(5)
s_add_u32 s63, s7, 131072
buffer_load_dwordx4 v[192:195], v0, s[8:11], s63 offen offset:0 nt
s_waitcnt vmcnt(5)
s_add_u32 s63, s7, 131072
buffer_load_dwordx4 v[196:199], v0, s[8:11], s63 offen offset:1024 nt
s_waitcnt vmcnt(5)
s_add_u32 s63, s7, 131072
buffer_load_dwordx4 v[200:203], v0, s[8:11], s63 offen offset:2048 nt
s_waitcnt vmcnt(5)
s_add_u32 s63, s7, 131072
buffer_load_dwordx4 v[204:207], v0, s[8:11], s63 offen offset:3072 nt
ds_write_b128 v2, v[176:179] offset:0
ds_write_b128 v3, v[180:183] offset:1024
ds_write_b128 v4, v[184:187] offset:2048
ds_write_b128 v5, v[188:191] offset:3072
ds_read_b128 v[176:179], v6
ds_read_b128 v[180:183], v7
ds_read_b128 v[184:187], v8
ds_read_b128 v[188:191], v9
s_waitcnt vmcnt(5)
s_add_u32 s63, s7, 163840
buffer_load_dwordx4 v[208:211], v0, s[8:11], s63 offen offset:0 nt
s_waitcnt vmcnt(5)
s_add_u32 s63, s7, 163840
buffer_load_dwordx4 v[212:215], v0, s[8:11], s63 offen offset:1024 nt
s_waitcnt vmcnt(5)
s_add_u32 s63, s7, 163840
buffer_load_dwordx4 v[216:219], v0, s[8:11], s63 offen offset:2048 nt
s_waitcnt vmcnt(5)
s_add_u32 s63, s7, 163840
buffer_load_dwordx4 v[220:223], v0, s[8:11], s63 offen offset:3072 nt
s_waitcnt vmcnt(5)
s_add_u32 s63, s7, 196608
buffer_load_dwordx4 v[224:227], v0, s[8:11], s63 offen offset:0 nt
s_waitcnt vmcnt(5)
s_add_u32 s63, s7, 196608
buffer_load_dwordx4 v[228:231], v0, s[8:11], s63 offen offset:1024 nt
ds_write_b128 v2, v[192:195] offset:0
ds_write_b128 v3, v[196:199] offset:1024
ds_write_b128 v4, v[200:203] offset:2048
ds_write_b128 v5, v[204:207] offset:3072
ds_read_b128 v[192:195], v6
ds_read_b128 v[196:199], v7
ds_read_b128 v[200:203], v8
ds_read_b128 v[204:207], v9
s_waitcnt vmcnt(5)
s_add_u32 s63, s7, 196608
buffer_load_dwordx4 v[232:235], v0, s[8:11], s63 offen offset:2048 nt
s_waitcnt vmcnt(5)
s_add_u32 s63, s7, 196608
buffer_load_dwordx4 v[236:239], v0, s[8:11], s63 offen offset:3072 nt
s_waitcnt vmcnt(5)
s_add_u32 s63, s7, 229376
buffer_load_dwordx4 v[240:243], v0, s[8:11], s63 offen offset:0 nt
s_waitcnt vmcnt(5)
s_add_u32 s63, s7, 229376
buffer_load_dwordx4 v[244:247], v0, s[8:11], s63 offen offset:1024 nt
ds_write_b128 v2, v[208:211] offset:0
ds_write_b128 v3, v[212:215] offset:1024
ds_write_b128 v4, v[216:219] offset:2048
ds_write_b128 v5, v[220:223] offset:3072
ds_read_b128 v[208:211], v6
ds_read_b128 v[212:215], v7
ds_read_b128 v[216:219], v8
ds_read_b128 v[220:223], v9
s_waitcnt vmcnt(5)
s_add_u32 s63, s7, 229376
buffer_load_dwordx4 v[248:251], v0, s[8:11], s63 offen offset:2048 nt
s_waitcnt vmcnt(5)
s_add_u32 s63, s7, 229376
buffer_load_dwordx4 v[252:255], v0, s[8:11], s63 offen offset:3072 nt
s_waitcnt vmcnt(5)
s_add_u32 s63, s7, 0
buffer_load_dwordx4 v[64:67], v0, s[12:15], s63 offen offset:0 nt
s_waitcnt vmcnt(5)
s_add_u32 s63, s7, 0
buffer_load_dwordx4 v[68:71], v0, s[12:15], s63 offen offset:1024 nt
ds_write_b128 v2, v[224:227] offset:0
ds_write_b128 v3, v[228:231] offset:1024
ds_write_b128 v4, v[232:235] offset:2048
ds_write_b128 v5, v[236:239] offset:3072
ds_read_b128 v[224:227], v6
ds_read_b128 v[228:231], v7
ds_read_b128 v[232:235], v8
ds_read_b128 v[236:239], v9
s_waitcnt vmcnt(5)
s_add_u32 s63, s7, 0
buffer_load_dwordx4 v[72:75], v0, s[12:15], s63 offen offset:2048 nt
s_waitcnt vmcnt(5)
s_add_u32 s63, s7, 0
buffer_load_dwordx4 v[76:79], v0, s[12:15], s63 offen offset:3072 nt
s_waitcnt vmcnt(5)
s_add_u32 s63, s7, 32768
buffer_load_dwordx4 v[80:83], v0, s[12:15], s63 offen offset:0 nt
s_waitcnt vmcnt(5)
s_add_u32 s63, s7, 32768
buffer_load_dwordx4 v[84:87], v0, s[12:15], s63 offen offset:1024 nt
ds_write_b128 v2, v[240:243] offset:0
ds_write_b128 v3, v[244:247] offset:1024
ds_write_b128 v4, v[248:251] offset:2048
ds_write_b128 v5, v[252:255] offset:3072
ds_read_b128 v[240:243], v6
ds_read_b128 v[244:247], v7
ds_read_b128 v[248:251], v8
ds_read_b128 v[252:255], v9
s_mov_b32 s20, s48
s_mov_b32 s21, s49
s_mov_b32 s22, 0x700000
s_mov_b32 s23, 0x20000
s_mov_b32 s24, s32
s_mov_b32 s25, s33
s_mov_b32 s26, 0x2000
s_mov_b32 s27, 0x20000
s_mov_b32 s66, 0xff00ff00
s_mov_b32 s67, 0xff00ff00
v_mov_b32 v12, s44
v_mov_b32 v13, s45
v_mov_b32 v14, s46
v_mov_b32 v15, s47
v_cndmask_b32 v12, v12, v14, s[66:67]
v_cndmask_b32 v13, v13, v15, s[66:67]
s_mul_i32 s60, s3, 917504
s_lshl_b32 s61, s72, 7
s_add_u32 s60, s60, s61
v_lshrrev_b32 v14, 4, v1
v_mul_u32_u24 v14, 57344, v14
v_and_b32 v15, 7, v1
v_lshl_add_u32 v14, v15, 4, v14
v_add_u32 v14, s60, v14
v_mov_b32 v15, 0
v_lshl_add_u64 v[12:13], v[14:15], 0, v[12:13]
s_mov_b32 s80, 7168
s_mov_b32 s81, 0
s_mov_b32 s82, 179200
s_mov_b32 s83, 0
v_lshrrev_b32 v14, 4, v1
v_lshlrev_b32 v14, 14, v14
v_and_b32 v15, 15, v1
v_lshl_add_u32 v14, v15, 4, v14
s_lshl_b32 s74, s72, 17
s_lshl_b32 s60, s3, 8
s_add_u32 s74, s74, s60
s_waitcnt vmcnt(5)
s_add_u32 s63, s7, 32768
buffer_load_dwordx4 v[88:91], v0, s[12:15], s63 offen offset:2048 nt
s_waitcnt vmcnt(5)
s_add_u32 s63, s7, 32768
buffer_load_dwordx4 v[92:95], v0, s[12:15], s63 offen offset:3072 nt
s_waitcnt vmcnt(5)
s_add_u32 s63, s7, 65536
buffer_load_dwordx4 v[96:99], v0, s[12:15], s63 offen offset:0 nt
s_waitcnt vmcnt(5)
s_add_u32 s63, s7, 65536
buffer_load_dwordx4 v[100:103], v0, s[12:15], s63 offen offset:1024 nt
s_waitcnt vmcnt(5)
s_add_u32 s63, s7, 65536
buffer_load_dwordx4 v[104:107], v0, s[12:15], s63 offen offset:2048 nt
s_waitcnt vmcnt(5)
s_add_u32 s63, s7, 65536
buffer_load_dwordx4 v[108:111], v0, s[12:15], s63 offen offset:3072 nt
s_waitcnt vmcnt(5)
s_add_u32 s63, s7, 98304
buffer_load_dwordx4 v[112:115], v0, s[12:15], s63 offen offset:0 nt
s_waitcnt vmcnt(5)
buffer_load_dword v10, off, s[28:31], 0 offset:0 sc1
s_waitcnt vmcnt(5)
s_add_u32 s63, s7, 98304
buffer_load_dwordx4 v[116:119], v0, s[12:15], s63 offen offset:1024 nt
s_waitcnt vmcnt(5)
s_add_u32 s63, s7, 98304
buffer_load_dwordx4 v[120:123], v0, s[12:15], s63 offen offset:2048 nt
s_waitcnt vmcnt(5)
s_add_u32 s63, s7, 98304
buffer_load_dwordx4 v[124:127], v0, s[12:15], s63 offen offset:3072 nt
s_waitcnt vmcnt(5)
s_lshl_b32 s42, s3, 13
s_add_u32 s42, s42, 83968
s_add_u32 m0, s42, 0
s_add_u32 s63, s7, 131072
buffer_load_dwordx4 v0, s[12:15], s63 offen nt lds
s_waitcnt vmcnt(5)
s_add_u32 m0, s42, 1024
s_add_u32 s63, s7, 132096
buffer_load_dwordx4 v0, s[12:15], s63 offen nt lds
s_waitcnt vmcnt(5)
s_add_u32 m0, s42, 2048
s_add_u32 s63, s7, 133120
buffer_load_dwordx4 v0, s[12:15], s63 offen nt lds
v_readfirstlane_b32 s60, v10
s_mov_b32 s70, 0
s_cmp_ge_u32 s60, 256
s_cbranch_scc1 L_M_cok4
L_M_cretry5:
buffer_load_dword v10, off, s[28:31], 0 offset:0 sc1
s_waitcnt vmcnt(0)
v_readfirstlane_b32 s60, v10
s_add_u32 s70, s70, 1
s_cmp_ge_u32 s70, 262144
s_cbranch_scc1 L_M_cok4
s_cmp_lt_u32 s60, 256
s_cbranch_scc1 L_M_cretry5
L_M_cok4:
s_cmp_lt_u32 s3, 4
s_cbranch_scc1 L_M_pr6
s_setprio 1
L_M_pr6:
s_lshl_b32 s60, s3, 12
v_and_b32 v10, 3, v1
v_lshlrev_b32 v10, 2, v10
v_bfe_u32 v11, v1, 2, 1
v_or_b32 v10, v10, v11
v_lshrrev_b32 v11, 4, v1
v_xor_b32 v10, v10, v11
v_lshlrev_b32 v10, 4, v10
v_and_b32 v11, 7, v1
v_lshl_add_u32 v10, v11, 8, v10
v_add_u32 v6, s60, v10
v_xor_b32 v7, 64, v6
v_xor_b32 v8, 128, v6
v_xor_b32 v9, 192, v6
s_waitcnt vmcnt(5)
s_lshr_b32 s75, s5, 4
s_lshl_b32 s75, s75, 11
s_add_u32 s75, s75, 65536
buffer_load_dwordx4 v[16:19], v0, s[16:19], s75 offen offset:0 sc1
buffer_load_dwordx4 v[20:23], v0, s[16:19], s75 offen offset:1024 sc1
s_waitcnt vmcnt(5)
s_add_u32 m0, s42, 3072
s_add_u32 s63, s7, 134144
buffer_load_dwordx4 v0, s[12:15], s63 offen nt lds
s_waitcnt vmcnt(5)
s_add_u32 m0, s42, 4096
s_add_u32 s63, s7, 163840
buffer_load_dwordx4 v0, s[12:15], s63 offen nt lds
s_waitcnt vmcnt(5)
s_add_u32 m0, s42, 5120
s_add_u32 s63, s7, 164864
buffer_load_dwordx4 v0, s[12:15], s63 offen nt lds
s_waitcnt vmcnt(5)
s_add_u32 m0, s42, 6144
s_add_u32 s63, s7, 165888
buffer_load_dwordx4 v0, s[12:15], s63 offen nt lds
s_waitcnt vmcnt(5)
s_add_u32 m0, s42, 7168
s_add_u32 s63, s7, 166912
buffer_load_dwordx4 v0, s[12:15], s63 offen nt lds
s_waitcnt vmcnt(5)
v_max_u32 v10, v16, v17
v_max3_u32 v10, v10, v18, v19
v_max3_u32 v10, v10, v20, v21
v_max3_u32 v10, v10, v22, v23
v_cmp_eq_u32 vcc, -1, v10
s_cbranch_vccz L_M_ok7
s_mov_b32 s70, 0
L_M_retry8:
buffer_load_dwordx4 v[16:19], v0, s[16:19], s75 offen offset:0 sc1
buffer_load_dwordx4 v[20:23], v0, s[16:19], s75 offen offset:1024 sc1
s_waitcnt vmcnt(0)
v_max_u32 v10, v16, v17
v_max3_u32 v10, v10, v18, v19
v_max3_u32 v10, v10, v20, v21
v_max3_u32 v10, v10, v22, v23
s_add_u32 s70, s70, 1
s_cmp_ge_u32 s70, 262144
s_cbranch_scc1 L_M_ok7
v_cmp_eq_u32 vcc, -1, v10
s_cbranch_vccnz L_M_retry8
L_M_ok7:
ds_write_b128 v2, v[16:19] offset:0
ds_write_b128 v3, v[20:23] offset:1024
ds_read_b128 v[16:19], v6
ds_read_b128 v[20:23], v7
ds_read_b128 v[24:27], v8
ds_read_b128 v[28:31], v9
s_waitcnt lgkmcnt(0)
v_mfma_f32_16x16x32_bf16 v[32:35], v[128:131], v[16:19], 0
v_mfma_f32_16x16x32_bf16 v[32:35], v[132:135], v[20:23], v[32:35]
v_mfma_f32_16x16x32_bf16 v[32:35], v[136:139], v[24:27], v[32:35]
v_mfma_f32_16x16x32_bf16 v[32:35], v[140:143], v[28:31], v[32:35]
v_mfma_f32_16x16x32_bf16 v[36:39], v[144:147], v[16:19], 0
v_mfma_f32_16x16x32_bf16 v[36:39], v[148:151], v[20:23], v[36:39]
v_mfma_f32_16x16x32_bf16 v[36:39], v[152:155], v[24:27], v[36:39]
v_mfma_f32_16x16x32_bf16 v[36:39], v[156:159], v[28:31], v[36:39]
s_add_u32 s63, s7, 196608
buffer_load_dwordx4 v[128:131], v0, s[12:15], s63 offen offset:0 nt
s_add_u32 s63, s7, 196608
buffer_load_dwordx4 v[132:135], v0, s[12:15], s63 offen offset:1024 nt
s_add_u32 s63, s7, 196608
buffer_load_dwordx4 v[136:139], v0, s[12:15], s63 offen offset:2048 nt
v_mfma_f32_16x16x32_bf16 v[40:43], v[160:163], v[16:19], 0
v_mfma_f32_16x16x32_bf16 v[40:43], v[164:167], v[20:23], v[40:43]
v_mfma_f32_16x16x32_bf16 v[40:43], v[168:171], v[24:27], v[40:43]
v_mfma_f32_16x16x32_bf16 v[40:43], v[172:175], v[28:31], v[40:43]
v_mfma_f32_16x16x32_bf16 v[44:47], v[176:179], v[16:19], 0
v_mfma_f32_16x16x32_bf16 v[44:47], v[180:183], v[20:23], v[44:47]
v_mfma_f32_16x16x32_bf16 v[44:47], v[184:187], v[24:27], v[44:47]
v_mfma_f32_16x16x32_bf16 v[44:47], v[188:191], v[28:31], v[44:47]
v_mfma_f32_16x16x32_bf16 v[48:51], v[192:195], v[16:19], 0
v_mfma_f32_16x16x32_bf16 v[48:51], v[196:199], v[20:23], v[48:51]
v_mfma_f32_16x16x32_bf16 v[48:51], v[200:203], v[24:27], v[48:51]
v_mfma_f32_16x16x32_bf16 v[48:51], v[204:207], v[28:31], v[48:51]
v_mfma_f32_16x16x32_bf16 v[52:55], v[208:211], v[16:19], 0
v_mfma_f32_16x16x32_bf16 v[52:55], v[212:215], v[20:23], v[52:55]
v_mfma_f32_16x16x32_bf16 v[52:55], v[216:219], v[24:27], v[52:55]
v_mfma_f32_16x16x32_bf16 v[52:55], v[220:223], v[28:31], v[52:55]
v_mfma_f32_16x16x32_bf16 v[56:59], v[224:227], v[16:19], 0
v_mfma_f32_16x16x32_bf16 v[56:59], v[228:231], v[20:23], v[56:59]
v_mfma_f32_16x16x32_bf16 v[56:59], v[232:235], v[24:27], v[56:59]
v_mfma_f32_16x16x32_bf16 v[56:59], v[236:239], v[28:31], v[56:59]
v_mfma_f32_16x16x32_bf16 v[60:63], v[240:243], v[16:19], 0
v_mfma_f32_16x16x32_bf16 v[60:63], v[244:247], v[20:23], v[60:63]
v_mfma_f32_16x16x32_bf16 v[60:63], v[248:251], v[24:27], v[60:63]
v_mfma_f32_16x16x32_bf16 v[60:63], v[252:255], v[28:31], v[60:63]
s_add_u32 s63, s7, 196608
buffer_load_dwordx4 v[140:143], v0, s[12:15], s63 offen offset:3072 nt
v_cvt_pk_bf16_f32 v2, v32, v33
v_lshlrev_b32 v32, 16, v2
v_and_b32 v33, 0xffff0000, v2
v_cvt_pk_bf16_f32 v3, v34, v35
v_lshlrev_b32 v34, 16, v3
v_and_b32 v35, 0xffff0000, v3
v_mul_f32 v32, 0x3db504f3, v32
v_mul_f32 v33, 0x3db504f3, v33
v_mul_f32 v34, 0x3db504f3, v34
v_mul_f32 v35, 0x3db504f3, v35
v_cvt_pk_bf16_f32 v2, v32, v33
v_lshlrev_b32 v32, 16, v2
v_and_b32 v33, 0xffff0000, v2
v_cvt_pk_bf16_f32 v3, v34, v35
v_lshlrev_b32 v34, 16, v3
v_and_b32 v35, 0xffff0000, v3
v_max_f32 v4, v32, v33
v_max3_f32 v4, v4, v34, v35
v_cvt_pk_bf16_f32 v2, v36, v37
v_lshlrev_b32 v36, 16, v2
v_and_b32 v37, 0xffff0000, v2
v_cvt_pk_bf16_f32 v3, v38, v39
v_lshlrev_b32 v38, 16, v3
v_and_b32 v39, 0xffff0000, v3
v_mul_f32 v36, 0x3db504f3, v36
v_mul_f32 v37, 0x3db504f3, v37
v_mul_f32 v38, 0x3db504f3, v38
v_mul_f32 v39, 0x3db504f3, v39
v_cvt_pk_bf16_f32 v2, v36, v37
v_lshlrev_b32 v36, 16, v2
v_and_b32 v37, 0xffff0000, v2
v_cvt_pk_bf16_f32 v3, v38, v39
v_lshlrev_b32 v38, 16, v3
v_and_b32 v39, 0xffff0000, v3
v_max3_f32 v4, v4, v36, v37
v_max3_f32 v4, v4, v38, v39
v_cvt_pk_bf16_f32 v2, v40, v41
v_lshlrev_b32 v40, 16, v2
v_and_b32 v41, 0xffff0000, v2
v_cvt_pk_bf16_f32 v3, v42, v43
v_lshlrev_b32 v42, 16, v3
v_and_b32 v43, 0xffff0000, v3
v_mul_f32 v40, 0x3db504f3, v40
v_mul_f32 v41, 0x3db504f3, v41
v_mul_f32 v42, 0x3db504f3, v42
v_mul_f32 v43, 0x3db504f3, v43
v_cvt_pk_bf16_f32 v2, v40, v41
v_lshlrev_b32 v40, 16, v2
v_and_b32 v41, 0xffff0000, v2
v_cvt_pk_bf16_f32 v3, v42, v43
v_lshlrev_b32 v42, 16, v3
v_and_b32 v43, 0xffff0000, v3
v_max3_f32 v4, v4, v40, v41
v_max3_f32 v4, v4, v42, v43
v_cvt_pk_bf16_f32 v2, v44, v45
v_lshlrev_b32 v44, 16, v2
v_and_b32 v45, 0xffff0000, v2
v_cvt_pk_bf16_f32 v3, v46, v47
v_lshlrev_b32 v46, 16, v3
v_and_b32 v47, 0xffff0000, v3
v_mul_f32 v44, 0x3db504f3, v44
v_mul_f32 v45, 0x3db504f3, v45
v_mul_f32 v46, 0x3db504f3, v46
v_mul_f32 v47, 0x3db504f3, v47
v_cvt_pk_bf16_f32 v2, v44, v45
v_lshlrev_b32 v44, 16, v2
v_and_b32 v45, 0xffff0000, v2
v_cvt_pk_bf16_f32 v3, v46, v47
v_lshlrev_b32 v46, 16, v3
v_and_b32 v47, 0xffff0000, v3
v_max3_f32 v4, v4, v44, v45
v_max3_f32 v4, v4, v46, v47
v_cvt_pk_bf16_f32 v2, v48, v49
v_lshlrev_b32 v48, 16, v2
v_and_b32 v49, 0xffff0000, v2
v_cvt_pk_bf16_f32 v3, v50, v51
v_lshlrev_b32 v50, 16, v3
v_and_b32 v51, 0xffff0000, v3
v_mul_f32 v48, 0x3db504f3, v48
v_mul_f32 v49, 0x3db504f3, v49
v_mul_f32 v50, 0x3db504f3, v50
v_mul_f32 v51, 0x3db504f3, v51
v_cvt_pk_bf16_f32 v2, v48, v49
v_lshlrev_b32 v48, 16, v2
v_and_b32 v49, 0xffff0000, v2
v_cvt_pk_bf16_f32 v3, v50, v51
v_lshlrev_b32 v50, 16, v3
v_and_b32 v51, 0xffff0000, v3
v_max3_f32 v4, v4, v48, v49
v_max3_f32 v4, v4, v50, v51
v_cvt_pk_bf16_f32 v2, v52, v53
v_lshlrev_b32 v52, 16, v2
v_and_b32 v53, 0xffff0000, v2
v_cvt_pk_bf16_f32 v3, v54, v55
v_lshlrev_b32 v54, 16, v3
v_and_b32 v55, 0xffff0000, v3
v_mul_f32 v52, 0x3db504f3, v52
v_mul_f32 v53, 0x3db504f3, v53
v_mul_f32 v54, 0x3db504f3, v54
v_mul_f32 v55, 0x3db504f3, v55
v_cvt_pk_bf16_f32 v2, v52, v53
v_lshlrev_b32 v52, 16, v2
v_and_b32 v53, 0xffff0000, v2
v_cvt_pk_bf16_f32 v3, v54, v55
v_lshlrev_b32 v54, 16, v3
v_and_b32 v55, 0xffff0000, v3
v_max3_f32 v4, v4, v52, v53
v_max3_f32 v4, v4, v54, v55
v_cvt_pk_bf16_f32 v2, v56, v57
v_lshlrev_b32 v56, 16, v2
v_and_b32 v57, 0xffff0000, v2
v_cvt_pk_bf16_f32 v3, v58, v59
v_lshlrev_b32 v58, 16, v3
v_and_b32 v59, 0xffff0000, v3
v_mul_f32 v56, 0x3db504f3, v56
v_mul_f32 v57, 0x3db504f3, v57
v_mul_f32 v58, 0x3db504f3, v58
v_mul_f32 v59, 0x3db504f3, v59
v_cvt_pk_bf16_f32 v2, v56, v57
v_lshlrev_b32 v56, 16, v2
v_and_b32 v57, 0xffff0000, v2
v_cvt_pk_bf16_f32 v3, v58, v59
v_lshlrev_b32 v58, 16, v3
v_and_b32 v59, 0xffff0000, v3
v_max3_f32 v4, v4, v56, v57
v_max3_f32 v4, v4, v58, v59
v_cvt_pk_bf16_f32 v2, v60, v61
v_lshlrev_b32 v60, 16, v2
v_and_b32 v61, 0xffff0000, v2
v_cvt_pk_bf16_f32 v3, v62, v63
v_lshlrev_b32 v62, 16, v3
v_and_b32 v63, 0xffff0000, v3
v_mul_f32 v60, 0x3db504f3, v60
v_mul_f32 v61, 0x3db504f3, v61
v_mul_f32 v62, 0x3db504f3, v62
v_mul_f32 v63, 0x3db504f3, v63
v_cvt_pk_bf16_f32 v2, v60, v61
v_lshlrev_b32 v60, 16, v2
v_and_b32 v61, 0xffff0000, v2
v_cvt_pk_bf16_f32 v3, v62, v63
v_lshlrev_b32 v62, 16, v3
v_and_b32 v63, 0xffff0000, v3
v_max3_f32 v4, v4, v60, v61
v_max3_f32 v4, v4, v62, v63
s_waitcnt vmcnt(6)
s_add_u32 s63, s7, 229376
buffer_load_dwordx4 v[144:147], v0, s[12:15], s63 offen offset:0 nt
s_waitcnt vmcnt(6)
s_add_u32 s63, s7, 229376
buffer_load_dwordx4 v[148:151], v0, s[12:15], s63 offen offset:1024 nt
v_mov_b32 v5, v4
s_nop 1
v_permlane16_swap_b32 v4, v5
v_max_f32 v4, v4, v5
v_mov_b32 v5, v4
s_nop 1
v_permlane32_swap_b32 v4, v5
v_max_f32 v4, v4, v5
v_mul_f32 v6, 0xbfb8aa3b, v4
s_mov_b32 s60, 0x3fb8aa3b
s_mov_b32 s66, 0x00ff00ff
s_mov_b32 s67, 0x00ff00ff
v_mov_b32 v5, 0
v_fma_f32 v32, v32, s60, v6
v_fma_f32 v33, v33, s60, v6
v_fma_f32 v34, v34, s60, v6
v_fma_f32 v35, v35, s60, v6
v_exp_f32 v32, v32
v_exp_f32 v33, v33
v_exp_f32 v34, v34
v_exp_f32 v35, v35
v_add_f32 v7, v32, v33
v_add_f32 v8, v34, v35
v_cvt_pk_bf16_f32 v2, v32, v33
v_cvt_pk_bf16_f32 v3, v34, v35
v_add_f32 v5, v5, v7
v_add_f32 v5, v5, v8
v_cndmask_b32 v16, 0, v2, s[66:67]
v_cndmask_b32 v32, v2, 0, s[66:67]
v_cndmask_b32 v17, 0, v3, s[66:67]
v_cndmask_b32 v33, v3, 0, s[66:67]
v_fma_f32 v36, v36, s60, v6
v_fma_f32 v37, v37, s60, v6
v_fma_f32 v38, v38, s60, v6
v_fma_f32 v39, v39, s60, v6
v_exp_f32 v36, v36
v_exp_f32 v37, v37
v_exp_f32 v38, v38
v_exp_f32 v39, v39
v_add_f32 v7, v36, v37
v_add_f32 v8, v38, v39
v_cvt_pk_bf16_f32 v2, v36, v37
v_cvt_pk_bf16_f32 v3, v38, v39
v_add_f32 v5, v5, v7
v_add_f32 v5, v5, v8
v_cndmask_b32 v18, 0, v2, s[66:67]
v_cndmask_b32 v34, v2, 0, s[66:67]
v_cndmask_b32 v19, 0, v3, s[66:67]
v_cndmask_b32 v35, v3, 0, s[66:67]
v_fma_f32 v40, v40, s60, v6
v_fma_f32 v41, v41, s60, v6
v_fma_f32 v42, v42, s60, v6
v_fma_f32 v43, v43, s60, v6
v_exp_f32 v40, v40
v_exp_f32 v41, v41
v_exp_f32 v42, v42
v_exp_f32 v43, v43
v_add_f32 v7, v40, v41
v_add_f32 v8, v42, v43
v_cvt_pk_bf16_f32 v2, v40, v41
v_cvt_pk_bf16_f32 v3, v42, v43
v_add_f32 v5, v5, v7
v_add_f32 v5, v5, v8
v_cndmask_b32 v20, 0, v2, s[66:67]
v_cndmask_b32 v36, v2, 0, s[66:67]
v_cndmask_b32 v21, 0, v3, s[66:67]
v_cndmask_b32 v37, v3, 0, s[66:67]
v_fma_f32 v44, v44, s60, v6
v_fma_f32 v45, v45, s60, v6
v_fma_f32 v46, v46, s60, v6
v_fma_f32 v47, v47, s60, v6
v_exp_f32 v44, v44
v_exp_f32 v45, v45
v_exp_f32 v46, v46
v_exp_f32 v47, v47
v_add_f32 v7, v44, v45
v_add_f32 v8, v46, v47
v_cvt_pk_bf16_f32 v2, v44, v45
v_cvt_pk_bf16_f32 v3, v46, v47
v_add_f32 v5, v5, v7
v_add_f32 v5, v5, v8
v_cndmask_b32 v22, 0, v2, s[66:67]
v_cndmask_b32 v38, v2, 0, s[66:67]
v_cndmask_b32 v23, 0, v3, s[66:67]
v_cndmask_b32 v39, v3, 0, s[66:67]
v_fma_f32 v48, v48, s60, v6
v_fma_f32 v49, v49, s60, v6
v_fma_f32 v50, v50, s60, v6
v_fma_f32 v51, v51, s60, v6
v_exp_f32 v48, v48
v_exp_f32 v49, v49
v_exp_f32 v50, v50
v_exp_f32 v51, v51
v_add_f32 v7, v48, v49
v_add_f32 v8, v50, v51
v_cvt_pk_bf16_f32 v2, v48, v49
v_cvt_pk_bf16_f32 v3, v50, v51
v_add_f32 v5, v5, v7
v_add_f32 v5, v5, v8
v_cndmask_b32 v24, 0, v2, s[66:67]
v_cndmask_b32 v40, v2, 0, s[66:67]
v_cndmask_b32 v25, 0, v3, s[66:67]
v_cndmask_b32 v41, v3, 0, s[66:67]
v_fma_f32 v52, v52, s60, v6
v_fma_f32 v53, v53, s60, v6
v_fma_f32 v54, v54, s60, v6
v_fma_f32 v55, v55, s60, v6
v_exp_f32 v52, v52
v_exp_f32 v53, v53
v_exp_f32 v54, v54
v_exp_f32 v55, v55
v_add_f32 v7, v52, v53
v_add_f32 v8, v54, v55
v_cvt_pk_bf16_f32 v2, v52, v53
v_cvt_pk_bf16_f32 v3, v54, v55
v_add_f32 v5, v5, v7
v_add_f32 v5, v5, v8
v_cndmask_b32 v26, 0, v2, s[66:67]
v_cndmask_b32 v42, v2, 0, s[66:67]
v_cndmask_b32 v27, 0, v3, s[66:67]
v_cndmask_b32 v43, v3, 0, s[66:67]
v_fma_f32 v56, v56, s60, v6
v_fma_f32 v57, v57, s60, v6
v_fma_f32 v58, v58, s60, v6
v_fma_f32 v59, v59, s60, v6
v_exp_f32 v56, v56
v_exp_f32 v57, v57
v_exp_f32 v58, v58
v_exp_f32 v59, v59
v_add_f32 v7, v56, v57
v_add_f32 v8, v58, v59
v_cvt_pk_bf16_f32 v2, v56, v57
v_cvt_pk_bf16_f32 v3, v58, v59
v_add_f32 v5, v5, v7
v_add_f32 v5, v5, v8
v_cndmask_b32 v28, 0, v2, s[66:67]
v_cndmask_b32 v44, v2, 0, s[66:67]
v_cndmask_b32 v29, 0, v3, s[66:67]
v_cndmask_b32 v45, v3, 0, s[66:67]
v_fma_f32 v60, v60, s60, v6
v_fma_f32 v61, v61, s60, v6
v_fma_f32 v62, v62, s60, v6
v_fma_f32 v63, v63, s60, v6
v_exp_f32 v60, v60
v_exp_f32 v61, v61
v_exp_f32 v62, v62
v_exp_f32 v63, v63
v_add_f32 v7, v60, v61
v_add_f32 v8, v62, v63
v_cvt_pk_bf16_f32 v2, v60, v61
v_cvt_pk_bf16_f32 v3, v62, v63
v_add_f32 v5, v5, v7
v_add_f32 v5, v5, v8
v_cndmask_b32 v30, 0, v2, s[66:67]
v_cndmask_b32 v46, v2, 0, s[66:67]
v_cndmask_b32 v31, 0, v3, s[66:67]
v_cndmask_b32 v47, v3, 0, s[66:67]
v_mov_b32 v6, v5
s_nop 1
v_permlane16_swap_b32 v5, v6
v_add_f32 v5, v5, v6
v_mov_b32 v6, v5
s_nop 1
v_permlane32_swap_b32 v5, v6
v_add_f32 v5, v5, v6
s_lshl_b32 s60, s3, 6
s_add_u32 s60, s60, 49664
v_lshlrev_b32 v6, 3, v1
v_add_u32 v7, s60, v6
v_mov_b32 v8, 1
v_mov_b32 v9, 50176
s_mov_b32 exec_lo, 0xff
s_mov_b32 exec_hi, 0x0
ds_write_b64 v7, v[4:5]
s_mov_b64 exec, 1
ds_add_rtn_u32 v8, v9, v8
s_mov_b64 exec, -1
s_waitcnt lgkmcnt(0)
v_readfirstlane_b32 s60, v8
s_cmp_lg_u32 s60, 7
s_cbranch_scc1 L_M_ml9
ds_read_b64 v[8:9], v6 offset:49664
s_waitcnt lgkmcnt(0)
v_max_f32_dpp v2, v8, v8 row_ror:8 row_mask:0xf bank_mask:0xf
v_mov_b32 v7, v2
s_nop 1
v_permlane16_swap_b32 v2, v7
v_max_f32 v2, v2, v7
v_mov_b32 v7, v2
s_nop 1
v_permlane32_swap_b32 v2, v7
v_max_f32 v2, v2, v7
v_sub_f32 v7, v8, v2
v_mul_f32 v7, 0x3fb8aa3b, v7
v_exp_f32 v7, v7
s_nop 0
v_mul_f32 v3, v9, v7
s_nop 1
v_add_f32_dpp v3, v3, v3 row_ror:8 row_mask:0xf bank_mask:0xf
v_mov_b32 v7, v3
s_nop 1
v_permlane16_swap_b32 v3, v7
v_add_f32 v3, v3, v7
v_mov_b32 v7, v3
s_nop 1
v_permlane32_swap_b32 v3, v7
v_add_f32 v3, v3, v7
s_lshl_b32 s60, s5, 7
s_add_u32 s60, s60, 131072
s_mov_b32 exec_lo, 0xff
s_mov_b32 exec_hi, 0x0
buffer_store_dwordx2 v[2:3], v6, s[16:19], s60 offen sc1
s_mov_b64 exec, -1
L_M_ml9:
s_setprio 0
v_perm_b32 v160, v68, v64, s64
v_perm_b32 v161, v76, v72, s64
v_perm_b32 v162, v84, v80, s64
v_perm_b32 v163, v92, v88, s64
v_perm_b32 v164, v68, v64, s65
v_perm_b32 v165, v76, v72, s65
v_perm_b32 v166, v84, v80, s65
v_perm_b32 v167, v92, v88, s65
v_mfma_f32_16x16x32_bf16 v[48:51], v[160:163], v[16:19], 0
s_nop 0
v_mfma_f32_16x16x32_bf16 v[52:55], v[164:167], v[16:19], 0
v_perm_b32 v168, v69, v65, s64
v_perm_b32 v169, v77, v73, s64
v_perm_b32 v170, v85, v81, s64
v_perm_b32 v171, v93, v89, s64
v_perm_b32 v172, v69, v65, s65
v_perm_b32 v173, v77, v73, s65
v_perm_b32 v174, v85, v81, s65
v_perm_b32 v175, v93, v89, s65
v_mfma_f32_16x16x32_bf16 v[56:59], v[168:171], v[16:19], 0
s_nop 0
v_mfma_f32_16x16x32_bf16 v[60:63], v[172:175], v[16:19], 0
v_perm_b32 v160, v70, v66, s64
v_perm_b32 v161, v78, v74, s64
v_perm_b32 v162, v86, v82, s64
v_perm_b32 v163, v94, v90, s64
v_perm_b32 v164, v70, v66, s65
v_perm_b32 v165, v78, v74, s65
v_perm_b32 v166, v86, v82, s65
v_perm_b32 v167, v94, v90, s65
v_mfma_f32_16x16x32_bf16 v[48:51], v[160:163], v[32:35], v[48:51]
s_nop 0
v_mfma_f32_16x16x32_bf16 v[52:55], v[164:167], v[32:35], v[52:55]
v_perm_b32 v168, v71, v67, s64
v_perm_b32 v169, v79, v75, s64
v_perm_b32 v170, v87, v83, s64
v_perm_b32 v171, v95, v91, s64
v_perm_b32 v172, v71, v67, s65
v_perm_b32 v173, v79, v75, s65
v_perm_b32 v174, v87, v83, s65
v_perm_b32 v175, v95, v91, s65
v_mfma_f32_16x16x32_bf16 v[56:59], v[168:171], v[32:35], v[56:59]
s_nop 0
v_mfma_f32_16x16x32_bf16 v[60:63], v[172:175], v[32:35], v[60:63]
s_waitcnt vmcnt(6)
v_add_u32 v10, s42, v0
ds_read_b128 v[160:163], v10 offset:0
ds_read_b128 v[164:167], v10 offset:1024
ds_read_b128 v[168:171], v10 offset:2048
ds_read_b128 v[172:175], v10 offset:3072
ds_read_b128 v[176:179], v10 offset:4096
ds_read_b128 v[180:183], v10 offset:5120
ds_read_b128 v[184:187], v10 offset:6144
ds_read_b128 v[188:191], v10 offset:7168
v_perm_b32 v64, v100, v96, s64
v_perm_b32 v65, v108, v104, s64
v_perm_b32 v66, v116, v112, s64
v_perm_b32 v67, v124, v120, s64
v_perm_b32 v68, v100, v96, s65
v_perm_b32 v69, v108, v104, s65
v_perm_b32 v70, v116, v112, s65
v_perm_b32 v71, v124, v120, s65
v_mfma_f32_16x16x32_bf16 v[48:51], v[64:67], v[20:23], v[48:51]
s_nop 0
v_mfma_f32_16x16x32_bf16 v[52:55], v[68:71], v[20:23], v[52:55]
v_perm_b32 v72, v101, v97, s64
v_perm_b32 v73, v109, v105, s64
v_perm_b32 v74, v117, v113, s64
v_perm_b32 v75, v125, v121, s64
v_perm_b32 v76, v101, v97, s65
v_perm_b32 v77, v109, v105, s65
v_perm_b32 v78, v117, v113, s65
v_perm_b32 v79, v125, v121, s65
v_mfma_f32_16x16x32_bf16 v[56:59], v[72:75], v[20:23], v[56:59]
s_nop 0
v_mfma_f32_16x16x32_bf16 v[60:63], v[76:79], v[20:23], v[60:63]
v_perm_b32 v64, v102, v98, s64
v_perm_b32 v65, v110, v106, s64
v_perm_b32 v66, v118, v114, s64
v_perm_b32 v67, v126, v122, s64
v_perm_b32 v68, v102, v98, s65
v_perm_b32 v69, v110, v106, s65
v_perm_b32 v70, v118, v114, s65
v_perm_b32 v71, v126, v122, s65
v_mfma_f32_16x16x32_bf16 v[48:51], v[64:67], v[36:39], v[48:51]
s_nop 0
v_mfma_f32_16x16x32_bf16 v[52:55], v[68:71], v[36:39], v[52:55]
v_perm_b32 v72, v103, v99, s64
v_perm_b32 v73, v111, v107, s64
v_perm_b32 v74, v119, v115, s64
v_perm_b32 v75, v127, v123, s64
v_perm_b32 v76, v103, v99, s65
v_perm_b32 v77, v111, v107, s65
v_perm_b32 v78, v119, v115, s65
v_perm_b32 v79, v127, v123, s65
v_mfma_f32_16x16x32_bf16 v[56:59], v[72:75], v[36:39], v[56:59]
s_nop 0
v_mfma_f32_16x16x32_bf16 v[60:63], v[76:79], v[36:39], v[60:63]
s_waitcnt lgkmcnt(0)
v_perm_b32 v64, v164, v160, s64
v_perm_b32 v65, v172, v168, s64
v_perm_b32 v66, v180, v176, s64
v_perm_b32 v67, v188, v184, s64
v_perm_b32 v68, v164, v160, s65
v_perm_b32 v69, v172, v168, s65
v_perm_b32 v70, v180, v176, s65
v_perm_b32 v71, v188, v184, s65
v_mfma_f32_16x16x32_bf16 v[48:51], v[64:67], v[24:27], v[48:51]
s_nop 0
v_mfma_f32_16x16x32_bf16 v[52:55], v[68:71], v[24:27], v[52:55]
v_perm_b32 v72, v165, v161, s64
v_perm_b32 v73, v173, v169, s64
v_perm_b32 v74, v181, v177, s64
v_perm_b32 v75, v189, v185, s64
v_perm_b32 v76, v165, v161, s65
v_perm_b32 v77, v173, v169, s65
v_perm_b32 v78, v181, v177, s65
v_perm_b32 v79, v189, v185, s65
v_mfma_f32_16x16x32_bf16 v[56:59], v[72:75], v[24:27], v[56:59]
s_nop 0
v_mfma_f32_16x16x32_bf16 v[60:63], v[76:79], v[24:27], v[60:63]
v_perm_b32 v64, v166, v162, s64
v_perm_b32 v65, v174, v170, s64
v_perm_b32 v66, v182, v178, s64
v_perm_b32 v67, v190, v186, s64
v_perm_b32 v68, v166, v162, s65
v_perm_b32 v69, v174, v170, s65
v_perm_b32 v70, v182, v178, s65
v_perm_b32 v71, v190, v186, s65
v_mfma_f32_16x16x32_bf16 v[48:51], v[64:67], v[40:43], v[48:51]
s_nop 0
v_mfma_f32_16x16x32_bf16 v[52:55], v[68:71], v[40:43], v[52:55]
v_perm_b32 v72, v167, v163, s64
v_perm_b32 v73, v175, v171, s64
v_perm_b32 v74, v183, v179, s64
v_perm_b32 v75, v191, v187, s64
v_perm_b32 v76, v167, v163, s65
v_perm_b32 v77, v175, v171, s65
v_perm_b32 v78, v183, v179, s65
v_perm_b32 v79, v191, v187, s65
v_mfma_f32_16x16x32_bf16 v[56:59], v[72:75], v[40:43], v[56:59]
s_nop 0
v_mfma_f32_16x16x32_bf16 v[60:63], v[76:79], v[40:43], v[60:63]
s_waitcnt vmcnt(5)
s_add_u32 s63, s7, 229376
buffer_load_dwordx4 v[152:155], v0, s[12:15], s63 offen offset:2048 nt
s_waitcnt vmcnt(5)
s_add_u32 s63, s7, 229376
buffer_load_dwordx4 v[156:159], v0, s[12:15], s63 offen offset:3072 nt
s_waitcnt vmcnt(5)
global_load_dwordx4 v[192:195], v[12:13], off nt
v_lshl_add_u64 v[12:13], s[80:81], 0, v[12:13]
s_waitcnt vmcnt(5)
global_load_dwordx4 v[196:199], v[12:13], off nt
v_lshl_add_u64 v[12:13], s[80:81], 0, v[12:13]
s_waitcnt vmcnt(5)
global_load_dwordx4 v[200:203], v[12:13], off nt
v_lshl_add_u64 v[12:13], s[80:81], 0, v[12:13]
s_waitcnt vmcnt(5)
global_load_dwordx4 v[204:207], v[12:13], off nt
v_lshl_add_u64 v[12:13], s[80:81], 0, v[12:13]
s_waitcnt vmcnt(5)
global_load_dwordx4 v[208:211], v[12:13], off nt
v_lshl_add_u64 v[12:13], s[80:81], 0, v[12:13]
s_waitcnt vmcnt(5)
global_load_dwordx4 v[212:215], v[12:13], off nt
v_lshl_add_u64 v[12:13], s[80:81], 0, v[12:13]
v_perm_b32 v64, v132, v128, s64
v_perm_b32 v65, v140, v136, s64
v_perm_b32 v66, v148, v144, s64
v_perm_b32 v67, v156, v152, s64
v_perm_b32 v68, v132, v128, s65
v_perm_b32 v69, v140, v136, s65
v_perm_b32 v70, v148, v144, s65
v_perm_b32 v71, v156, v152, s65
v_mfma_f32_16x16x32_bf16 v[48:51], v[64:67], v[28:31], v[48:51]
s_nop 0
v_mfma_f32_16x16x32_bf16 v[52:55], v[68:71], v[28:31], v[52:55]
v_perm_b32 v72, v133, v129, s64
v_perm_b32 v73, v141, v137, s64
v_perm_b32 v74, v149, v145, s64
v_perm_b32 v75, v157, v153, s64
v_perm_b32 v76, v133, v129, s65
v_perm_b32 v77, v141, v137, s65
v_perm_b32 v78, v149, v145, s65
v_perm_b32 v79, v157, v153, s65
v_mfma_f32_16x16x32_bf16 v[56:59], v[72:75], v[28:31], v[56:59]
s_nop 0
v_mfma_f32_16x16x32_bf16 v[60:63], v[76:79], v[28:31], v[60:63]
v_perm_b32 v64, v134, v130, s64
v_perm_b32 v65, v142, v138, s64
v_perm_b32 v66, v150, v146, s64
v_perm_b32 v67, v158, v154, s64
v_perm_b32 v68, v134, v130, s65
v_perm_b32 v69, v142, v138, s65
v_perm_b32 v70, v150, v146, s65
v_perm_b32 v71, v158, v154, s65
v_mfma_f32_16x16x32_bf16 v[48:51], v[64:67], v[44:47], v[48:51]
s_nop 0
v_mfma_f32_16x16x32_bf16 v[52:55], v[68:71], v[44:47], v[52:55]
v_perm_b32 v72, v135, v131, s64
v_perm_b32 v73, v143, v139, s64
v_perm_b32 v74, v151, v147, s64
v_perm_b32 v75, v159, v155, s64
v_perm_b32 v76, v135, v131, s65
v_perm_b32 v77, v143, v139, s65
v_perm_b32 v78, v151, v147, s65
v_perm_b32 v79, v159, v155, s65
v_mfma_f32_16x16x32_bf16 v[56:59], v[72:75], v[44:47], v[56:59]
s_nop 0
v_mfma_f32_16x16x32_bf16 v[60:63], v[76:79], v[44:47], v[60:63]
s_waitcnt vmcnt(5)
global_load_dwordx4 v[216:219], v[12:13], off nt
v_lshl_add_u64 v[12:13], s[80:81], 0, v[12:13]
s_waitcnt vmcnt(5)
global_load_dwordx4 v[220:223], v[12:13], off nt
v_lshl_add_u64 v[12:13], s[82:83], 0, v[12:13]
s_waitcnt vmcnt(5)
s_lshr_b32 s75, s5, 4
s_lshl_b32 s75, s75, 11
s_add_u32 s75, s75, 131072
v_lshrrev_b32 v2, 3, v1
v_lshlrev_b32 v2, 7, v2
v_and_b32 v3, 7, v1
v_lshl_add_u32 v2, v3, 3, v2
buffer_load_dwordx2 v[6:7], v2, s[16:19], s75 offen offset:0 sc1
buffer_load_dwordx2 v[8:9], v2, s[16:19], s75 offen offset:1024 sc1
s_waitcnt vmcnt(5)
global_load_dwordx4 v[224:227], v[12:13], off nt
v_lshl_add_u64 v[12:13], s[80:81], 0, v[12:13]
s_waitcnt vmcnt(5)
global_load_dwordx4 v[228:231], v[12:13], off nt
v_lshl_add_u64 v[12:13], s[80:81], 0, v[12:13]
s_waitcnt vmcnt(5)
global_load_dwordx4 v[232:235], v[12:13], off nt
v_lshl_add_u64 v[12:13], s[80:81], 0, v[12:13]
s_waitcnt vmcnt(5)
global_load_dwordx4 v[236:239], v[12:13], off nt
v_lshl_add_u64 v[12:13], s[80:81], 0, v[12:13]
s_waitcnt vmcnt(5)
global_load_dwordx4 v[240:243], v[12:13], off nt
v_lshl_add_u64 v[12:13], s[80:81], 0, v[12:13]
s_waitcnt vmcnt(5)
global_load_dwordx4 v[244:247], v[12:13], off nt
v_lshl_add_u64 v[12:13], s[80:81], 0, v[12:13]
v_max_u32 v3, v6, v7
v_max3_u32 v3, v3, v8, v9
v_cmp_eq_u32 vcc, -1, v3
s_cbranch_vccz L_M_ok10
s_mov_b32 s70, 0
L_M_retry11:
buffer_load_dwordx2 v[6:7], v2, s[16:19], s75 offen offset:0 sc1
buffer_load_dwordx2 v[8:9], v2, s[16:19], s75 offen offset:1024 sc1
s_waitcnt vmcnt(0)
v_max_u32 v3, v6, v7
v_max3_u32 v3, v3, v8, v9
s_add_u32 s70, s70, 1
s_cmp_ge_u32 s70, 262144
s_cbranch_scc1 L_M_ok10
v_cmp_eq_u32 vcc, -1, v3
s_cbranch_vccnz L_M_retry11
L_M_ok10:
v_max_f32 v3, v6, v8
v_sub_f32 v6, v6, v3
v_sub_f32 v8, v8, v3
v_mul_f32 v6, 0x3fb8aa3b, v6
v_mul_f32 v8, 0x3fb8aa3b, v8
v_exp_f32 v6, v6
v_exp_f32 v8, v8
v_mul_f32 v7, v7, v6
v_fmac_f32 v7, v9, v8
v_max_f32_dpp v6, v3, v3 row_ror:8 row_mask:0xf bank_mask:0xf
v_mov_b32 v9, v6
s_nop 1
v_permlane16_swap_b32 v6, v9
v_max_f32 v6, v6, v9
v_mov_b32 v9, v6
s_nop 1
v_permlane32_swap_b32 v6, v9
v_max_f32 v6, v6, v9
v_sub_f32 v9, v3, v6
v_mul_f32 v9, 0x3fb8aa3b, v9
v_exp_f32 v9, v9
s_nop 0
v_mul_f32 v8, v7, v9
s_nop 1
v_add_f32_dpp v8, v8, v8 row_ror:8 row_mask:0xf bank_mask:0xf
v_mov_b32 v9, v8
s_nop 1
v_permlane16_swap_b32 v8, v9
v_add_f32 v8, v8, v9
v_mov_b32 v9, v8
s_nop 1
v_permlane32_swap_b32 v8, v9
v_add_f32 v8, v8, v9
v_sub_f32 v4, v4, v6
v_mul_f32 v4, 0x3fb8aa3b, v4
v_exp_f32 v4, v4
v_rcp_f32 v8, v8
s_nop 0
v_mul_f32 v5, v4, v8
s_mul_i32 s60, s3, 4864
s_add_u32 s60, s60, 0
v_and_b32 v6, 7, v1
v_mul_u32_u24 v6, 592, v6
v_lshrrev_b32 v3, 4, v1
v_mul_u32_u24 v3, 144, v3
v_add_u32 v6, v3, v6
v_bfe_u32 v3, v1, 3, 1
v_lshl_add_u32 v6, v3, 6, v6
v_add_u32 v6, s60, v6
s_mul_i32 s60, s3, 592
s_add_u32 s60, s60, 0
v_lshrrev_b32 v7, 4, v1
v_mul_u32_u24 v7, 144, v7
v_bfe_u32 v3, v1, 1, 1
v_lshl_add_u32 v7, v3, 6, v7
v_and_b32 v3, 1, v1
v_lshl_add_u32 v7, v3, 5, v7
v_bfe_u32 v3, v1, 2, 2
v_lshl_add_u32 v7, v3, 2, v7
v_add_u32 v7, s60, v7
v_add_u32 v8, 16, v7
v_lshlrev_b32 v9, 2, v1
s_lshl_b32 s75, s5, 11
s_lshl_b32 s61, s3, 8
s_add_u32 s75, s75, s61
s_add_u32 s75, s75, 262144
global_load_dwordx4 v[248:251], v[12:13], off nt
v_lshl_add_u64 v[12:13], s[80:81], 0, v[12:13]
global_load_dwordx4 v[252:255], v[12:13], off nt
v_lshl_add_u64 v[12:13], s[82:83], 0, v[12:13]
global_load_dwordx4 v[96:99], v[12:13], off nt
v_lshl_add_u64 v[12:13], s[80:81], 0, v[12:13]
global_load_dwordx4 v[100:103], v[12:13], off nt
v_lshl_add_u64 v[12:13], s[80:81], 0, v[12:13]
global_load_dwordx4 v[104:107], v[12:13], off nt
v_lshl_add_u64 v[12:13], s[80:81], 0, v[12:13]
global_load_dwordx4 v[108:111], v[12:13], off nt
v_lshl_add_u64 v[12:13], s[80:81], 0, v[12:13]
v_pk_mul_f32 v[48:49], v[48:49], v[4:5] op_sel:[0,1] op_sel_hi:[1,1]
v_pk_mul_f32 v[50:51], v[50:51], v[4:5] op_sel:[0,1] op_sel_hi:[1,1]
ds_write_b128 v6, v[48:51] offset:0
v_pk_mul_f32 v[52:53], v[52:53], v[4:5] op_sel:[0,1] op_sel_hi:[1,1]
v_pk_mul_f32 v[54:55], v[54:55], v[4:5] op_sel:[0,1] op_sel_hi:[1,1]
ds_write_b128 v6, v[52:55] offset:16
v_pk_mul_f32 v[56:57], v[56:57], v[4:5] op_sel:[0,1] op_sel_hi:[1,1]
v_pk_mul_f32 v[58:59], v[58:59], v[4:5] op_sel:[0,1] op_sel_hi:[1,1]
ds_write_b128 v6, v[56:59] offset:32
v_pk_mul_f32 v[60:61], v[60:61], v[4:5] op_sel:[0,1] op_sel_hi:[1,1]
v_pk_mul_f32 v[62:63], v[62:63], v[4:5] op_sel:[0,1] op_sel_hi:[1,1]
ds_write_b128 v6, v[60:63] offset:48
s_waitcnt lgkmcnt(0)
s_barrier
ds_read2st64_b32 v[16:17], v7 offset0:0 offset1:19
ds_read2st64_b32 v[24:25], v8 offset0:0 offset1:19
ds_read2st64_b32 v[18:19], v7 offset0:38 offset1:57
ds_read2st64_b32 v[26:27], v8 offset0:38 offset1:57
ds_read2st64_b32 v[20:21], v7 offset0:76 offset1:95
ds_read2st64_b32 v[28:29], v8 offset0:76 offset1:95
ds_read2st64_b32 v[22:23], v7 offset0:114 offset1:133
ds_read2st64_b32 v[30:31], v8 offset0:114 offset1:133
s_waitcnt lgkmcnt(0)
v_pk_add_f32 v[16:17], v[16:17], v[20:21]
v_pk_add_f32 v[18:19], v[18:19], v[22:23]
v_pk_add_f32 v[24:25], v[24:25], v[28:29]
v_pk_add_f32 v[26:27], v[26:27], v[30:31]
v_pk_add_f32 v[16:17], v[16:17], v[18:19]
v_pk_add_f32 v[24:25], v[24:25], v[26:27]
v_add_f32 v16, v16, v17
v_add_f32 v24, v24, v25
v_cvt_pk_bf16_f32 v20, v16, v24
s_nop 1
v_mov_b32_dpp v21, v20 quad_perm:[1,1,1,1] row_mask:0xf bank_mask:0xf
v_mov_b32_dpp v22, v20 quad_perm:[2,2,2,2] row_mask:0xf bank_mask:0xf
v_mov_b32_dpp v23, v20 quad_perm:[3,3,3,3] row_mask:0xf bank_mask:0xf
s_mov_b32 exec_lo, 0x11111111
s_mov_b32 exec_hi, 0x11111111
buffer_store_dwordx4 v[20:23], v9, s[16:19], s75 offen sc1
s_mov_b64 exec, -1
v_perm_b32 v32, v196, v192, s64
v_perm_b32 v33, v204, v200, s64
v_perm_b32 v34, v212, v208, s64
v_perm_b32 v35, v220, v216, s64
v_perm_b32 v40, v196, v192, s65
v_perm_b32 v41, v204, v200, s65
v_perm_b32 v42, v212, v208, s65
v_perm_b32 v43, v220, v216, s65
v_perm_b32 v48, v197, v193, s64
v_perm_b32 v49, v205, v201, s64
v_perm_b32 v50, v213, v209, s64
v_perm_b32 v51, v221, v217, s64
v_perm_b32 v56, v197, v193, s65
v_perm_b32 v57, v205, v201, s65
v_perm_b32 v58, v213, v209, s65
v_perm_b32 v59, v221, v217, s65
v_perm_b32 v64, v198, v194, s64
v_perm_b32 v65, v206, v202, s64
v_perm_b32 v66, v214, v210, s64
v_perm_b32 v67, v222, v218, s64
v_perm_b32 v72, v198, v194, s65
v_perm_b32 v73, v206, v202, s65
v_perm_b32 v74, v214, v210, s65
v_perm_b32 v75, v222, v218, s65
v_perm_b32 v80, v199, v195, s64
v_perm_b32 v81, v207, v203, s64
v_perm_b32 v82, v215, v211, s64
v_perm_b32 v83, v223, v219, s64
v_perm_b32 v88, v199, v195, s65
v_perm_b32 v89, v207, v203, s65
v_perm_b32 v90, v215, v211, s65
v_perm_b32 v91, v223, v219, s65
s_waitcnt vmcnt(5)
global_load_dwordx4 v[112:115], v[12:13], off nt
v_lshl_add_u64 v[12:13], s[80:81], 0, v[12:13]
v_perm_b32 v36, v228, v224, s64
v_perm_b32 v37, v236, v232, s64
v_perm_b32 v38, v244, v240, s64
v_perm_b32 v39, v252, v248, s64
v_perm_b32 v44, v228, v224, s65
v_perm_b32 v45, v236, v232, s65
v_perm_b32 v46, v244, v240, s65
v_perm_b32 v47, v252, v248, s65
v_perm_b32 v52, v229, v225, s64
v_perm_b32 v53, v237, v233, s64
v_perm_b32 v54, v245, v241, s64
v_perm_b32 v55, v253, v249, s64
v_perm_b32 v60, v229, v225, s65
v_perm_b32 v61, v237, v233, s65
v_perm_b32 v62, v245, v241, s65
v_perm_b32 v63, v253, v249, s65
v_perm_b32 v68, v230, v226, s64
v_perm_b32 v69, v238, v234, s64
v_perm_b32 v70, v246, v242, s64
v_perm_b32 v71, v254, v250, s64
v_perm_b32 v76, v230, v226, s65
v_perm_b32 v77, v238, v234, s65
v_perm_b32 v78, v246, v242, s65
v_perm_b32 v79, v254, v250, s65
v_perm_b32 v84, v231, v227, s64
v_perm_b32 v85, v239, v235, s64
v_perm_b32 v86, v247, v243, s64
v_perm_b32 v87, v255, v251, s64
v_perm_b32 v92, v231, v227, s65
v_perm_b32 v93, v239, v235, s65
v_perm_b32 v94, v247, v243, s65
v_perm_b32 v95, v255, v251, s65
s_waitcnt vmcnt(5)
global_load_dwordx4 v[116:119], v[12:13], off nt
v_lshl_add_u64 v[12:13], s[80:81], 0, v[12:13]
s_waitcnt vmcnt(5)
global_load_dwordx4 v[120:123], v[12:13], off nt
v_lshl_add_u64 v[12:13], s[80:81], 0, v[12:13]
s_waitcnt vmcnt(5)
global_load_dwordx4 v[124:127], v[12:13], off nt
v_lshl_add_u64 v[12:13], s[82:83], 0, v[12:13]
s_waitcnt vmcnt(0)
v_perm_b32 v192, v100, v96, s64
v_perm_b32 v193, v108, v104, s64
v_perm_b32 v194, v116, v112, s64
v_perm_b32 v195, v124, v120, s64
v_perm_b32 v200, v100, v96, s65
v_perm_b32 v201, v108, v104, s65
v_perm_b32 v202, v116, v112, s65
v_perm_b32 v203, v124, v120, s65
v_perm_b32 v208, v101, v97, s64
v_perm_b32 v209, v109, v105, s64
v_perm_b32 v210, v117, v113, s64
v_perm_b32 v211, v125, v121, s64
v_perm_b32 v216, v101, v97, s65
v_perm_b32 v217, v109, v105, s65
v_perm_b32 v218, v117, v113, s65
v_perm_b32 v219, v125, v121, s65
v_perm_b32 v224, v102, v98, s64
v_perm_b32 v225, v110, v106, s64
v_perm_b32 v226, v118, v114, s64
v_perm_b32 v227, v126, v122, s64
v_perm_b32 v232, v102, v98, s65
v_perm_b32 v233, v110, v106, s65
v_perm_b32 v234, v118, v114, s65
v_perm_b32 v235, v126, v122, s65
v_perm_b32 v240, v103, v99, s64
v_perm_b32 v241, v111, v107, s64
v_perm_b32 v242, v119, v115, s64
v_perm_b32 v243, v127, v123, s64
v_perm_b32 v248, v103, v99, s65
v_perm_b32 v249, v111, v107, s65
v_perm_b32 v250, v119, v115, s65
v_perm_b32 v251, v127, v123, s65
v_lshrrev_b32 v112, 5, v1
v_lshlrev_b32 v112, 11, v112
v_and_b32 v2, 15, v1
v_lshl_add_u32 v112, v2, 4, v112
v_bfe_u32 v2, v1, 4, 1
v_lshl_add_u32 v112, v2, 3, v112
v_lshrrev_b32 v113, 5, v1
v_lshlrev_b32 v113, 11, v113
v_and_b32 v2, 15, v1
v_lshl_add_u32 v113, v2, 5, v113
v_bfe_u32 v2, v1, 4, 1
v_lshl_add_u32 v113, v2, 4, v113
s_lshl_b32 s78, s3, 8
s_lshl_b32 s77, s3, 9
v_mov_b32 v104, 0
v_mov_b32 v105, 0
v_mov_b32 v106, 0
v_mov_b32 v107, 0
s_add_u32 s63, s78, 0
buffer_load_dwordx2 v[96:97], v112, s[24:27], s63 offen
s_add_u32 s63, s78, 4096
buffer_load_dwordx2 v[98:99], v112, s[24:27], s63 offen
s_cmp_ge_u32 s3, 4
s_cbranch_scc1 L_M_cbhi12
s_add_u32 s63, s78, 32768
buffer_load_dwordx2 v[104:105], v112, s[16:19], s63 offen sc1
s_add_u32 s63, s78, 36864
buffer_load_dwordx2 v[106:107], v112, s[16:19], s63 offen sc1
s_branch L_M_cbj13
L_M_cbhi12:
s_add_u32 s63, s77, 96256
buffer_load_dwordx4 v[160:163], v113, s[16:19], s63 offen sc1
s_add_u32 s63, s77, 100352
buffer_load_dwordx4 v[164:167], v113, s[16:19], s63 offen sc1
s_add_u32 s63, s77, 104448
buffer_load_dwordx4 v[168:171], v113, s[16:19], s63 offen sc1
s_add_u32 s63, s77, 108544
buffer_load_dwordx4 v[172:175], v113, s[16:19], s63 offen sc1
s_add_u32 s63, s77, 112640
buffer_load_dwordx4 v[176:179], v113, s[16:19], s63 offen sc1
s_add_u32 s63, s77, 116736
buffer_load_dwordx4 v[180:183], v113, s[16:19], s63 offen sc1
s_add_u32 s63, s77, 120832
buffer_load_dwordx4 v[184:187], v113, s[16:19], s63 offen sc1
s_add_u32 s63, s77, 124928
buffer_load_dwordx4 v[188:191], v113, s[16:19], s63 offen sc1
L_M_cbj13:
s_add_u32 s63, s78, 16384
buffer_load_dwordx2 v[100:101], v112, s[16:19], s63 offen sc1
s_add_u32 s63, s78, 20480
buffer_load_dwordx2 v[102:103], v112, s[16:19], s63 offen sc1
s_add_u32 s63, s78, 24576
buffer_load_dwordx2 v[108:109], v112, s[16:19], s63 offen sc1
s_add_u32 s63, s78, 28672
buffer_load_dwordx2 v[110:111], v112, s[16:19], s63 offen sc1
v_and_b32 v2, 1, v1
v_cmp_eq_u32 vcc, 1, v2
v_mov_b32 v2, 0x3f80
v_mov_b32 v3, 1.0
v_cndmask_b32 v2, v2, v3, vcc
v_lshrrev_b32 v3, 1, v1
v_xor_b32 v3, v3, v1
v_and_b32 v3, 8, v3
v_bfe_u32 v16, v1, 1, 2
v_or_b32 v3, v3, v16
v_bfe_u32 v16, v1, 5, 1
v_lshl_or_b32 v3, v16, 2, v3
v_cmp_eq_u32 vcc, 0, v3
s_nop 1
v_cndmask_b32 v16, 0, v2, vcc
v_cmp_eq_u32 vcc, 1, v3
s_nop 1
v_cndmask_b32 v17, 0, v2, vcc
v_cmp_eq_u32 vcc, 2, v3
s_nop 1
v_cndmask_b32 v18, 0, v2, vcc
v_cmp_eq_u32 vcc, 3, v3
s_nop 1
v_cndmask_b32 v19, 0, v2, vcc
v_cmp_eq_u32 vcc, 4, v3
s_nop 1
v_cndmask_b32 v20, 0, v2, vcc
v_cmp_eq_u32 vcc, 5, v3
s_nop 1
v_cndmask_b32 v21, 0, v2, vcc
v_cmp_eq_u32 vcc, 6, v3
s_nop 1
v_cndmask_b32 v22, 0, v2, vcc
v_cmp_eq_u32 vcc, 7, v3
s_nop 1
v_cndmask_b32 v23, 0, v2, vcc
v_lshrrev_b32 v11, 4, v1
v_lshlrev_b32 v11, 11, v11
v_and_b32 v2, 15, v1
v_lshl_add_u32 v11, v2, 4, v11
s_add_u32 s79, s78, 196608
s_lshl_b32 s60, s3, 10
s_add_u32 s60, s60, 40960
v_bfe_u32 v2, v1, 2, 2
v_lshlrev_b32 v2, 8, v2
v_and_b32 v5, 1, v1
v_lshl_add_u32 v2, v5, 7, v2
v_lshrrev_b32 v5, 4, v1
v_lshl_add_u32 v2, v5, 4, v2
v_add_u32 v2, s60, v2
v_mov_b32 v3, 49152
s_mov_b32 s66, 0x33333333
s_mov_b32 s67, 0x33333333
v_cndmask_b32 v5, v3, v2, s[66:67]
v_cndmask_b32 v6, v2, v3, s[66:67]
s_mov_b32 s66, 0x55555555
s_mov_b32 s67, 0x55555555
v_mov_b32 v2, 0xeeee
v_mov_b32 v3, 0x4444
v_cndmask_b32 v4, v2, v3, s[66:67]
s_lshl_b32 s60, s3, 11
s_add_u32 s60, s60, 60416
v_lshrrev_b32 v15, 4, v1
v_lshlrev_b32 v15, 9, v15
v_and_b32 v2, 15, v1
v_lshl_add_u32 v15, v2, 5, v15
v_add_u32 v15, s60, v15
s_lshr_b32 s60, s3, 1
s_lshl_b32 s60, s60, 9
s_and_b32 s61, s3, 1
s_lshl_b32 s62, s61, 7
s_add_u32 s62, s62, s60
s_add_u32 s62, s62, 60416
v_lshrrev_b32 v8, 5, v1
v_lshlrev_b32 v8, 8, v8
v_and_b32 v2, 31, v1
v_lshl_add_u32 v8, v2, 2, v8
v_add_u32 v8, s62, v8
s_lshr_b32 s60, s60, 2
s_lshl_b32 s61, s61, 5
s_add_u32 s60, s60, s61
s_add_u32 s60, s60, 50688
v_bfe_u32 v9, v1, 1, 1
v_lshlrev_b32 v9, 6, v9
v_bfe_u32 v2, v1, 2, 3
v_lshl_add_u32 v9, v2, 2, v9
v_and_b32 v2, 1, v1
v_lshl_add_u32 v9, v2, 1, v9
v_add_u32 v9, s60, v9
v_bfe_u32 v7, v1, 2, 2
v_lshlrev_b32 v7, 8, v7
v_lshrrev_b32 v2, 4, v1
v_lshl_add_u32 v7, v2, 6, v7
v_and_b32 v2, 3, v1
v_lshl_add_u32 v7, v2, 4, v7
s_lshl_b32 s60, s3, 4
s_add_u32 s60, s60, 51200
v_lshrrev_b32 v10, 5, v1
v_lshlrev_b32 v10, 7, v10
v_bfe_u32 v2, v1, 4, 1
v_lshl_add_u32 v10, v2, 3, v10
v_add_u32 v10, s60, v10
v_lshrrev_b32 v3, 5, v1
v_lshlrev_b32 v3, 7, v3
v_and_b32 v2, 15, v1
v_lshl_add_u32 v3, v2, 3, v3
v_add_u32 v3, 51200, v3
v_mov_b32 v24, 0
v_mov_b32 v25, 0
v_mov_b32 v26, 0
v_mov_b32 v27, 0
v_mov_b32 v28, 0
v_mov_b32 v29, 0
v_mov_b32 v30, 0
v_mov_b32 v31, 0
s_waitcnt vmcnt(0)
s_cmp_ge_u32 s3, 4
s_cbranch_scc1 L_M_mhi14
s_mov_b32 s71, 0
s_mov_b32 s70, 0
s_mov_b64 s[68:69], 0
s_branch L_M_pgchk17
L_M_pg16:
s_bitcmp1_b32 s71, 0
s_cbranch_scc1 L_M_pi18
s_add_u32 s63, s78, 16384
buffer_load_dwordx2 v[100:101], v112, s[16:19], s63 offen sc1
s_add_u32 s63, s78, 20480
buffer_load_dwordx2 v[102:103], v112, s[16:19], s63 offen sc1
L_M_pi18:
s_bitcmp1_b32 s71, 1
s_cbranch_scc1 L_M_pi19
s_add_u32 s63, s78, 32768
buffer_load_dwordx2 v[104:105], v112, s[16:19], s63 offen sc1
s_add_u32 s63, s78, 36864
buffer_load_dwordx2 v[106:107], v112, s[16:19], s63 offen sc1
L_M_pi19:
s_bitcmp1_b32 s71, 2
s_cbranch_scc1 L_M_pi20
s_add_u32 s63, s78, 24576
buffer_load_dwordx2 v[108:109], v112, s[16:19], s63 offen sc1
s_add_u32 s63, s78, 28672
buffer_load_dwordx2 v[110:111], v112, s[16:19], s63 offen sc1
L_M_pi20:
s_add_u32 s70, s70, 1
s_cmp_ge_u32 s70, 262144
s_cselect_b64 s[68:69], -1, 0
s_waitcnt vmcnt(0)
L_M_pgchk17:
s_bitcmp1_b32 s71, 0
s_cbranch_scc1 L_M_pc21
v_max_u32 v2, v100, v101
v_max3_u32 v2, v2, v102, v103
v_cmp_ne_u32 vcc, -1, v2
s_or_b64 vcc, vcc, s[68:69]
s_cmp_eq_u64 vcc, -1
s_cbranch_scc0 L_M_pc21
s_bitset1_b32 s71, 0
L_M_pc21:
s_bitcmp1_b32 s71, 1
s_cbranch_scc1 L_M_pc22
v_max_u32 v2, v104, v105
v_max3_u32 v2, v2, v106, v107
v_cmp_ne_u32 vcc, -1, v2
s_or_b64 vcc, vcc, s[68:69]
s_cmp_eq_u64 vcc, -1
s_cbranch_scc0 L_M_pc22
s_bitset1_b32 s71, 1
L_M_pc22:
s_bitcmp1_b32 s71, 2
s_cbranch_scc1 L_M_pc23
v_max_u32 v2, v108, v109
v_max3_u32 v2, v2, v110, v111
v_cmp_ne_u32 vcc, -1, v2
s_or_b64 vcc, vcc, s[68:69]
s_cmp_eq_u64 vcc, -1
s_cbranch_scc0 L_M_pc23
s_bitset1_b32 s71, 2
L_M_pc23:
s_cmp_lg_u32 s71, 0x7
s_cbranch_scc1 L_M_pg16
s_branch L_M_mjn15
L_M_mhi14:
s_mov_b32 s71, 0
s_mov_b32 s70, 0
s_mov_b64 s[68:69], 0
s_branch L_M_pgchk25
L_M_pg24:
s_bitcmp1_b32 s71, 0
s_cbranch_scc1 L_M_pi26
s_add_u32 s63, s78, 16384
buffer_load_dwordx2 v[100:101], v112, s[16:19], s63 offen sc1
s_add_u32 s63, s78, 20480
buffer_load_dwordx2 v[102:103], v112, s[16:19], s63 offen sc1
L_M_pi26:
s_bitcmp1_b32 s71, 1
s_cbranch_scc1 L_M_pi27
s_add_u32 s63, s78, 24576
buffer_load_dwordx2 v[108:109], v112, s[16:19], s63 offen sc1
s_add_u32 s63, s78, 28672
buffer_load_dwordx2 v[110:111], v112, s[16:19], s63 offen sc1
L_M_pi27:
s_bitcmp1_b32 s71, 2
s_cbranch_scc1 L_M_pi28
s_add_u32 s63, s77, 96256
buffer_load_dwordx4 v[160:163], v113, s[16:19], s63 offen sc1
s_add_u32 s63, s77, 100352
buffer_load_dwordx4 v[164:167], v113, s[16:19], s63 offen sc1
L_M_pi28:
s_bitcmp1_b32 s71, 3
s_cbranch_scc1 L_M_pi29
s_add_u32 s63, s77, 104448
buffer_load_dwordx4 v[168:171], v113, s[16:19], s63 offen sc1
s_add_u32 s63, s77, 108544
buffer_load_dwordx4 v[172:175], v113, s[16:19], s63 offen sc1
L_M_pi29:
s_bitcmp1_b32 s71, 4
s_cbranch_scc1 L_M_pi30
s_add_u32 s63, s77, 112640
buffer_load_dwordx4 v[176:179], v113, s[16:19], s63 offen sc1
s_add_u32 s63, s77, 116736
buffer_load_dwordx4 v[180:183], v113, s[16:19], s63 offen sc1
L_M_pi30:
s_bitcmp1_b32 s71, 5
s_cbranch_scc1 L_M_pi31
s_add_u32 s63, s77, 120832
buffer_load_dwordx4 v[184:187], v113, s[16:19], s63 offen sc1
s_add_u32 s63, s77, 124928
buffer_load_dwordx4 v[188:191], v113, s[16:19], s63 offen sc1
L_M_pi31:
s_add_u32 s70, s70, 1
s_cmp_ge_u32 s70, 262144
s_cselect_b64 s[68:69], -1, 0
s_waitcnt vmcnt(0)
L_M_pgchk25:
s_bitcmp1_b32 s71, 0
s_cbranch_scc1 L_M_pc32
v_max_u32 v2, v100, v101
v_max3_u32 v2, v2, v102, v103
v_cmp_ne_u32 vcc, -1, v2
s_or_b64 vcc, vcc, s[68:69]
s_cmp_eq_u64 vcc, -1
s_cbranch_scc0 L_M_pc32
s_bitset1_b32 s71, 0
L_M_pc32:
s_bitcmp1_b32 s71, 1
s_cbranch_scc1 L_M_pc33
v_max_u32 v2, v108, v109
v_max3_u32 v2, v2, v110, v111
v_cmp_ne_u32 vcc, -1, v2
s_or_b64 vcc, vcc, s[68:69]
s_cmp_eq_u64 vcc, -1
s_cbranch_scc0 L_M_pc33
s_bitset1_b32 s71, 1
L_M_pc33:
s_bitcmp1_b32 s71, 2
s_cbranch_scc1 L_M_pc34
v_max_u32 v2, v160, v161
v_max3_u32 v2, v2, v162, v163
v_max3_u32 v2, v2, v164, v165
v_max3_u32 v2, v2, v166, v167
v_cmp_ne_u32 vcc, -1, v2
s_or_b64 vcc, vcc, s[68:69]
s_cmp_eq_u64 vcc, -1
s_cbranch_scc0 L_M_pc34
s_bitset1_b32 s71, 2
L_M_pc34:
s_bitcmp1_b32 s71, 3
s_cbranch_scc1 L_M_pc35
v_max_u32 v2, v168, v169
v_max3_u32 v2, v2, v170, v171
v_max3_u32 v2, v2, v172, v173
v_max3_u32 v2, v2, v174, v175
v_cmp_ne_u32 vcc, -1, v2
s_or_b64 vcc, vcc, s[68:69]
s_cmp_eq_u64 vcc, -1
s_cbranch_scc0 L_M_pc35
s_bitset1_b32 s71, 3
L_M_pc35:
s_bitcmp1_b32 s71, 4
s_cbranch_scc1 L_M_pc36
v_max_u32 v2, v176, v177
v_max3_u32 v2, v2, v178, v179
v_max3_u32 v2, v2, v180, v181
v_max3_u32 v2, v2, v182, v183
v_cmp_ne_u32 vcc, -1, v2
s_or_b64 vcc, vcc, s[68:69]
s_cmp_eq_u64 vcc, -1
s_cbranch_scc0 L_M_pc36
s_bitset1_b32 s71, 4
L_M_pc36:
s_bitcmp1_b32 s71, 5
s_cbranch_scc1 L_M_pc37
v_max_u32 v2, v184, v185
v_max3_u32 v2, v2, v186, v187
v_max3_u32 v2, v2, v188, v189
v_max3_u32 v2, v2, v190, v191
v_cmp_ne_u32 vcc, -1, v2
s_or_b64 vcc, vcc, s[68:69]
s_cmp_eq_u64 vcc, -1
s_cbranch_scc0 L_M_pc37
s_bitset1_b32 s71, 5
L_M_pc37:
s_cmp_lg_u32 s71, 0x3f
s_cbranch_scc1 L_M_pg24
L_M_mjn15:
global_load_dwordx4 v[128:131], v[12:13], off nt
v_lshl_add_u64 v[12:13], s[80:81], 0, v[12:13]
global_load_dwordx4 v[132:135], v[12:13], off nt
v_lshl_add_u64 v[12:13], s[80:81], 0, v[12:13]
global_load_dwordx4 v[136:139], v[12:13], off nt
v_lshl_add_u64 v[12:13], s[80:81], 0, v[12:13]
global_load_dwordx4 v[140:143], v[12:13], off nt
v_lshl_add_u64 v[12:13], s[80:81], 0, v[12:13]
global_load_dwordx4 v[144:147], v[12:13], off nt
v_lshl_add_u64 v[12:13], s[80:81], 0, v[12:13]
global_load_dwordx4 v[148:151], v[12:13], off nt
v_lshl_add_u64 v[12:13], s[80:81], 0, v[12:13]
global_load_dwordx4 v[152:155], v[12:13], off nt
v_lshl_add_u64 v[12:13], s[80:81], 0, v[12:13]
global_load_dwordx4 v[156:159], v[12:13], off nt
v_lshl_add_u64 v[12:13], s[82:83], 0, v[12:13]
s_cmp_lt_u32 s3, 4
s_cbranch_scc1 L_M_cbs38
v_add_f32 v160, v160, v176
v_add_f32 v161, v161, v177
v_add_f32 v162, v162, v178
v_add_f32 v163, v163, v179
v_add_f32 v164, v164, v180
v_add_f32 v165, v165, v181
v_add_f32 v166, v166, v182
v_add_f32 v167, v167, v183
v_add_f32 v168, v168, v184
v_add_f32 v169, v169, v185
v_add_f32 v170, v170, v186
v_add_f32 v171, v171, v187
v_add_f32 v172, v172, v188
v_add_f32 v173, v173, v189
v_add_f32 v174, v174, v190
v_add_f32 v175, v175, v191
v_add_f32 v160, v160, v168
v_add_f32 v161, v161, v169
v_add_f32 v162, v162, v170
v_add_f32 v163, v163, v171
v_add_f32 v164, v164, v172
v_add_f32 v165, v165, v173
v_add_f32 v166, v166, v174
v_add_f32 v167, v167, v175
v_cvt_pk_bf16_f32 v104, v160, v161
v_cvt_pk_bf16_f32 v105, v162, v163
v_cvt_pk_bf16_f32 v106, v164, v165
v_cvt_pk_bf16_f32 v107, v166, v167
L_M_cbs38:
L_mtail:
v_lshlrev_b32 v2, 16, v104
v_and_b32 v114, 0xffff0000, v104
v_add_f32 v2, 1.0, v2
v_add_f32 v114, 1.0, v114
v_cvt_pk_bf16_f32 v104, v2, v114
v_lshlrev_b32 v2, 16, v105
v_and_b32 v114, 0xffff0000, v105
v_add_f32 v2, 1.0, v2
v_add_f32 v114, 1.0, v114
v_cvt_pk_bf16_f32 v105, v2, v114
v_lshlrev_b32 v2, 16, v106
v_and_b32 v114, 0xffff0000, v106
v_add_f32 v2, 1.0, v2
v_add_f32 v114, 1.0, v114
v_cvt_pk_bf16_f32 v106, v2, v114
v_lshlrev_b32 v2, 16, v107
v_and_b32 v114, 0xffff0000, v107
v_add_f32 v2, 1.0, v2
v_add_f32 v114, 1.0, v114
v_cvt_pk_bf16_f32 v107, v2, v114
v_lshlrev_b32 v160, 16, v96
v_and_b32 v161, 0xffff0000, v96
v_lshlrev_b32 v162, 16, v97
v_and_b32 v163, 0xffff0000, v97
v_lshlrev_b32 v164, 16, v98
v_and_b32 v165, 0xffff0000, v98
v_lshlrev_b32 v166, 16, v99
v_and_b32 v167, 0xffff0000, v99
v_lshlrev_b32 v176, 16, v100
v_and_b32 v177, 0xffff0000, v100
v_lshlrev_b32 v178, 16, v101
v_and_b32 v179, 0xffff0000, v101
v_lshlrev_b32 v180, 16, v102
v_and_b32 v181, 0xffff0000, v102
v_lshlrev_b32 v182, 16, v103
v_and_b32 v183, 0xffff0000, v103
v_lshlrev_b32 v168, 16, v104
v_and_b32 v169, 0xffff0000, v104
v_lshlrev_b32 v170, 16, v105
v_and_b32 v171, 0xffff0000, v105
v_lshlrev_b32 v172, 16, v106
v_and_b32 v173, 0xffff0000, v106
v_lshlrev_b32 v174, 16, v107
v_and_b32 v175, 0xffff0000, v107
v_lshlrev_b32 v184, 16, v108
v_and_b32 v185, 0xffff0000, v108
v_lshlrev_b32 v186, 16, v109
v_and_b32 v187, 0xffff0000, v109
v_lshlrev_b32 v188, 16, v110
v_and_b32 v189, 0xffff0000, v110
v_lshlrev_b32 v190, 16, v111
v_and_b32 v191, 0xffff0000, v111
s_add_u32 s63, s79, 0
buffer_load_dwordx4 v[96:99], v11, s[16:19], s63 offen sc1
s_add_u32 s63, s79, 8192
buffer_load_dwordx4 v[100:103], v11, s[16:19], s63 offen sc1
s_add_u32 s63, s79, 16384
buffer_load_dwordx4 v[104:107], v11, s[16:19], s63 offen sc1
s_add_u32 s63, s79, 24576
buffer_load_dwordx4 v[108:111], v11, s[16:19], s63 offen sc1
s_add_u32 s63, s79, 32768
buffer_load_dwordx4 v[112:115], v11, s[16:19], s63 offen sc1
s_add_u32 s63, s79, 40960
buffer_load_dwordx4 v[116:119], v11, s[16:19], s63 offen sc1
s_add_u32 s63, s79, 49152
buffer_load_dwordx4 v[120:123], v11, s[16:19], s63 offen sc1
s_add_u32 s63, s79, 57344
buffer_load_dwordx4 v[124:127], v11, s[16:19], s63 offen sc1
s_lshl_b32 s60, s3, 10
s_add_u32 s60, s60, 40960
v_lshrrev_b32 v13, 5, v1
v_lshlrev_b32 v13, 8, v13
v_and_b32 v2, 15, v1
v_lshl_add_u32 v13, v2, 3, v13
v_bfe_u32 v2, v1, 4, 1
v_lshl_add_u32 v13, v2, 2, v13
v_add_u32 v13, s60, v13
s_add_u32 s60, s78, 52224
v_lshrrev_b32 v12, 5, v1
v_lshlrev_b32 v12, 11, v12
v_and_b32 v2, 15, v1
v_lshl_add_u32 v12, v2, 4, v12
v_bfe_u32 v2, v1, 4, 1
v_lshl_add_u32 v12, v2, 3, v12
v_add_u32 v12, s60, v12
s_waitcnt vmcnt(8)
v_perm_b32 v196, v132, v128, s64
v_perm_b32 v197, v140, v136, s64
v_perm_b32 v198, v148, v144, s64
v_perm_b32 v199, v156, v152, s64
v_perm_b32 v204, v132, v128, s65
v_perm_b32 v205, v140, v136, s65
v_perm_b32 v206, v148, v144, s65
v_perm_b32 v207, v156, v152, s65
v_perm_b32 v212, v133, v129, s64
v_perm_b32 v213, v141, v137, s64
v_perm_b32 v214, v149, v145, s64
v_perm_b32 v215, v157, v153, s64
v_perm_b32 v220, v133, v129, s65
v_perm_b32 v221, v141, v137, s65
v_perm_b32 v222, v149, v145, s65
v_perm_b32 v223, v157, v153, s65
v_perm_b32 v228, v134, v130, s64
v_perm_b32 v229, v142, v138, s64
v_perm_b32 v230, v150, v146, s64
v_perm_b32 v231, v158, v154, s64
v_perm_b32 v236, v134, v130, s65
v_perm_b32 v237, v142, v138, s65
v_perm_b32 v238, v150, v146, s65
v_perm_b32 v239, v158, v154, s65
v_perm_b32 v244, v135, v131, s64
v_perm_b32 v245, v143, v139, s64
v_perm_b32 v246, v151, v147, s64
v_perm_b32 v247, v159, v155, s64
v_perm_b32 v252, v135, v131, s65
v_perm_b32 v253, v143, v139, s65
v_perm_b32 v254, v151, v147, s65
v_perm_b32 v255, v159, v155, s65
s_add_u32 s63, s74, 0
buffer_load_dwordx4 v[128:131], v14, s[20:23], s63 offen offset:0 nt
s_add_u32 s63, s74, 0
buffer_load_dwordx4 v[132:135], v14, s[20:23], s63 offen offset:2048 nt
s_add_u32 s63, s74, 4096
buffer_load_dwordx4 v[136:139], v14, s[20:23], s63 offen offset:0 nt
s_add_u32 s63, s74, 4096
buffer_load_dwordx4 v[140:143], v14, s[20:23], s63 offen offset:2048 nt
s_waitcnt vmcnt(4)
s_mov_b32 s71, 0
s_mov_b32 s70, 0
s_mov_b64 s[68:69], 0
s_branch L_M_prchk41
L_M_pr39:
s_bitcmp1_b32 s71, 0
s_cbranch_scc1 L_M_pi42
s_add_u32 s63, s79, 0
buffer_load_dwordx4 v[96:99], v11, s[16:19], s63 offen sc1
L_M_pi42:
s_bitcmp1_b32 s71, 1
s_cbranch_scc1 L_M_pi43
s_add_u32 s63, s79, 8192
buffer_load_dwordx4 v[100:103], v11, s[16:19], s63 offen sc1
L_M_pi43:
s_bitcmp1_b32 s71, 2
s_cbranch_scc1 L_M_pi44
s_add_u32 s63, s79, 16384
buffer_load_dwordx4 v[104:107], v11, s[16:19], s63 offen sc1
L_M_pi44:
s_bitcmp1_b32 s71, 3
s_cbranch_scc1 L_M_pi45
s_add_u32 s63, s79, 24576
buffer_load_dwordx4 v[108:111], v11, s[16:19], s63 offen sc1
L_M_pi45:
s_bitcmp1_b32 s71, 4
s_cbranch_scc1 L_M_pi46
s_add_u32 s63, s79, 32768
buffer_load_dwordx4 v[112:115], v11, s[16:19], s63 offen sc1
L_M_pi46:
s_bitcmp1_b32 s71, 5
s_cbranch_scc1 L_M_pi47
s_add_u32 s63, s79, 40960
buffer_load_dwordx4 v[116:119], v11, s[16:19], s63 offen sc1
L_M_pi47:
s_bitcmp1_b32 s71, 6
s_cbranch_scc1 L_M_pi48
s_add_u32 s63, s79, 49152
buffer_load_dwordx4 v[120:123], v11, s[16:19], s63 offen sc1
L_M_pi48:
s_bitcmp1_b32 s71, 7
s_cbranch_scc1 L_M_pi49
s_add_u32 s63, s79, 57344
buffer_load_dwordx4 v[124:127], v11, s[16:19], s63 offen sc1
L_M_pi49:
s_add_u32 s70, s70, 1
s_cmp_ge_u32 s70, 262144
s_cselect_b64 s[68:69], -1, 0
s_waitcnt vmcnt(0)
L_M_prchk41:
s_bitcmp1_b32 s71, 0
s_cbranch_scc1 L_M_pc50
v_max_u32 v2, v96, v97
v_max3_u32 v2, v2, v98, v99
v_cmp_ne_u32 vcc, -1, v2
s_or_b64 vcc, vcc, s[68:69]
s_cmp_eq_u64 vcc, -1
s_cbranch_scc0 L_M_pc50
v_mfma_f32_16x16x32_bf16 v[24:27], v[16:19], v[96:99], v[24:27]
v_mfma_f32_16x16x32_bf16 v[28:31], v[20:23], v[96:99], v[28:31]
s_bitset1_b32 s71, 0
L_M_pc50:
s_bitcmp1_b32 s71, 1
s_cbranch_scc1 L_M_pc51
v_max_u32 v2, v100, v101
v_max3_u32 v2, v2, v102, v103
v_cmp_ne_u32 vcc, -1, v2
s_or_b64 vcc, vcc, s[68:69]
s_cmp_eq_u64 vcc, -1
s_cbranch_scc0 L_M_pc51
v_mfma_f32_16x16x32_bf16 v[24:27], v[16:19], v[100:103], v[24:27]
v_mfma_f32_16x16x32_bf16 v[28:31], v[20:23], v[100:103], v[28:31]
s_bitset1_b32 s71, 1
L_M_pc51:
s_bitcmp1_b32 s71, 2
s_cbranch_scc1 L_M_pc52
v_max_u32 v2, v104, v105
v_max3_u32 v2, v2, v106, v107
v_cmp_ne_u32 vcc, -1, v2
s_or_b64 vcc, vcc, s[68:69]
s_cmp_eq_u64 vcc, -1
s_cbranch_scc0 L_M_pc52
v_mfma_f32_16x16x32_bf16 v[24:27], v[16:19], v[104:107], v[24:27]
v_mfma_f32_16x16x32_bf16 v[28:31], v[20:23], v[104:107], v[28:31]
s_bitset1_b32 s71, 2
L_M_pc52:
s_bitcmp1_b32 s71, 3
s_cbranch_scc1 L_M_pc53
v_max_u32 v2, v108, v109
v_max3_u32 v2, v2, v110, v111
v_cmp_ne_u32 vcc, -1, v2
s_or_b64 vcc, vcc, s[68:69]
s_cmp_eq_u64 vcc, -1
s_cbranch_scc0 L_M_pc53
v_mfma_f32_16x16x32_bf16 v[24:27], v[16:19], v[108:111], v[24:27]
v_mfma_f32_16x16x32_bf16 v[28:31], v[20:23], v[108:111], v[28:31]
s_bitset1_b32 s71, 3
L_M_pc53:
s_bitcmp1_b32 s71, 4
s_cbranch_scc1 L_M_pc54
v_max_u32 v2, v112, v113
v_max3_u32 v2, v2, v114, v115
v_cmp_ne_u32 vcc, -1, v2
s_or_b64 vcc, vcc, s[68:69]
s_cmp_eq_u64 vcc, -1
s_cbranch_scc0 L_M_pc54
v_mfma_f32_16x16x32_bf16 v[24:27], v[16:19], v[112:115], v[24:27]
v_mfma_f32_16x16x32_bf16 v[28:31], v[20:23], v[112:115], v[28:31]
s_bitset1_b32 s71, 4
L_M_pc54:
s_bitcmp1_b32 s71, 5
s_cbranch_scc1 L_M_pc55
v_max_u32 v2, v116, v117
v_max3_u32 v2, v2, v118, v119
v_cmp_ne_u32 vcc, -1, v2
s_or_b64 vcc, vcc, s[68:69]
s_cmp_eq_u64 vcc, -1
s_cbranch_scc0 L_M_pc55
v_mfma_f32_16x16x32_bf16 v[24:27], v[16:19], v[116:119], v[24:27]
v_mfma_f32_16x16x32_bf16 v[28:31], v[20:23], v[116:119], v[28:31]
s_bitset1_b32 s71, 5
L_M_pc55:
s_bitcmp1_b32 s71, 6
s_cbranch_scc1 L_M_pc56
v_max_u32 v2, v120, v121
v_max3_u32 v2, v2, v122, v123
v_cmp_ne_u32 vcc, -1, v2
s_or_b64 vcc, vcc, s[68:69]
s_cmp_eq_u64 vcc, -1
s_cbranch_scc0 L_M_pc56
v_mfma_f32_16x16x32_bf16 v[24:27], v[16:19], v[120:123], v[24:27]
v_mfma_f32_16x16x32_bf16 v[28:31], v[20:23], v[120:123], v[28:31]
s_bitset1_b32 s71, 6
L_M_pc56:
s_bitcmp1_b32 s71, 7
s_cbranch_scc1 L_M_pc57
v_max_u32 v2, v124, v125
v_max3_u32 v2, v2, v126, v127
v_cmp_ne_u32 vcc, -1, v2
s_or_b64 vcc, vcc, s[68:69]
s_cmp_eq_u64 vcc, -1
s_cbranch_scc0 L_M_pc57
v_mfma_f32_16x16x32_bf16 v[24:27], v[16:19], v[124:127], v[24:27]
v_mfma_f32_16x16x32_bf16 v[28:31], v[20:23], v[124:127], v[28:31]
s_bitset1_b32 s71, 7
L_M_pc57:
s_cmp_lg_u32 s71, 0xff
s_cbranch_scc1 L_M_pr39
L_M_prdone40:
s_add_u32 s63, s74, 8192
buffer_load_dwordx4 v[144:147], v14, s[20:23], s63 offen offset:0 nt
s_add_u32 s63, s74, 8192
buffer_load_dwordx4 v[148:151], v14, s[20:23], s63 offen offset:2048 nt
s_add_u32 s63, s74, 12288
buffer_load_dwordx4 v[152:155], v14, s[20:23], s63 offen offset:0 nt
s_add_u32 s63, s74, 12288
buffer_load_dwordx4 v[156:159], v14, s[20:23], s63 offen offset:2048 nt
v_pk_fma_f32 v[160:161], v[24:25], v[176:177], v[160:161]
v_pk_fma_f32 v[162:163], v[26:27], v[178:179], v[162:163]
v_pk_fma_f32 v[164:165], v[28:29], v[180:181], v[164:165]
v_pk_fma_f32 v[166:167], v[30:31], v[182:183], v[166:167]
v_cvt_pk_bf16_f32 v176, v160, v161
v_cvt_pk_bf16_f32 v177, v162, v163
v_cvt_pk_bf16_f32 v178, v164, v165
v_cvt_pk_bf16_f32 v179, v166, v167
v_lshlrev_b32 v24, 16, v176
v_and_b32 v25, 0xffff0000, v176
v_lshlrev_b32 v26, 16, v177
v_and_b32 v27, 0xffff0000, v177
v_lshlrev_b32 v28, 16, v178
v_and_b32 v29, 0xffff0000, v178
v_lshlrev_b32 v30, 16, v179
v_and_b32 v31, 0xffff0000, v179
v_pk_mul_f32 v[164:165], v[24:25], v[24:25]
v_pk_mul_f32 v[166:167], v[28:29], v[28:29]
v_pk_add_f32 v[160:161], v[24:25], v[26:27]
v_pk_add_f32 v[162:163], v[28:29], v[30:31]
v_pk_fma_f32 v[164:165], v[26:27], v[26:27], v[164:165]
v_pk_fma_f32 v[166:167], v[30:31], v[30:31], v[166:167]
v_add_f32 v160, v160, v161
v_add_f32 v162, v162, v163
v_add_f32 v161, v164, v165
v_add_f32 v163, v166, v167
v_add_f32_dpp v160, v160, v160 row_ror:8 row_mask:0xf bank_mask:0xf
v_add_f32_dpp v162, v162, v162 row_ror:8 row_mask:0xf bank_mask:0xf
v_add_f32_dpp v161, v161, v161 row_ror:8 row_mask:0xf bank_mask:0xf
v_add_f32_dpp v163, v163, v163 row_ror:8 row_mask:0xf bank_mask:0xf
v_add_f32_dpp v160, v160, v160 row_ror:4 row_mask:0xf bank_mask:0xf
v_add_f32_dpp v162, v162, v162 row_ror:4 row_mask:0xf bank_mask:0xf
v_add_f32_dpp v161, v161, v161 row_ror:4 row_mask:0xf bank_mask:0xf
v_add_f32_dpp v163, v163, v163 row_ror:4 row_mask:0xf bank_mask:0xf
v_add_f32_dpp v160, v160, v160 row_ror:2 row_mask:0xf bank_mask:0xf
v_add_f32_dpp v162, v162, v162 row_ror:2 row_mask:0xf bank_mask:0xf
v_add_f32_dpp v161, v161, v161 row_ror:2 row_mask:0xf bank_mask:0xf
v_add_f32_dpp v163, v163, v163 row_ror:2 row_mask:0xf bank_mask:0xf
v_add_f32_dpp v160, v160, v160 row_ror:1 row_mask:0xf bank_mask:0xf
v_add_f32_dpp v162, v162, v162 row_ror:1 row_mask:0xf bank_mask:0xf
v_add_f32_dpp v161, v161, v161 row_ror:1 row_mask:0xf bank_mask:0xf
v_add_f32_dpp v163, v163, v163 row_ror:1 row_mask:0xf bank_mask:0xf
s_mov_b32 exec_lo, 0x10001
s_mov_b32 exec_hi, 0x10001
ds_write_b64 v10, v[160:161]
ds_write_b64 v10, v[162:163] offset:256
s_mov_b64 exec, -1
ds_write_b64 v12, v[176:177]
ds_write_b64 v12, v[178:179] offset:4096
v_pk_mul_f32 v[24:25], v[24:25], v[168:169]
v_pk_mul_f32 v[26:27], v[26:27], v[170:171]
v_pk_mul_f32 v[28:29], v[28:29], v[172:173]
v_pk_mul_f32 v[30:31], v[30:31], v[174:175]
s_mov_b32 s60, 0x3a800000
s_mov_b32 s61, 0x3a800000
s_waitcnt lgkmcnt(2)
s_barrier
ds_read_b64 v[160:161], v3
ds_read_b64 v[162:163], v3 offset:256
s_add_u32 s63, s74, 65536
buffer_load_dwordx4 v[96:99], v14, s[20:23], s63 offen offset:0 nt
s_add_u32 s63, s74, 65536
buffer_load_dwordx4 v[100:103], v14, s[20:23], s63 offen offset:2048 nt
s_add_u32 s63, s74, 69632
buffer_load_dwordx4 v[104:107], v14, s[20:23], s63 offen offset:0 nt
s_add_u32 s63, s74, 69632
buffer_load_dwordx4 v[108:111], v14, s[20:23], s63 offen offset:2048 nt
s_waitcnt lgkmcnt(0)
v_add_f32_dpp v160, v160, v160 row_ror:8 row_mask:0xf bank_mask:0xf
v_add_f32_dpp v162, v162, v162 row_ror:8 row_mask:0xf bank_mask:0xf
v_add_f32_dpp v161, v161, v161 row_ror:8 row_mask:0xf bank_mask:0xf
v_add_f32_dpp v163, v163, v163 row_ror:8 row_mask:0xf bank_mask:0xf
v_add_f32_dpp v160, v160, v160 row_ror:4 row_mask:0xf bank_mask:0xf
v_add_f32_dpp v162, v162, v162 row_ror:4 row_mask:0xf bank_mask:0xf
v_add_f32_dpp v161, v161, v161 row_ror:4 row_mask:0xf bank_mask:0xf
v_add_f32_dpp v163, v163, v163 row_ror:4 row_mask:0xf bank_mask:0xf
v_add_f32_dpp v160, v160, v160 row_ror:2 row_mask:0xf bank_mask:0xf
v_add_f32_dpp v162, v162, v162 row_ror:2 row_mask:0xf bank_mask:0xf
v_add_f32_dpp v161, v161, v161 row_ror:2 row_mask:0xf bank_mask:0xf
v_add_f32_dpp v163, v163, v163 row_ror:2 row_mask:0xf bank_mask:0xf
v_add_f32_dpp v160, v160, v160 row_ror:1 row_mask:0xf bank_mask:0xf
v_add_f32_dpp v162, v162, v162 row_ror:1 row_mask:0xf bank_mask:0xf
v_add_f32_dpp v161, v161, v161 row_ror:1 row_mask:0xf bank_mask:0xf
v_add_f32_dpp v163, v163, v163 row_ror:1 row_mask:0xf bank_mask:0xf
v_pk_mul_f32 v[160:161], v[160:161], s[60:61]
v_pk_mul_f32 v[162:163], v[162:163], s[60:61]
v_fma_f32 v161, -v160, v160, v161
v_fma_f32 v163, -v162, v162, v163
v_max_f32 v161, 0, v161
v_max_f32 v163, 0, v163
v_add_f32 v161, 0x3727c5ac, v161
v_add_f32 v163, 0x3727c5ac, v163
v_rsq_f32 v161, v161
v_rsq_f32 v163, v163
v_pk_fma_f32 v[24:25], v[168:169], v[160:161], v[24:25] op_sel:[0,0,0] op_sel_hi:[1,0,1] neg_lo:[0,1,0] neg_hi:[0,1,0]
v_pk_fma_f32 v[26:27], v[170:171], v[160:161], v[26:27] op_sel:[0,0,0] op_sel_hi:[1,0,1] neg_lo:[0,1,0] neg_hi:[0,1,0]
v_pk_fma_f32 v[28:29], v[172:173], v[162:163], v[28:29] op_sel:[0,0,0] op_sel_hi:[1,0,1] neg_lo:[0,1,0] neg_hi:[0,1,0]
v_pk_fma_f32 v[30:31], v[174:175], v[162:163], v[30:31] op_sel:[0,0,0] op_sel_hi:[1,0,1] neg_lo:[0,1,0] neg_hi:[0,1,0]
v_pk_fma_f32 v[184:185], v[24:25], v[160:161], v[184:185] op_sel:[0,1,0] op_sel_hi:[1,1,1]
v_pk_fma_f32 v[186:187], v[26:27], v[160:161], v[186:187] op_sel:[0,1,0] op_sel_hi:[1,1,1]
v_pk_fma_f32 v[188:189], v[28:29], v[162:163], v[188:189] op_sel:[0,1,0] op_sel_hi:[1,1,1]
v_pk_fma_f32 v[190:191], v[30:31], v[162:163], v[190:191] op_sel:[0,1,0] op_sel_hi:[1,1,1]
v_cvt_pk_bf16_f32 v160, v184, v185
v_cvt_pk_bf16_f32 v161, v186, v187
v_cvt_pk_bf16_f32 v162, v188, v189
v_cvt_pk_bf16_f32 v163, v190, v191
ds_write2_b32 v13, v160, v161 offset0:0 offset1:32
ds_write2_b32 v13, v162, v163 offset0:128 offset1:160
ds_read_b128 v[160:163], v5 offset:0
ds_read_b128 v[164:167], v6 offset:0
ds_read_b128 v[168:171], v5 offset:64
ds_read_b128 v[172:175], v6 offset:64
v_mov_b32 v176, 0
v_mov_b32 v177, 0
v_mov_b32 v178, 0
v_mov_b32 v179, 0
v_mov_b32 v180, 0
v_mov_b32 v181, 0
v_mov_b32 v182, 0
v_mov_b32 v183, 0
v_mov_b32 v184, 0
v_mov_b32 v185, 0
v_mov_b32 v186, 0
v_mov_b32 v187, 0
v_mov_b32 v188, 0
v_mov_b32 v189, 0
v_mov_b32 v190, 0
v_mov_b32 v191, 0
s_waitcnt lgkmcnt(2)
v_smfmac_f32_16x16x64_bf16 v[176:179], v[160:163], v[32:39], v4
v_bfe_u32 v10, v1, 2, 2
v_lshlrev_b32 v10, 11, v10
v_and_b32 v3, 3, v1
v_smfmac_f32_16x16x64_bf16 v[180:183], v[160:163], v[40:47], v4
v_lshl_add_u32 v10, v3, 4, v10
v_bfe_u32 v3, v1, 4, 1
v_lshl_add_u32 v10, v3, 3, v10
v_smfmac_f32_16x16x64_bf16 v[184:187], v[160:163], v[48:55], v4
s_lshl_b32 s78, s72, 6
s_add_u32 s62, s78, 40960
v_bfe_u32 v2, v1, 2, 2
v_smfmac_f32_16x16x64_bf16 v[188:191], v[160:163], v[56:63], v4
v_lshlrev_b32 v2, 7, v2
v_and_b32 v5, 1, v1
v_lshl_add_u32 v2, v5, 6, v2
v_smfmac_f32_16x16x64_bf16 v[176:179], v[164:167], v[64:71], v4
v_lshrrev_b32 v5, 4, v1
v_lshl_add_u32 v2, v5, 4, v2
v_add_u32 v2, 50688, v2
v_smfmac_f32_16x16x64_bf16 v[180:183], v[164:167], v[72:79], v4
v_mov_b32 v3, 49152
s_mov_b32 s66, 0x33333333
s_mov_b32 s67, 0x33333333
v_smfmac_f32_16x16x64_bf16 v[184:187], v[164:167], v[80:87], v4
v_cndmask_b32 v5, v3, v2, s[66:67]
v_cndmask_b32 v6, v2, v3, s[66:67]
v_smfmac_f32_16x16x64_bf16 v[188:191], v[164:167], v[88:95], v4
s_add_u32 s63, s74, 73728
buffer_load_dwordx4 v[112:115], v14, s[20:23], s63 offen offset:0 nt
s_add_u32 s63, s74, 73728
buffer_load_dwordx4 v[116:119], v14, s[20:23], s63 offen offset:2048 nt
s_add_u32 s63, s74, 77824
buffer_load_dwordx4 v[120:123], v14, s[20:23], s63 offen offset:0 nt
s_add_u32 s63, s74, 77824
buffer_load_dwordx4 v[124:127], v14, s[20:23], s63 offen offset:2048 nt
s_waitcnt lgkmcnt(0)
s_waitcnt vmcnt(8)
v_smfmac_f32_16x16x64_bf16 v[176:179], v[168:171], v[192:199], v4
v_perm_b32 v32, v132, v128, s64
v_perm_b32 v33, v140, v136, s64
v_perm_b32 v34, v148, v144, s64
v_perm_b32 v35, v156, v152, s64
v_smfmac_f32_16x16x64_bf16 v[180:183], v[168:171], v[200:207], v4
v_perm_b32 v40, v132, v128, s65
v_perm_b32 v41, v140, v136, s65
v_perm_b32 v42, v148, v144, s65
v_perm_b32 v43, v156, v152, s65
v_smfmac_f32_16x16x64_bf16 v[184:187], v[168:171], v[208:215], v4
v_perm_b32 v48, v133, v129, s64
v_perm_b32 v49, v141, v137, s64
v_perm_b32 v50, v149, v145, s64
v_perm_b32 v51, v157, v153, s64
v_smfmac_f32_16x16x64_bf16 v[188:191], v[168:171], v[216:223], v4
v_perm_b32 v56, v133, v129, s65
v_perm_b32 v57, v141, v137, s65
v_perm_b32 v58, v149, v145, s65
v_perm_b32 v59, v157, v153, s65
v_smfmac_f32_16x16x64_bf16 v[176:179], v[172:175], v[224:231], v4
v_perm_b32 v64, v134, v130, s64
v_perm_b32 v65, v142, v138, s64
v_perm_b32 v66, v150, v146, s64
v_perm_b32 v67, v158, v154, s64
v_smfmac_f32_16x16x64_bf16 v[180:183], v[172:175], v[232:239], v4
v_perm_b32 v72, v134, v130, s65
v_perm_b32 v73, v142, v138, s65
v_perm_b32 v74, v150, v146, s65
v_perm_b32 v75, v158, v154, s65
v_smfmac_f32_16x16x64_bf16 v[184:187], v[172:175], v[240:247], v4
v_perm_b32 v80, v135, v131, s64
v_perm_b32 v81, v143, v139, s64
v_perm_b32 v82, v151, v147, s64
v_perm_b32 v83, v159, v155, s64
v_smfmac_f32_16x16x64_bf16 v[188:191], v[172:175], v[248:255], v4
v_perm_b32 v88, v135, v131, s65
v_perm_b32 v89, v143, v139, s65
v_perm_b32 v90, v151, v147, s65
v_perm_b32 v91, v159, v155, s65
v_add_f32 v24, v176, v177
v_add_f32 v25, v180, v181
v_add_f32 v26, v184, v185
s_nop 0
v_add_f32 v27, v188, v189
v_add_f32 v28, v178, v179
v_add_f32 v29, v182, v183
v_add_f32 v30, v186, v187
v_add_f32 v31, v190, v191
ds_write_b128 v15, v[24:27]
ds_write_b128 v15, v[28:31] offset:16
v_mov_b32 v176, 0
v_mov_b32 v177, 0
v_mov_b32 v178, 0
v_mov_b32 v179, 0
v_mov_b32 v180, 0
v_mov_b32 v181, 0
v_mov_b32 v182, 0
v_mov_b32 v183, 0
v_mov_b32 v184, 0
v_mov_b32 v185, 0
v_mov_b32 v186, 0
v_mov_b32 v187, 0
v_mov_b32 v188, 0
v_mov_b32 v189, 0
v_mov_b32 v190, 0
v_mov_b32 v191, 0
s_waitcnt lgkmcnt(0)
s_barrier
ds_read2st64_b32 v[224:225], v8 offset0:0 offset1:8
ds_read2st64_b32 v[226:227], v8 offset0:16 offset1:24
ds_read2st64_b32 v[228:229], v8 offset0:32 offset1:40
ds_read2st64_b32 v[230:231], v8 offset0:48 offset1:56
s_waitcnt vmcnt(0)
v_perm_b32 v36, v100, v96, s64
v_perm_b32 v37, v108, v104, s64
v_perm_b32 v38, v116, v112, s64
v_perm_b32 v39, v124, v120, s64
v_perm_b32 v44, v100, v96, s65
v_perm_b32 v45, v108, v104, s65
v_perm_b32 v46, v116, v112, s65
v_perm_b32 v47, v124, v120, s65
v_perm_b32 v52, v101, v97, s64
v_perm_b32 v53, v109, v105, s64
v_perm_b32 v54, v117, v113, s64
v_perm_b32 v55, v125, v121, s64
v_perm_b32 v60, v101, v97, s65
v_perm_b32 v61, v109, v105, s65
v_perm_b32 v62, v117, v113, s65
v_perm_b32 v63, v125, v121, s65
v_perm_b32 v68, v102, v98, s64
v_perm_b32 v69, v110, v106, s64
v_perm_b32 v70, v118, v114, s64
v_perm_b32 v71, v126, v122, s64
s_waitcnt lgkmcnt(0)
v_pk_add_f32 v[224:225], v[224:225], v[228:229]
v_pk_add_f32 v[226:227], v[226:227], v[230:231]
v_pk_add_f32 v[224:225], v[224:225], v[226:227]
v_add_f32 v224, v224, v225
v_cvt_pk_bf16_f32 v224, v224, v224
v_and_b32 v224, 0xffff0000, v224
v_mov_b32 v225, v224
v_perm_b32 v76, v102, v98, s65
v_perm_b32 v77, v110, v106, s65
v_permlane32_swap_b32 v224, v225
v_mul_f32 v226, 0xbfb8aa3b, v224
v_exp_f32 v226, v226
v_perm_b32 v78, v118, v114, s65
v_add_f32 v226, 1.0, v226
v_rcp_f32 v226, v226
v_perm_b32 v79, v126, v122, s65
v_mul_f32 v224, v224, v226
v_mul_f32 v224, v224, v225
v_cvt_pk_bf16_f32 v224, v224, v224
s_mov_b32 exec_lo, 0xffffffff
s_mov_b32 exec_hi, 0x0
ds_write_b16 v9, v224
s_mov_b64 exec, -1
v_perm_b32 v84, v103, v99, s64
v_perm_b32 v85, v111, v107, s64
v_perm_b32 v86, v119, v115, s64
v_perm_b32 v87, v127, v123, s64
v_perm_b32 v92, v103, v99, s65
v_perm_b32 v93, v111, v107, s65
v_perm_b32 v94, v119, v115, s65
v_perm_b32 v95, v127, v123, s65
s_cmp_lg_u32 s3, 0
s_cbranch_scc1 L_M_gb58
s_cmp_ge_u32 s72, 32
s_cbranch_scc1 L_M_gb58
buffer_load_dwordx2 v[232:233], v10, s[16:19], s62 offen sc1
L_M_gb58:
s_waitcnt lgkmcnt(0)
s_barrier
ds_read_b128 v[160:163], v5
ds_read_b128 v[164:167], v6
s_waitcnt lgkmcnt(0)
v_smfmac_f32_16x16x64_bf16 v[176:179], v[160:163], v[32:39], v4
v_smfmac_f32_16x16x64_bf16 v[180:183], v[160:163], v[40:47], v4
v_smfmac_f32_16x16x64_bf16 v[184:187], v[160:163], v[48:55], v4
v_smfmac_f32_16x16x64_bf16 v[188:191], v[160:163], v[56:63], v4
v_smfmac_f32_16x16x64_bf16 v[176:179], v[164:167], v[64:71], v4
v_smfmac_f32_16x16x64_bf16 v[180:183], v[164:167], v[72:79], v4
v_smfmac_f32_16x16x64_bf16 v[184:187], v[164:167], v[80:87], v4
v_smfmac_f32_16x16x64_bf16 v[188:191], v[164:167], v[88:95], v4
s_nop 4
v_add_f32 v24, v176, v177
v_add_f32 v25, v180, v181
v_add_f32 v26, v184, v185
v_add_f32 v27, v188, v189
v_add_f32 v28, v178, v179
v_add_f32 v29, v182, v183
v_add_f32 v30, v186, v187
v_add_f32 v31, v190, v191
v_cvt_pk_bf16_f32 v224, v24, v25
v_cvt_pk_bf16_f32 v225, v26, v27
v_cvt_pk_bf16_f32 v226, v28, v29
v_cvt_pk_bf16_f32 v227, v30, v31
buffer_store_dwordx4 v[224:227], v7, s[16:19], s73 offen sc1
s_cmp_ge_u32 s72, 32
s_cbranch_scc1 L_M_mend59
v_lshrrev_b32 v11, 4, v1
v_lshlrev_b32 v11, 13, v11
v_and_b32 v3, 15, v1
v_lshl_add_u32 v11, v3, 4, v11
s_lshl_b32 s79, s72, 8
s_add_u32 s79, s79, 786432
v_mov_b32 v24, 0
v_mov_b32 v25, 0
v_mov_b32 v26, 0
v_mov_b32 v27, 0
s_cmp_eq_u32 s3, 0
s_cbranch_scc1 L_M_w060
s_lshl_b32 s60, s3, 16
s_add_u32 s79, s79, s60
s_sub_u32 s79, s79, 65536
s_lshl_b32 s60, s3, 10
v_add_u32 v4, s60, v0
s_add_u32 s63, s79, 0
buffer_load_dwordx4 v[64:67], v11, s[16:19], s63 offen sc1
s_add_u32 s63, s79, 32768
buffer_load_dwordx4 v[68:71], v11, s[16:19], s63 offen sc1
v_and_b32 v2, 1, v1
v_cmp_eq_u32 vcc, 1, v2
v_mov_b32 v2, 0x3f80
v_mov_b32 v3, 1.0
v_cndmask_b32 v2, v2, v3, vcc
v_bfe_u32 v3, v1, 1, 3
v_cmp_eq_u32 vcc, 0, v3
s_nop 1
v_cndmask_b32 v16, 0, v2, vcc
v_cmp_eq_u32 vcc, 1, v3
s_nop 1
v_cndmask_b32 v17, 0, v2, vcc
v_cmp_eq_u32 vcc, 2, v3
s_nop 1
v_cndmask_b32 v18, 0, v2, vcc
v_cmp_eq_u32 vcc, 3, v3
s_nop 1
v_cndmask_b32 v19, 0, v2, vcc
s_waitcnt vmcnt(0)
s_mov_b32 s71, 0
s_mov_b32 s70, 0
s_mov_b64 s[68:69], 0
s_branch L_M_prchk64
L_M_pr62:
s_bitcmp1_b32 s71, 0
s_cbranch_scc1 L_M_pi65
s_add_u32 s63, s79, 0
buffer_load_dwordx4 v[64:67], v11, s[16:19], s63 offen sc1
L_M_pi65:
s_bitcmp1_b32 s71, 1
s_cbranch_scc1 L_M_pi66
s_add_u32 s63, s79, 32768
buffer_load_dwordx4 v[68:71], v11, s[16:19], s63 offen sc1
L_M_pi66:
s_add_u32 s70, s70, 1
s_cmp_ge_u32 s70, 262144
s_cselect_b64 s[68:69], -1, 0
s_waitcnt vmcnt(0)
L_M_prchk64:
s_bitcmp1_b32 s71, 0
s_cbranch_scc1 L_M_pc67
v_max_u32 v3, v64, v65
v_max3_u32 v3, v3, v66, v67
v_cmp_ne_u32 vcc, -1, v3
s_or_b64 vcc, vcc, s[68:69]
s_cmp_eq_u64 vcc, -1
s_cbranch_scc0 L_M_pc67
v_mfma_f32_16x16x32_bf16 v[24:27], v[16:19], v[64:67], v[24:27]
s_bitset1_b32 s71, 0
L_M_pc67:
s_bitcmp1_b32 s71, 1
s_cbranch_scc1 L_M_pc68
v_max_u32 v3, v68, v69
v_max3_u32 v3, v3, v70, v71
v_cmp_ne_u32 vcc, -1, v3
s_or_b64 vcc, vcc, s[68:69]
s_cmp_eq_u64 vcc, -1
s_cbranch_scc0 L_M_pc68
v_mfma_f32_16x16x32_bf16 v[24:27], v[16:19], v[68:71], v[24:27]
s_bitset1_b32 s71, 1
L_M_pc68:
s_cmp_lg_u32 s71, 0x3
s_cbranch_scc1 L_M_pr62
L_M_prdone63:
s_nop 4
ds_write_b128 v4, v[24:27]
s_waitcnt lgkmcnt(0)
s_branch L_M_jn61
L_M_w060:
s_mov_b32 s24, s54
s_mov_b32 s25, s55
s_mov_b32 s26, 0x2000
s_mov_b32 s27, 0x20000
v_add_u32 v2, s78, v10
ds_read_b64 v[240:241], v2 offset:52224
s_waitcnt vmcnt(1) lgkmcnt(0)
v_max_u32 v3, v232, v233
v_cmp_eq_u32 vcc, -1, v3
s_cbranch_vccz L_M_ok69
s_mov_b32 s70, 0
L_M_retry70:
buffer_load_dwordx2 v[232:233], v10, s[16:19], s62 offen sc1
s_waitcnt vmcnt(0)
v_max_u32 v3, v232, v233
s_add_u32 s70, s70, 1
s_cmp_ge_u32 s70, 262144
s_cbranch_scc1 L_M_ok69
v_cmp_eq_u32 vcc, -1, v3
s_cbranch_vccnz L_M_retry70
L_M_ok69:
v_lshlrev_b32 v234, 16, v233
v_and_b32 v235, 0xffff0000, v233
v_lshlrev_b32 v4, 16, v232
v_and_b32 v233, 0xffff0000, v232
v_mov_b32 v232, v4
v_lshlrev_b32 v236, 16, v240
v_and_b32 v237, 0xffff0000, v240
v_lshlrev_b32 v238, 16, v241
v_and_b32 v239, 0xffff0000, v241
L_M_jn61:
s_barrier
s_cmp_lg_u32 s3, 0
s_cbranch_scc1 L_M_mend59
ds_read_b128 v[64:67], v0 offset:1024
ds_read_b128 v[68:71], v0 offset:2048
ds_read_b128 v[72:75], v0 offset:3072
ds_read_b128 v[76:79], v0 offset:4096
ds_read_b128 v[80:83], v0 offset:5120
ds_read_b128 v[84:87], v0 offset:6144
ds_read_b128 v[88:91], v0 offset:7168
s_waitcnt lgkmcnt(0)
v_pk_add_f32 v[64:65], v[64:65], v[80:81]
v_pk_add_f32 v[66:67], v[66:67], v[82:83]
v_pk_add_f32 v[68:69], v[68:69], v[84:85]
v_pk_add_f32 v[70:71], v[70:71], v[86:87]
v_pk_add_f32 v[72:73], v[72:73], v[88:89]
v_pk_add_f32 v[74:75], v[74:75], v[90:91]
v_pk_add_f32 v[68:69], v[68:69], v[76:77]
v_pk_add_f32 v[70:71], v[70:71], v[78:79]
v_pk_add_f32 v[64:65], v[64:65], v[72:73]
v_pk_add_f32 v[66:67], v[66:67], v[74:75]
v_pk_add_f32 v[24:25], v[64:65], v[68:69]
v_pk_add_f32 v[26:27], v[66:67], v[70:71]
v_pk_fma_f32 v[24:25], v[24:25], v[232:233], v[236:237]
v_pk_fma_f32 v[26:27], v[26:27], v[234:235], v[238:239]
v_cvt_pk_bf16_f32 v24, v24, v25
v_cvt_pk_bf16_f32 v25, v26, v27
s_mov_b32 exec_lo, 0xffffffff
s_mov_b32 exec_hi, 0x0
buffer_store_dwordx2 v[24:25], v2, s[24:27], 0 offen
s_mov_b64 exec, -1
L_M_mend59:
s_endpgm
.p2align 6
L_class_Q:
s_waitcnt lgkmcnt(0)
s_mov_b32 s8, s34
s_mov_b32 s9, s35
s_mov_b32 s16, s58
s_mov_b32 s17, s59
s_mov_b32 s18, 0x10000000
s_mov_b32 s19, 0x20000
v_mov_b32 v4, -1
v_mov_b32 v5, -1
v_mov_b32 v6, -1
v_mov_b32 v7, -1
s_mov_b32 s20, s38
s_mov_b32 s21, s39
s_mov_b32 s22, 0x800000
s_mov_b32 s23, 0x20000
s_mov_b32 s24, s32
s_mov_b32 s25, s33
s_mov_b32 s26, 0x2000
s_mov_b32 s27, 0x20000
s_sub_u32 s72, s2, 119
s_cmp_ge_u32 s72, 64
s_cselect_b32 s60, 64, 0
s_sub_u32 s72, s72, s60
s_lshl_b32 s72, s72, 7
s_add_u32 s73, s72, 65536
v_lshrrev_b32 v10, 3, v1
v_lshlrev_b32 v10, 16, v10
v_and_b32 v3, 7, v1
v_lshl_add_u32 v10, v3, 4, v10
s_mul_i32 s74, s3, 1048576
s_add_u32 s74, s74, s72
v_lshrrev_b32 v11, 5, v1
v_lshlrev_b32 v11, 11, v11
v_and_b32 v3, 15, v1
v_lshl_add_u32 v11, v3, 4, v11
v_bfe_u32 v3, v1, 4, 1
v_lshl_add_u32 v11, v3, 3, v11
s_lshl_b32 s78, s3, 8
s_cmp_lg_u32 s3, 0
s_cbranch_scc1 L_Q_clr1
s_setprio 3
v_bfe_u32 v2, v1, 3, 2
v_lshlrev_b32 v2, 13, v2
v_and_b32 v3, 7, v1
v_lshl_add_u32 v2, v3, 4, v2
s_mov_b32 exec_lo, 0xffffffff
s_mov_b32 exec_hi, 0x0
buffer_store_dwordx4 v[4:7], v2, s[16:19], s73 offen sc1
s_mov_b64 exec, -1
s_lshl_b32 s60, s5, 11
s_add_u32 s60, s60, 262144
buffer_store_dwordx4 v[4:7], v0, s[16:19], s60 offen sc1
buffer_store_dwordx4 v[4:7], v0, s[16:19], s60 offen offset:1024 sc1
s_lshl_b32 s60, s5, 7
s_add_u32 s60, s60, 131072
s_mov_b32 exec_lo, 0xff
s_mov_b32 exec_hi, 0x0
buffer_store_dwordx4 v[4:7], v0, s[16:19], s60 offen sc1
s_mov_b64 exec, -1
v_mov_b32 v8, 0
v_mov_b32 v9, 0
v_lshlrev_b32 v2, 3, v1
ds_write_b64 v2, v[8:9] offset:49152
ds_write_b32 v8, v8 offset:50176
s_setprio 0
L_Q_clr1:
s_add_u32 s63, s78, 0
buffer_load_dwordx2 v[16:17], v11, s[24:27], s63 offen
s_add_u32 s63, s78, 4096
buffer_load_dwordx2 v[18:19], v11, s[24:27], s63 offen
s_add_u32 s63, s74, 0
buffer_load_dwordx4 v[64:67], v10, s[20:23], s63 offen nt
s_add_u32 s63, s74, 8192
buffer_load_dwordx4 v[68:71], v10, s[20:23], s63 offen nt
s_add_u32 s63, s74, 16384
buffer_load_dwordx4 v[72:75], v10, s[20:23], s63 offen nt
s_add_u32 s63, s74, 24576
buffer_load_dwordx4 v[76:79], v10, s[20:23], s63 offen nt
s_add_u32 s63, s74, 32768
buffer_load_dwordx4 v[80:83], v10, s[20:23], s63 offen nt
s_mov_b32 s12, s36
s_mov_b32 s13, s37
s_mov_b32 s14, 0x4000000
s_mov_b32 s15, 0x20000
s_mov_b32 s28, s56
s_mov_b32 s29, s57
s_mov_b32 s30, 0x100
s_mov_b32 s31, 0x20000
s_mov_b32 s64, 0x05040100
s_mov_b32 s65, 0x07060302
s_lshl_b32 s60, s3, 12
v_lshrrev_b32 v6, 4, v1
v_lshlrev_b32 v7, 2, v6
v_xor_b32 v7, v7, v1
v_and_b32 v7, 15, v7
v_lshlrev_b32 v7, 4, v7
v_lshl_add_u32 v2, v6, 8, v7
v_add_u32 v2, s60, v2
v_xor_b32 v3, 16, v2
v_xor_b32 v4, 32, v2
v_xor_b32 v5, 48, v2
v_xor_b32 v7, v6, v1
v_and_b32 v7, 15, v7
v_lshlrev_b32 v7, 4, v7
v_and_b32 v8, 3, v1
v_lshl_add_u32 v7, v8, 10, v7
v_bfe_u32 v8, v1, 2, 2
v_lshl_add_u32 v7, v8, 8, v7
v_add_u32 v6, s60, v7
v_xor_b32 v7, 64, v6
v_xor_b32 v8, 128, v6
v_xor_b32 v9, 192, v6
s_cmp_lg_u32 s3, 0
s_cbranch_scc1 L_Q_arr2
s_waitcnt vmcnt(7) lgkmcnt(0)
s_mov_b32 s60, 1
s_atomic_add s60, s[56:57], 0
L_Q_arr2:
s_barrier
s_waitcnt vmcnt(5)
v_lshlrev_b32 v40, 16, v16
v_and_b32 v41, 0xffff0000, v16
v_lshlrev_b32 v42, 16, v17
v_and_b32 v43, 0xffff0000, v17
v_lshlrev_b32 v44, 16, v18
v_and_b32 v45, 0xffff0000, v18
v_lshlrev_b32 v46, 16, v19
v_and_b32 v47, 0xffff0000, v19
v_add_f32 v48, v40, v41
v_add_f32 v50, v42, v43
v_add_f32 v49, v44, v45
v_add_f32 v51, v46, v47
v_add_f32 v48, v48, v50
v_add_f32 v49, v49, v51
s_nop 0
v_add_f32_dpp v48, v48, v48 row_ror:8 row_mask:0xf bank_mask:0xf
v_add_f32_dpp v49, v49, v49 row_ror:8 row_mask:0xf bank_mask:0xf
s_nop 0
v_add_f32_dpp v48, v48, v48 row_ror:4 row_mask:0xf bank_mask:0xf
v_add_f32_dpp v49, v49, v49 row_ror:4 row_mask:0xf bank_mask:0xf
s_nop 0
v_add_f32_dpp v48, v48, v48 row_ror:2 row_mask:0xf bank_mask:0xf
v_add_f32_dpp v49, v49, v49 row_ror:2 row_mask:0xf bank_mask:0xf
s_nop 0
v_add_f32_dpp v48, v48, v48 row_ror:1 row_mask:0xf bank_mask:0xf
v_add_f32_dpp v49, v49, v49 row_ror:1 row_mask:0xf bank_mask:0xf
v_mov_b32 v50, v48
v_mov_b32 v51, v49
s_nop 0
v_permlane16_swap_b32 v48, v50
v_permlane16_swap_b32 v49, v51
v_add_f32 v48, v48, v50
v_add_f32 v49, v49, v51
v_mul_f32 v56, 0x3c000000, v48
v_mul_f32 v58, 0x3c000000, v49
v_sub_f32 v50, v40, v56
v_sub_f32 v51, v41, v56
v_mul_f32 v57, v50, v50
v_fmac_f32 v57, v51, v51
v_sub_f32 v50, v42, v56
v_sub_f32 v51, v43, v56
v_fmac_f32 v57, v50, v50
v_fmac_f32 v57, v51, v51
v_sub_f32 v50, v44, v58
v_sub_f32 v51, v45, v58
v_mul_f32 v59, v50, v50
v_fmac_f32 v59, v51, v51
v_sub_f32 v50, v46, v58
v_sub_f32 v51, v47, v58
v_fmac_f32 v59, v50, v50
v_fmac_f32 v59, v51, v51
v_add_f32_dpp v57, v57, v57 row_ror:8 row_mask:0xf bank_mask:0xf
s_nop 0
v_add_f32_dpp v59, v59, v59 row_ror:8 row_mask:0xf bank_mask:0xf
v_add_f32_dpp v57, v57, v57 row_ror:4 row_mask:0xf bank_mask:0xf
s_nop 0
v_add_f32_dpp v59, v59, v59 row_ror:4 row_mask:0xf bank_mask:0xf
v_add_f32_dpp v57, v57, v57 row_ror:2 row_mask:0xf bank_mask:0xf
s_nop 0
v_add_f32_dpp v59, v59, v59 row_ror:2 row_mask:0xf bank_mask:0xf
v_add_f32_dpp v57, v57, v57 row_ror:1 row_mask:0xf bank_mask:0xf
s_nop 0
v_add_f32_dpp v59, v59, v59 row_ror:1 row_mask:0xf bank_mask:0xf
v_mov_b32 v50, v57
v_mov_b32 v51, v59
s_nop 0
v_permlane16_swap_b32 v57, v50
v_permlane16_swap_b32 v59, v51
v_add_f32 v57, v57, v50
v_add_f32 v59, v59, v51
s_lshl_b32 s60, s3, 5
s_add_u32 s60, s60, 50432
v_lshrrev_b32 v54, 5, v1
v_lshlrev_b32 v54, 3, v54
v_add_u32 v54, s60, v54
s_mov_b32 exec_lo, 0x1
s_mov_b32 exec_hi, 0x1
ds_write_b64 v54, v[56:57]
ds_write_b64 v54, v[58:59] offset:16
s_mov_b64 exec, -1
v_and_b32 v54, 7, v1
v_lshlrev_b32 v54, 5, v54
v_lshrrev_b32 v50, 5, v1
v_lshl_add_u32 v54, v50, 3, v54
v_add_u32 v54, 50432, v54
s_waitcnt lgkmcnt(0)
s_barrier
ds_read_b64 v[56:57], v54
ds_read_b64 v[58:59], v54 offset:16
s_waitcnt lgkmcnt(0)
v_mov_b32 v52, v56
v_mov_b32 v53, v58
s_nop 0
v_add_f32_dpp v52, v52, v52 row_ror:4 row_mask:0xf bank_mask:0xf
v_add_f32_dpp v53, v53, v53 row_ror:4 row_mask:0xf bank_mask:0xf
s_nop 0
v_add_f32_dpp v52, v52, v52 row_ror:2 row_mask:0xf bank_mask:0xf
v_add_f32_dpp v53, v53, v53 row_ror:2 row_mask:0xf bank_mask:0xf
s_nop 0
v_add_f32_dpp v52, v52, v52 row_ror:1 row_mask:0xf bank_mask:0xf
v_add_f32_dpp v53, v53, v53 row_ror:1 row_mask:0xf bank_mask:0xf
v_mul_f32 v52, 0x3e000000, v52
v_mul_f32 v53, 0x3e000000, v53
v_sub_f32 v50, v56, v52
v_sub_f32 v51, v58, v53
v_mul_f32 v48, 0x43000000, v50
v_mul_f32 v49, 0x43000000, v51
v_fmac_f32 v57, v48, v50
v_fmac_f32 v59, v49, v51
s_nop 0
v_add_f32_dpp v57, v57, v57 row_ror:4 row_mask:0xf bank_mask:0xf
v_add_f32_dpp v59, v59, v59 row_ror:4 row_mask:0xf bank_mask:0xf
s_nop 0
v_add_f32_dpp v57, v57, v57 row_ror:2 row_mask:0xf bank_mask:0xf
v_add_f32_dpp v59, v59, v59 row_ror:2 row_mask:0xf bank_mask:0xf
s_nop 0
v_add_f32_dpp v57, v57, v57 row_ror:1 row_mask:0xf bank_mask:0xf
v_add_f32_dpp v59, v59, v59 row_ror:1 row_mask:0xf bank_mask:0xf
v_cvt_pk_bf16_f32 v50, v52, v53
v_lshlrev_b32 v52, 16, v50
v_and_b32 v53, 0xffff0000, v50
v_mul_f32 v48, 0x3a800000, v57
v_mul_f32 v49, 0x3a800000, v59
v_cvt_pk_bf16_f32 v50, v48, v49
v_lshlrev_b32 v48, 16, v50
v_and_b32 v49, 0xffff0000, v50
v_add_f32 v48, 0x3727c5ac, v48
v_add_f32 v49, 0x3727c5ac, v49
v_cvt_pk_bf16_f32 v50, v48, v49
v_lshlrev_b32 v48, 16, v50
v_and_b32 v49, 0xffff0000, v50
v_sqrt_f32 v48, v48
v_sqrt_f32 v49, v49
s_nop 0
v_cvt_pk_bf16_f32 v50, v48, v49
v_lshlrev_b32 v48, 16, v50
v_and_b32 v49, 0xffff0000, v50
v_rcp_f32 v56, v48
v_rcp_f32 v58, v49
v_sub_f32 v40, v40, v52
v_sub_f32 v41, v41, v52
v_sub_f32 v42, v42, v52
v_sub_f32 v43, v43, v52
v_cvt_pk_bf16_f32 v50, v40, v41
v_lshlrev_b32 v40, 16, v50
v_and_b32 v41, 0xffff0000, v50
v_cvt_pk_bf16_f32 v51, v42, v43
v_lshlrev_b32 v42, 16, v51
v_and_b32 v43, 0xffff0000, v51
v_mul_f32 v50, v40, v56
v_fma_f32 v40, -v50, v48, v40
v_fma_f32 v40, v40, v56, v50
v_mul_f32 v50, v41, v56
v_fma_f32 v41, -v50, v48, v41
v_fma_f32 v41, v41, v56, v50
v_mul_f32 v50, v42, v56
v_fma_f32 v42, -v50, v48, v42
v_fma_f32 v42, v42, v56, v50
v_mul_f32 v50, v43, v56
v_fma_f32 v43, -v50, v48, v43
v_fma_f32 v43, v43, v56, v50
v_cvt_pk_bf16_f32 v50, v40, v41
v_lshlrev_b32 v40, 16, v50
v_and_b32 v41, 0xffff0000, v50
v_cvt_pk_bf16_f32 v51, v42, v43
v_lshlrev_b32 v42, 16, v51
v_and_b32 v43, 0xffff0000, v51
v_sub_f32 v44, v44, v53
v_sub_f32 v45, v45, v53
v_sub_f32 v46, v46, v53
v_sub_f32 v47, v47, v53
v_cvt_pk_bf16_f32 v50, v44, v45
v_lshlrev_b32 v44, 16, v50
v_and_b32 v45, 0xffff0000, v50
v_cvt_pk_bf16_f32 v51, v46, v47
v_lshlrev_b32 v46, 16, v51
v_and_b32 v47, 0xffff0000, v51
v_mul_f32 v50, v44, v58
v_fma_f32 v44, -v50, v49, v44
v_fma_f32 v44, v44, v58, v50
v_mul_f32 v50, v45, v58
v_fma_f32 v45, -v50, v49, v45
v_fma_f32 v45, v45, v58, v50
v_mul_f32 v50, v46, v58
v_fma_f32 v46, -v50, v49, v46
v_fma_f32 v46, v46, v58, v50
v_mul_f32 v50, v47, v58
v_fma_f32 v47, -v50, v49, v47
v_fma_f32 v47, v47, v58, v50
v_cvt_pk_bf16_f32 v50, v44, v45
v_lshlrev_b32 v44, 16, v50
v_and_b32 v45, 0xffff0000, v50
v_cvt_pk_bf16_f32 v51, v46, v47
v_lshlrev_b32 v46, 16, v51
v_and_b32 v47, 0xffff0000, v51
v_cvt_pk_bf16_f32 v16, v40, v41
v_cvt_pk_bf16_f32 v17, v42, v43
v_cvt_pk_bf16_f32 v18, v44, v45
v_cvt_pk_bf16_f32 v19, v46, v47
s_waitcnt vmcnt(3)
s_add_u32 s63, s74, 40960
buffer_load_dwordx4 v[84:87], v10, s[20:23], s63 offen nt
s_waitcnt vmcnt(3)
s_add_u32 s63, s74, 49152
buffer_load_dwordx4 v[88:91], v10, s[20:23], s63 offen nt
s_waitcnt vmcnt(3)
s_add_u32 s63, s74, 57344
buffer_load_dwordx4 v[92:95], v10, s[20:23], s63 offen nt
s_waitcnt vmcnt(3)
s_add_u32 s63, s74, 524288
buffer_load_dwordx4 v[96:99], v10, s[20:23], s63 offen nt
s_waitcnt vmcnt(3)
s_add_u32 s63, s74, 532480
buffer_load_dwordx4 v[100:103], v10, s[20:23], s63 offen nt
s_waitcnt vmcnt(3)
s_add_u32 s63, s74, 540672
buffer_load_dwordx4 v[104:107], v10, s[20:23], s63 offen nt
s_waitcnt vmcnt(3)
s_add_u32 s63, s74, 548864
buffer_load_dwordx4 v[108:111], v10, s[20:23], s63 offen nt
v_perm_b32 v32, v68, v64, s64
v_perm_b32 v33, v76, v72, s64
v_perm_b32 v34, v84, v80, s64
v_perm_b32 v35, v92, v88, s64
v_perm_b32 v36, v68, v64, s65
v_perm_b32 v37, v76, v72, s65
v_perm_b32 v38, v84, v80, s65
v_perm_b32 v39, v92, v88, s65
v_perm_b32 v40, v69, v65, s64
v_perm_b32 v41, v77, v73, s64
v_perm_b32 v42, v85, v81, s64
v_perm_b32 v43, v93, v89, s64
v_perm_b32 v44, v69, v65, s65
v_perm_b32 v45, v77, v73, s65
v_perm_b32 v46, v85, v81, s65
v_perm_b32 v47, v93, v89, s65
v_perm_b32 v48, v70, v66, s64
v_perm_b32 v49, v78, v74, s64
v_perm_b32 v50, v86, v82, s64
v_perm_b32 v51, v94, v90, s64
v_perm_b32 v52, v70, v66, s65
v_perm_b32 v53, v78, v74, s65
v_perm_b32 v54, v86, v82, s65
v_perm_b32 v55, v94, v90, s65
v_perm_b32 v56, v71, v67, s64
v_perm_b32 v57, v79, v75, s64
v_perm_b32 v58, v87, v83, s64
v_perm_b32 v59, v95, v91, s64
v_perm_b32 v60, v71, v67, s65
v_perm_b32 v61, v79, v75, s65
v_perm_b32 v62, v87, v83, s65
v_perm_b32 v63, v95, v91, s65
s_waitcnt vmcnt(3)
s_add_u32 s63, s74, 557056
buffer_load_dwordx4 v[112:115], v10, s[20:23], s63 offen nt
s_waitcnt vmcnt(3)
s_add_u32 s63, s74, 565248
buffer_load_dwordx4 v[116:119], v10, s[20:23], s63 offen nt
s_waitcnt vmcnt(3)
s_add_u32 s63, s74, 573440
buffer_load_dwordx4 v[120:123], v10, s[20:23], s63 offen nt
s_waitcnt vmcnt(3)
s_add_u32 s63, s74, 581632
buffer_load_dwordx4 v[124:127], v10, s[20:23], s63 offen nt
s_waitcnt vmcnt(3)
buffer_load_dword v14, off, s[28:31], 0 offset:128 sc1
s_waitcnt vmcnt(3)
s_add_u32 s63, s7, 0
buffer_load_dwordx4 v[128:131], v0, s[8:11], s63 offen offset:0 nt
s_waitcnt vmcnt(3)
s_add_u32 s63, s7, 0
buffer_load_dwordx4 v[132:135], v0, s[8:11], s63 offen offset:1024 nt
s_waitcnt vmcnt(3)
s_add_u32 s63, s7, 0
buffer_load_dwordx4 v[136:139], v0, s[8:11], s63 offen offset:2048 nt
v_perm_b32 v64, v100, v96, s64
v_perm_b32 v65, v108, v104, s64
v_perm_b32 v66, v116, v112, s64
v_perm_b32 v67, v124, v120, s64
v_perm_b32 v68, v100, v96, s65
v_perm_b32 v69, v108, v104, s65
v_perm_b32 v70, v116, v112, s65
v_perm_b32 v71, v124, v120, s65
v_perm_b32 v72, v101, v97, s64
v_perm_b32 v73, v109, v105, s64
v_perm_b32 v74, v117, v113, s64
v_perm_b32 v75, v125, v121, s64
v_perm_b32 v76, v101, v97, s65
v_perm_b32 v77, v109, v105, s65
v_perm_b32 v78, v117, v113, s65
v_perm_b32 v79, v125, v121, s65
v_perm_b32 v80, v102, v98, s64
v_perm_b32 v81, v110, v106, s64
v_perm_b32 v82, v118, v114, s64
v_perm_b32 v83, v126, v122, s64
v_perm_b32 v84, v102, v98, s65
v_perm_b32 v85, v110, v106, s65
v_perm_b32 v86, v118, v114, s65
v_perm_b32 v87, v126, v122, s65
v_perm_b32 v88, v103, v99, s64
v_perm_b32 v89, v111, v107, s64
v_perm_b32 v90, v119, v115, s64
v_perm_b32 v91, v127, v123, s64
v_perm_b32 v92, v103, v99, s65
v_perm_b32 v93, v111, v107, s65
v_perm_b32 v94, v119, v115, s65
v_perm_b32 v95, v127, v123, s65
s_waitcnt vmcnt(3)
s_add_u32 s63, s7, 0
buffer_load_dwordx4 v[140:143], v0, s[8:11], s63 offen offset:3072 nt
v_readfirstlane_b32 s60, v14
s_mov_b32 s70, 0
s_cmp_ge_u32 s60, 32
s_cbranch_scc1 L_Q_cok3
L_Q_cretry4:
buffer_load_dword v14, off, s[28:31], 0 offset:128 sc1
s_waitcnt vmcnt(0)
v_readfirstlane_b32 s60, v14
s_add_u32 s70, s70, 1
s_cmp_ge_u32 s70, 262144
s_cbranch_scc1 L_Q_cok3
s_cmp_lt_u32 s60, 32
s_cbranch_scc1 L_Q_cretry4
L_Q_cok3:
s_waitcnt vmcnt(3)
s_add_u32 s63, s7, 32768
buffer_load_dwordx4 v[144:147], v0, s[8:11], s63 offen offset:0 nt
s_waitcnt vmcnt(3)
s_add_u32 s63, s7, 32768
buffer_load_dwordx4 v[148:151], v0, s[8:11], s63 offen offset:1024 nt
s_waitcnt vmcnt(3)
s_add_u32 s63, s7, 32768
buffer_load_dwordx4 v[152:155], v0, s[8:11], s63 offen offset:2048 nt
s_waitcnt vmcnt(3)
s_add_u32 s63, s7, 32768
buffer_load_dwordx4 v[156:159], v0, s[8:11], s63 offen offset:3072 nt
ds_write_b128 v2, v[128:131] offset:0
ds_write_b128 v3, v[132:135] offset:1024
ds_write_b128 v4, v[136:139] offset:2048
ds_write_b128 v5, v[140:143] offset:3072
ds_read_b128 v[128:131], v6
ds_read_b128 v[132:135], v7
ds_read_b128 v[136:139], v8
ds_read_b128 v[140:143], v9
s_waitcnt vmcnt(3)
s_add_u32 s63, s7, 65536
buffer_load_dwordx4 v[160:163], v0, s[8:11], s63 offen offset:0 nt
s_waitcnt vmcnt(3)
s_add_u32 s63, s7, 65536
buffer_load_dwordx4 v[164:167], v0, s[8:11], s63 offen offset:1024 nt
s_waitcnt vmcnt(3)
s_add_u32 s63, s7, 65536
buffer_load_dwordx4 v[168:171], v0, s[8:11], s63 offen offset:2048 nt
s_waitcnt vmcnt(3)
s_add_u32 s63, s7, 65536
buffer_load_dwordx4 v[172:175], v0, s[8:11], s63 offen offset:3072 nt
ds_write_b128 v2, v[144:147] offset:0
ds_write_b128 v3, v[148:151] offset:1024
ds_write_b128 v4, v[152:155] offset:2048
ds_write_b128 v5, v[156:159] offset:3072
ds_read_b128 v[144:147], v6
ds_read_b128 v[148:151], v7
ds_read_b128 v[152:155], v8
ds_read_b128 v[156:159], v9
s_waitcnt vmcnt(3)
s_add_u32 s63, s78, 0
buffer_load_dwordx2 v[24:25], v11, s[16:19], s63 offen sc1
s_add_u32 s63, s78, 4096
buffer_load_dwordx2 v[26:27], v11, s[16:19], s63 offen sc1
s_add_u32 s63, s78, 8192
buffer_load_dwordx2 v[28:29], v11, s[16:19], s63 offen sc1
s_add_u32 s63, s78, 12288
buffer_load_dwordx2 v[30:31], v11, s[16:19], s63 offen sc1
s_waitcnt vmcnt(4)
ds_write_b128 v2, v[160:163] offset:0
ds_write_b128 v3, v[164:167] offset:1024
ds_write_b128 v4, v[168:171] offset:2048
ds_write_b128 v5, v[172:175] offset:3072
ds_read_b128 v[160:163], v6
ds_read_b128 v[164:167], v7
ds_read_b128 v[168:171], v8
ds_read_b128 v[172:175], v9
s_waitcnt vmcnt(3)
s_add_u32 s63, s7, 98304
buffer_load_dwordx4 v[176:179], v0, s[8:11], s63 offen offset:0 nt
s_waitcnt vmcnt(3)
s_add_u32 s63, s7, 98304
buffer_load_dwordx4 v[180:183], v0, s[8:11], s63 offen offset:1024 nt
s_waitcnt vmcnt(3)
s_add_u32 s63, s7, 98304
buffer_load_dwordx4 v[184:187], v0, s[8:11], s63 offen offset:2048 nt
s_waitcnt vmcnt(3)
s_add_u32 s63, s7, 98304
buffer_load_dwordx4 v[188:191], v0, s[8:11], s63 offen offset:3072 nt
v_max_u32 v12, v24, v25
v_max3_u32 v12, v12, v26, v27
v_max3_u32 v12, v12, v28, v29
v_max3_u32 v12, v12, v30, v31
v_cmp_eq_u32 vcc, -1, v12
s_cbranch_vccz L_Q_ok5
s_mov_b32 s70, 0
L_Q_retry6:
s_add_u32 s63, s78, 0
buffer_load_dwordx2 v[24:25], v11, s[16:19], s63 offen sc1
s_add_u32 s63, s78, 4096
buffer_load_dwordx2 v[26:27], v11, s[16:19], s63 offen sc1
s_add_u32 s63, s78, 8192
buffer_load_dwordx2 v[28:29], v11, s[16:19], s63 offen sc1
s_add_u32 s63, s78, 12288
buffer_load_dwordx2 v[30:31], v11, s[16:19], s63 offen sc1
s_waitcnt vmcnt(0)
v_max_u32 v12, v24, v25
v_max3_u32 v12, v12, v26, v27
v_max3_u32 v12, v12, v28, v29
v_max3_u32 v12, v12, v30, v31
s_add_u32 s70, s70, 1
s_cmp_ge_u32 s70, 262144
s_cbranch_scc1 L_Q_ok5
v_cmp_eq_u32 vcc, -1, v12
s_cbranch_vccnz L_Q_retry6
L_Q_ok5:
v_lshlrev_b32 v96, 16, v16
v_and_b32 v97, 0xffff0000, v16
v_lshlrev_b32 v98, 16, v17
v_and_b32 v99, 0xffff0000, v17
v_lshlrev_b32 v100, 16, v18
v_and_b32 v101, 0xffff0000, v18
v_lshlrev_b32 v102, 16, v19
v_and_b32 v103, 0xffff0000, v19
v_lshlrev_b32 v104, 16, v28
v_and_b32 v105, 0xffff0000, v28
v_add_f32 v104, 1.0, v104
v_add_f32 v105, 1.0, v105
v_cvt_pk_bf16_f32 v28, v104, v105
v_lshlrev_b32 v104, 16, v29
v_and_b32 v105, 0xffff0000, v29
v_add_f32 v104, 1.0, v104
v_add_f32 v105, 1.0, v105
v_cvt_pk_bf16_f32 v29, v104, v105
v_lshlrev_b32 v104, 16, v30
v_and_b32 v105, 0xffff0000, v30
v_add_f32 v104, 1.0, v104
v_add_f32 v105, 1.0, v105
v_cvt_pk_bf16_f32 v30, v104, v105
v_lshlrev_b32 v104, 16, v31
v_and_b32 v105, 0xffff0000, v31
v_add_f32 v104, 1.0, v104
v_add_f32 v105, 1.0, v105
v_cvt_pk_bf16_f32 v31, v104, v105
v_lshlrev_b32 v104, 16, v28
v_and_b32 v105, 0xffff0000, v28
v_mul_f32 v96, v96, v104
v_mul_f32 v97, v97, v105
v_cvt_pk_bf16_f32 v104, v96, v97
v_lshlrev_b32 v96, 16, v104
v_and_b32 v97, 0xffff0000, v104
v_lshlrev_b32 v104, 16, v24
v_and_b32 v105, 0xffff0000, v24
v_add_f32 v96, v96, v104
v_add_f32 v97, v97, v105
v_cvt_pk_bf16_f32 v16, v96, v97
v_lshlrev_b32 v104, 16, v29
v_and_b32 v105, 0xffff0000, v29
v_mul_f32 v98, v98, v104
v_mul_f32 v99, v99, v105
v_cvt_pk_bf16_f32 v104, v98, v99
v_lshlrev_b32 v98, 16, v104
v_and_b32 v99, 0xffff0000, v104
v_lshlrev_b32 v104, 16, v25
v_and_b32 v105, 0xffff0000, v25
v_add_f32 v98, v98, v104
v_add_f32 v99, v99, v105
v_cvt_pk_bf16_f32 v17, v98, v99
v_lshlrev_b32 v104, 16, v30
v_and_b32 v105, 0xffff0000, v30
v_mul_f32 v100, v100, v104
v_mul_f32 v101, v101, v105
v_cvt_pk_bf16_f32 v104, v100, v101
v_lshlrev_b32 v100, 16, v104
v_and_b32 v101, 0xffff0000, v104
v_lshlrev_b32 v104, 16, v26
v_and_b32 v105, 0xffff0000, v26
v_add_f32 v100, v100, v104
v_add_f32 v101, v101, v105
v_cvt_pk_bf16_f32 v18, v100, v101
v_lshlrev_b32 v104, 16, v31
v_and_b32 v105, 0xffff0000, v31
v_mul_f32 v102, v102, v104
v_mul_f32 v103, v103, v105
v_cvt_pk_bf16_f32 v104, v102, v103
v_lshlrev_b32 v102, 16, v104
v_and_b32 v103, 0xffff0000, v104
v_lshlrev_b32 v104, 16, v27
v_and_b32 v105, 0xffff0000, v27
v_add_f32 v102, v102, v104
v_add_f32 v103, v103, v105
v_cvt_pk_bf16_f32 v19, v102, v103
s_lshl_b32 s60, s3, 10
s_add_u32 s60, s60, 40960
v_lshrrev_b32 v12, 5, v1
v_lshlrev_b32 v12, 8, v12
v_and_b32 v13, 15, v1
v_lshl_add_u32 v12, v13, 4, v12
v_bfe_u32 v13, v1, 4, 1
v_lshl_add_u32 v12, v13, 3, v12
v_add_u32 v12, s60, v12
ds_write_b64 v12, v[16:17]
ds_write_b64 v12, v[18:19] offset:512
s_lshl_b32 s60, s3, 10
s_add_u32 s60, s60, 40960
v_and_b32 v12, 3, v1
v_lshlrev_b32 v12, 8, v12
v_lshrrev_b32 v14, 4, v1
v_lshl_add_u32 v12, v14, 5, v12
v_bfe_u32 v14, v1, 3, 1
v_lshl_add_u32 v12, v14, 4, v12
v_add_u32 v12, s60, v12
s_mov_b32 s66, 0x0f0f0f0f
s_mov_b32 s67, 0x0f0f0f0f
v_mov_b32 v14, 49152
v_cndmask_b32 v13, v12, v14, s[66:67]
v_cndmask_b32 v12, v14, v12, s[66:67]
ds_read_b128 v[96:99], v12 offset:0
ds_read_b128 v[100:103], v13 offset:0
ds_read_b128 v[104:107], v12 offset:128
ds_read_b128 v[108:111], v13 offset:128
s_lshl_b32 s60, s3, 11
s_add_u32 s60, s60, 60416
v_lshrrev_b32 v12, 5, v1
v_lshlrev_b32 v12, 10, v12
v_and_b32 v14, 3, v1
v_lshl_add_u32 v12, v14, 8, v12
v_bfe_u32 v14, v1, 2, 1
v_lshl_add_u32 v12, v14, 7, v12
v_bfe_u32 v14, v1, 4, 1
v_lshl_add_u32 v12, v14, 4, v12
v_add_u32 v12, s60, v12
s_waitcnt lgkmcnt(0)
v_mfma_f32_16x16x32_bf16 v[112:115], v[32:35], v[96:99], 0
v_mfma_f32_16x16x32_bf16 v[116:119], v[36:39], v[96:99], 0
v_mfma_f32_16x16x32_bf16 v[120:123], v[40:43], v[96:99], 0
v_mfma_f32_16x16x32_bf16 v[124:127], v[44:47], v[96:99], 0
v_mfma_f32_16x16x32_bf16 v[112:115], v[48:51], v[100:103], v[112:115]
v_mfma_f32_16x16x32_bf16 v[116:119], v[52:55], v[100:103], v[116:119]
v_mfma_f32_16x16x32_bf16 v[120:123], v[56:59], v[100:103], v[120:123]
v_mfma_f32_16x16x32_bf16 v[124:127], v[60:63], v[100:103], v[124:127]
v_mfma_f32_16x16x32_bf16 v[112:115], v[64:67], v[104:107], v[112:115]
v_mfma_f32_16x16x32_bf16 v[116:119], v[68:71], v[104:107], v[116:119]
v_mfma_f32_16x16x32_bf16 v[120:123], v[72:75], v[104:107], v[120:123]
v_mfma_f32_16x16x32_bf16 v[124:127], v[76:79], v[104:107], v[124:127]
v_mfma_f32_16x16x32_bf16 v[112:115], v[80:83], v[108:111], v[112:115]
v_mfma_f32_16x16x32_bf16 v[116:119], v[84:87], v[108:111], v[116:119]
v_mfma_f32_16x16x32_bf16 v[120:123], v[88:91], v[108:111], v[120:123]
v_mfma_f32_16x16x32_bf16 v[124:127], v[92:95], v[108:111], v[124:127]
s_mov_b32 exec_lo, 0xff00ff
s_mov_b32 exec_hi, 0xff00ff00
s_nop 2
ds_write_b128 v12, v[112:115] offset:0
ds_write_b128 v12, v[116:119] offset:32
ds_write_b128 v12, v[120:123] offset:64
ds_write_b128 v12, v[124:127] offset:96
s_mov_b64 exec, -1
s_lshl_b32 s60, s3, 8
s_add_u32 s60, s60, 60416
v_bfe_u32 v13, v1, 2, 1
v_lshlrev_b32 v13, 7, v13
v_and_b32 v14, 3, v1
v_lshl_add_u32 v13, v14, 5, v13
v_lshrrev_b32 v14, 5, v1
v_lshl_add_u32 v13, v14, 4, v13
v_bfe_u32 v14, v1, 3, 2
v_lshl_add_u32 v13, v14, 2, v13
v_add_u32 v13, s60, v13
s_waitcnt lgkmcnt(0)
s_barrier
s_cmp_ge_u32 s3, 4
s_cbranch_scc1 L_Q_fin7
ds_read2st64_b32 v[96:97], v13 offset0:0 offset1:4
ds_read2st64_b32 v[98:99], v13 offset0:8 offset1:12
ds_read2st64_b32 v[100:101], v13 offset0:16 offset1:20
ds_read2st64_b32 v[102:103], v13 offset0:24 offset1:28
ds_read2st64_b32 v[104:105], v13 offset0:32 offset1:36
ds_read2st64_b32 v[106:107], v13 offset0:40 offset1:44
ds_read2st64_b32 v[108:109], v13 offset0:48 offset1:52
ds_read2st64_b32 v[110:111], v13 offset0:56 offset1:60
s_mul_i32 s60, s3, 8192
s_add_u32 s60, s60, s73
v_lshlrev_b32 v12, 1, v1
s_waitcnt lgkmcnt(0)
v_add_f32 v96, v96, v104
v_add_f32 v97, v97, v105
v_add_f32 v98, v98, v106
v_add_f32 v99, v99, v107
v_add_f32 v100, v100, v108
v_add_f32 v101, v101, v109
v_add_f32 v102, v102, v110
v_add_f32 v103, v103, v111
v_add_f32 v96, v96, v100
v_add_f32 v97, v97, v101
v_add_f32 v98, v98, v102
v_add_f32 v99, v99, v103
v_add_f32 v96, v96, v98
v_add_f32 v97, v97, v99
v_add_f32 v96, v96, v97
s_nop 1
v_mov_b32_dpp v97, v96 quad_perm:[1,1,3,3] row_mask:0xf bank_mask:0xf
v_cvt_pk_bf16_f32 v112, v96, v97
s_nop 1
v_mov_b32_dpp v113, v112 row_shl:2 row_mask:0xf bank_mask:0xf
v_mov_b32_dpp v114, v112 row_shl:4 row_mask:0xf bank_mask:0xf
v_mov_b32_dpp v115, v112 row_shl:6 row_mask:0xf bank_mask:0xf
s_mov_b32 exec_lo, 0x1010101
s_mov_b32 exec_hi, 0x1010101
buffer_store_dwordx4 v[112:115], v12, s[16:19], s60 offen sc1
s_mov_b64 exec, -1
L_Q_fin7:
s_waitcnt vmcnt(3)
s_add_u32 s63, s7, 131072
buffer_load_dwordx4 v[192:195], v0, s[8:11], s63 offen offset:0 nt
s_waitcnt vmcnt(3)
s_add_u32 s63, s7, 131072
buffer_load_dwordx4 v[196:199], v0, s[8:11], s63 offen offset:1024 nt
s_waitcnt vmcnt(3)
s_add_u32 s63, s7, 131072
buffer_load_dwordx4 v[200:203], v0, s[8:11], s63 offen offset:2048 nt
s_waitcnt vmcnt(3)
s_add_u32 s63, s7, 131072
buffer_load_dwordx4 v[204:207], v0, s[8:11], s63 offen offset:3072 nt
ds_write_b128 v2, v[176:179] offset:0
ds_write_b128 v3, v[180:183] offset:1024
ds_write_b128 v4, v[184:187] offset:2048
ds_write_b128 v5, v[188:191] offset:3072
ds_read_b128 v[176:179], v6
ds_read_b128 v[180:183], v7
ds_read_b128 v[184:187], v8
ds_read_b128 v[188:191], v9
s_waitcnt vmcnt(3)
s_add_u32 s63, s7, 163840
buffer_load_dwordx4 v[208:211], v0, s[8:11], s63 offen offset:0 nt
s_waitcnt vmcnt(3)
s_add_u32 s63, s7, 163840
buffer_load_dwordx4 v[212:215], v0, s[8:11], s63 offen offset:1024 nt
s_waitcnt vmcnt(3)
s_add_u32 s63, s7, 163840
buffer_load_dwordx4 v[216:219], v0, s[8:11], s63 offen offset:2048 nt
s_waitcnt vmcnt(3)
s_add_u32 s63, s7, 163840
buffer_load_dwordx4 v[220:223], v0, s[8:11], s63 offen offset:3072 nt
ds_write_b128 v2, v[192:195] offset:0
ds_write_b128 v3, v[196:199] offset:1024
ds_write_b128 v4, v[200:203] offset:2048
ds_write_b128 v5, v[204:207] offset:3072
ds_read_b128 v[192:195], v6
ds_read_b128 v[196:199], v7
ds_read_b128 v[200:203], v8
ds_read_b128 v[204:207], v9
s_waitcnt vmcnt(3)
buffer_load_dword v10, off, s[28:31], 0 offset:0 sc1
s_waitcnt vmcnt(3)
s_add_u32 s63, s7, 196608
buffer_load_dwordx4 v[224:227], v0, s[8:11], s63 offen offset:0 nt
s_waitcnt vmcnt(3)
s_add_u32 s63, s7, 196608
buffer_load_dwordx4 v[228:231], v0, s[8:11], s63 offen offset:1024 nt
s_waitcnt vmcnt(3)
s_add_u32 s63, s7, 196608
buffer_load_dwordx4 v[232:235], v0, s[8:11], s63 offen offset:2048 nt
ds_write_b128 v2, v[208:211] offset:0
ds_write_b128 v3, v[212:215] offset:1024
ds_write_b128 v4, v[216:219] offset:2048
ds_write_b128 v5, v[220:223] offset:3072
ds_read_b128 v[208:211], v6
ds_read_b128 v[212:215], v7
ds_read_b128 v[216:219], v8
ds_read_b128 v[220:223], v9
s_waitcnt vmcnt(3)
s_add_u32 s63, s7, 196608
buffer_load_dwordx4 v[236:239], v0, s[8:11], s63 offen offset:3072 nt
s_waitcnt vmcnt(3)
s_add_u32 s63, s7, 229376
buffer_load_dwordx4 v[240:243], v0, s[8:11], s63 offen offset:0 nt
s_waitcnt vmcnt(3)
s_add_u32 s63, s7, 229376
buffer_load_dwordx4 v[244:247], v0, s[8:11], s63 offen offset:1024 nt
s_waitcnt vmcnt(3)
s_add_u32 s63, s7, 229376
buffer_load_dwordx4 v[248:251], v0, s[8:11], s63 offen offset:2048 nt
s_waitcnt vmcnt(3)
s_add_u32 s63, s7, 229376
buffer_load_dwordx4 v[252:255], v0, s[8:11], s63 offen offset:3072 nt
ds_write_b128 v2, v[224:227] offset:0
ds_write_b128 v3, v[228:231] offset:1024
ds_write_b128 v4, v[232:235] offset:2048
ds_write_b128 v5, v[236:239] offset:3072
ds_read_b128 v[224:227], v6
ds_read_b128 v[228:231], v7
ds_read_b128 v[232:235], v8
ds_read_b128 v[236:239], v9
v_readfirstlane_b32 s60, v10
s_mov_b32 s70, 0
s_cmp_ge_u32 s60, 256
s_cbranch_scc1 L_Q_cok8
L_Q_cretry9:
buffer_load_dword v10, off, s[28:31], 0 offset:0 sc1
s_waitcnt vmcnt(0)
v_readfirstlane_b32 s60, v10
s_add_u32 s70, s70, 1
s_cmp_ge_u32 s70, 262144
s_cbranch_scc1 L_Q_cok8
s_cmp_lt_u32 s60, 256
s_cbranch_scc1 L_Q_cretry9
L_Q_cok8:
s_waitcnt vmcnt(3)
s_lshr_b32 s75, s5, 4
s_lshl_b32 s75, s75, 11
s_add_u32 s75, s75, 65536
buffer_load_dwordx4 v[16:19], v0, s[16:19], s75 offen offset:0 sc1
buffer_load_dwordx4 v[20:23], v0, s[16:19], s75 offen offset:1024 sc1
s_waitcnt vmcnt(3)
s_add_u32 s63, s7, 0
buffer_load_dwordx4 v[64:67], v0, s[12:15], s63 offen offset:0 nt
s_waitcnt vmcnt(3)
s_add_u32 s63, s7, 0
buffer_load_dwordx4 v[68:71], v0, s[12:15], s63 offen offset:1024 nt
ds_write_b128 v2, v[240:243] offset:0
ds_write_b128 v3, v[244:247] offset:1024
ds_write_b128 v4, v[248:251] offset:2048
ds_write_b128 v5, v[252:255] offset:3072
ds_read_b128 v[240:243], v6
ds_read_b128 v[244:247], v7
ds_read_b128 v[248:251], v8
ds_read_b128 v[252:255], v9
s_cmp_lt_u32 s3, 4
s_cbranch_scc1 L_Q_pr10
s_setprio 1
L_Q_pr10:
s_lshl_b32 s60, s3, 12
v_and_b32 v10, 3, v1
v_lshlrev_b32 v10, 2, v10
v_bfe_u32 v11, v1, 2, 1
v_or_b32 v10, v10, v11
v_lshrrev_b32 v11, 4, v1
v_xor_b32 v10, v10, v11
v_lshlrev_b32 v10, 4, v10
v_and_b32 v11, 7, v1
v_lshl_add_u32 v10, v11, 8, v10
v_add_u32 v6, s60, v10
v_xor_b32 v7, 64, v6
v_xor_b32 v8, 128, v6
v_xor_b32 v9, 192, v6
s_waitcnt vmcnt(3)
s_add_u32 s63, s7, 0
buffer_load_dwordx4 v[72:75], v0, s[12:15], s63 offen offset:2048 nt
s_waitcnt vmcnt(3)
s_add_u32 s63, s7, 0
buffer_load_dwordx4 v[76:79], v0, s[12:15], s63 offen offset:3072 nt
v_max_u32 v10, v16, v17
v_max3_u32 v10, v10, v18, v19
v_max3_u32 v10, v10, v20, v21
v_max3_u32 v10, v10, v22, v23
v_cmp_eq_u32 vcc, -1, v10
s_cbranch_vccz L_Q_ok11
s_mov_b32 s70, 0
L_Q_retry12:
buffer_load_dwordx4 v[16:19], v0, s[16:19], s75 offen offset:0 sc1
buffer_load_dwordx4 v[20:23], v0, s[16:19], s75 offen offset:1024 sc1
s_waitcnt vmcnt(0)
v_max_u32 v10, v16, v17
v_max3_u32 v10, v10, v18, v19
v_max3_u32 v10, v10, v20, v21
v_max3_u32 v10, v10, v22, v23
s_add_u32 s70, s70, 1
s_cmp_ge_u32 s70, 262144
s_cbranch_scc1 L_Q_ok11
v_cmp_eq_u32 vcc, -1, v10
s_cbranch_vccnz L_Q_retry12
L_Q_ok11:
ds_write_b128 v2, v[16:19] offset:0
ds_write_b128 v3, v[20:23] offset:1024
ds_read_b128 v[16:19], v6
ds_read_b128 v[20:23], v7
ds_read_b128 v[24:27], v8
ds_read_b128 v[28:31], v9
s_waitcnt lgkmcnt(0)
v_mfma_f32_16x16x32_bf16 v[32:35], v[128:131], v[16:19], 0
v_mfma_f32_16x16x32_bf16 v[32:35], v[132:135], v[20:23], v[32:35]
v_mfma_f32_16x16x32_bf16 v[32:35], v[136:139], v[24:27], v[32:35]
v_mfma_f32_16x16x32_bf16 v[32:35], v[140:143], v[28:31], v[32:35]
v_mfma_f32_16x16x32_bf16 v[36:39], v[144:147], v[16:19], 0
v_mfma_f32_16x16x32_bf16 v[36:39], v[148:151], v[20:23], v[36:39]
v_mfma_f32_16x16x32_bf16 v[36:39], v[152:155], v[24:27], v[36:39]
v_mfma_f32_16x16x32_bf16 v[36:39], v[156:159], v[28:31], v[36:39]
s_add_u32 s63, s7, 32768
buffer_load_dwordx4 v[80:83], v0, s[12:15], s63 offen offset:0 nt
s_add_u32 s63, s7, 32768
buffer_load_dwordx4 v[84:87], v0, s[12:15], s63 offen offset:1024 nt
v_mfma_f32_16x16x32_bf16 v[40:43], v[160:163], v[16:19], 0
v_mfma_f32_16x16x32_bf16 v[40:43], v[164:167], v[20:23], v[40:43]
v_mfma_f32_16x16x32_bf16 v[40:43], v[168:171], v[24:27], v[40:43]
v_mfma_f32_16x16x32_bf16 v[40:43], v[172:175], v[28:31], v[40:43]
v_mfma_f32_16x16x32_bf16 v[44:47], v[176:179], v[16:19], 0
v_mfma_f32_16x16x32_bf16 v[44:47], v[180:183], v[20:23], v[44:47]
v_mfma_f32_16x16x32_bf16 v[44:47], v[184:187], v[24:27], v[44:47]
v_mfma_f32_16x16x32_bf16 v[44:47], v[188:191], v[28:31], v[44:47]
v_mfma_f32_16x16x32_bf16 v[48:51], v[192:195], v[16:19], 0
v_mfma_f32_16x16x32_bf16 v[48:51], v[196:199], v[20:23], v[48:51]
v_mfma_f32_16x16x32_bf16 v[48:51], v[200:203], v[24:27], v[48:51]
v_mfma_f32_16x16x32_bf16 v[48:51], v[204:207], v[28:31], v[48:51]
v_mfma_f32_16x16x32_bf16 v[52:55], v[208:211], v[16:19], 0
v_mfma_f32_16x16x32_bf16 v[52:55], v[212:215], v[20:23], v[52:55]
v_mfma_f32_16x16x32_bf16 v[52:55], v[216:219], v[24:27], v[52:55]
v_mfma_f32_16x16x32_bf16 v[52:55], v[220:223], v[28:31], v[52:55]
v_mfma_f32_16x16x32_bf16 v[56:59], v[224:227], v[16:19], 0
v_mfma_f32_16x16x32_bf16 v[56:59], v[228:231], v[20:23], v[56:59]
v_mfma_f32_16x16x32_bf16 v[56:59], v[232:235], v[24:27], v[56:59]
v_mfma_f32_16x16x32_bf16 v[56:59], v[236:239], v[28:31], v[56:59]
v_mfma_f32_16x16x32_bf16 v[60:63], v[240:243], v[16:19], 0
v_mfma_f32_16x16x32_bf16 v[60:63], v[244:247], v[20:23], v[60:63]
v_mfma_f32_16x16x32_bf16 v[60:63], v[248:251], v[24:27], v[60:63]
v_mfma_f32_16x16x32_bf16 v[60:63], v[252:255], v[28:31], v[60:63]
s_add_u32 s63, s7, 32768
buffer_load_dwordx4 v[88:91], v0, s[12:15], s63 offen offset:2048 nt
v_cvt_pk_bf16_f32 v2, v32, v33
v_lshlrev_b32 v32, 16, v2
v_and_b32 v33, 0xffff0000, v2
v_cvt_pk_bf16_f32 v3, v34, v35
v_lshlrev_b32 v34, 16, v3
v_and_b32 v35, 0xffff0000, v3
v_mul_f32 v32, 0x3db504f3, v32
v_mul_f32 v33, 0x3db504f3, v33
v_mul_f32 v34, 0x3db504f3, v34
v_mul_f32 v35, 0x3db504f3, v35
v_cvt_pk_bf16_f32 v2, v32, v33
v_lshlrev_b32 v32, 16, v2
v_and_b32 v33, 0xffff0000, v2
v_cvt_pk_bf16_f32 v3, v34, v35
v_lshlrev_b32 v34, 16, v3
v_and_b32 v35, 0xffff0000, v3
v_max_f32 v4, v32, v33
v_max3_f32 v4, v4, v34, v35
v_cvt_pk_bf16_f32 v2, v36, v37
v_lshlrev_b32 v36, 16, v2
v_and_b32 v37, 0xffff0000, v2
v_cvt_pk_bf16_f32 v3, v38, v39
v_lshlrev_b32 v38, 16, v3
v_and_b32 v39, 0xffff0000, v3
v_mul_f32 v36, 0x3db504f3, v36
v_mul_f32 v37, 0x3db504f3, v37
v_mul_f32 v38, 0x3db504f3, v38
v_mul_f32 v39, 0x3db504f3, v39
v_cvt_pk_bf16_f32 v2, v36, v37
v_lshlrev_b32 v36, 16, v2
v_and_b32 v37, 0xffff0000, v2
v_cvt_pk_bf16_f32 v3, v38, v39
v_lshlrev_b32 v38, 16, v3
v_and_b32 v39, 0xffff0000, v3
v_max3_f32 v4, v4, v36, v37
v_max3_f32 v4, v4, v38, v39
v_cvt_pk_bf16_f32 v2, v40, v41
v_lshlrev_b32 v40, 16, v2
v_and_b32 v41, 0xffff0000, v2
v_cvt_pk_bf16_f32 v3, v42, v43
v_lshlrev_b32 v42, 16, v3
v_and_b32 v43, 0xffff0000, v3
v_mul_f32 v40, 0x3db504f3, v40
v_mul_f32 v41, 0x3db504f3, v41
v_mul_f32 v42, 0x3db504f3, v42
v_mul_f32 v43, 0x3db504f3, v43
v_cvt_pk_bf16_f32 v2, v40, v41
v_lshlrev_b32 v40, 16, v2
v_and_b32 v41, 0xffff0000, v2
v_cvt_pk_bf16_f32 v3, v42, v43
v_lshlrev_b32 v42, 16, v3
v_and_b32 v43, 0xffff0000, v3
v_max3_f32 v4, v4, v40, v41
v_max3_f32 v4, v4, v42, v43
v_cvt_pk_bf16_f32 v2, v44, v45
v_lshlrev_b32 v44, 16, v2
v_and_b32 v45, 0xffff0000, v2
v_cvt_pk_bf16_f32 v3, v46, v47
v_lshlrev_b32 v46, 16, v3
v_and_b32 v47, 0xffff0000, v3
v_mul_f32 v44, 0x3db504f3, v44
v_mul_f32 v45, 0x3db504f3, v45
v_mul_f32 v46, 0x3db504f3, v46
v_mul_f32 v47, 0x3db504f3, v47
v_cvt_pk_bf16_f32 v2, v44, v45
v_lshlrev_b32 v44, 16, v2
v_and_b32 v45, 0xffff0000, v2
v_cvt_pk_bf16_f32 v3, v46, v47
v_lshlrev_b32 v46, 16, v3
v_and_b32 v47, 0xffff0000, v3
v_max3_f32 v4, v4, v44, v45
v_max3_f32 v4, v4, v46, v47
v_cvt_pk_bf16_f32 v2, v48, v49
v_lshlrev_b32 v48, 16, v2
v_and_b32 v49, 0xffff0000, v2
v_cvt_pk_bf16_f32 v3, v50, v51
v_lshlrev_b32 v50, 16, v3
v_and_b32 v51, 0xffff0000, v3
v_mul_f32 v48, 0x3db504f3, v48
v_mul_f32 v49, 0x3db504f3, v49
v_mul_f32 v50, 0x3db504f3, v50
v_mul_f32 v51, 0x3db504f3, v51
v_cvt_pk_bf16_f32 v2, v48, v49
v_lshlrev_b32 v48, 16, v2
v_and_b32 v49, 0xffff0000, v2
v_cvt_pk_bf16_f32 v3, v50, v51
v_lshlrev_b32 v50, 16, v3
v_and_b32 v51, 0xffff0000, v3
v_max3_f32 v4, v4, v48, v49
v_max3_f32 v4, v4, v50, v51
v_cvt_pk_bf16_f32 v2, v52, v53
v_lshlrev_b32 v52, 16, v2
v_and_b32 v53, 0xffff0000, v2
v_cvt_pk_bf16_f32 v3, v54, v55
v_lshlrev_b32 v54, 16, v3
v_and_b32 v55, 0xffff0000, v3
v_mul_f32 v52, 0x3db504f3, v52
v_mul_f32 v53, 0x3db504f3, v53
v_mul_f32 v54, 0x3db504f3, v54
v_mul_f32 v55, 0x3db504f3, v55
v_cvt_pk_bf16_f32 v2, v52, v53
v_lshlrev_b32 v52, 16, v2
v_and_b32 v53, 0xffff0000, v2
v_cvt_pk_bf16_f32 v3, v54, v55
v_lshlrev_b32 v54, 16, v3
v_and_b32 v55, 0xffff0000, v3
v_max3_f32 v4, v4, v52, v53
v_max3_f32 v4, v4, v54, v55
v_cvt_pk_bf16_f32 v2, v56, v57
v_lshlrev_b32 v56, 16, v2
v_and_b32 v57, 0xffff0000, v2
v_cvt_pk_bf16_f32 v3, v58, v59
v_lshlrev_b32 v58, 16, v3
v_and_b32 v59, 0xffff0000, v3
v_mul_f32 v56, 0x3db504f3, v56
v_mul_f32 v57, 0x3db504f3, v57
v_mul_f32 v58, 0x3db504f3, v58
v_mul_f32 v59, 0x3db504f3, v59
v_cvt_pk_bf16_f32 v2, v56, v57
v_lshlrev_b32 v56, 16, v2
v_and_b32 v57, 0xffff0000, v2
v_cvt_pk_bf16_f32 v3, v58, v59
v_lshlrev_b32 v58, 16, v3
v_and_b32 v59, 0xffff0000, v3
v_max3_f32 v4, v4, v56, v57
v_max3_f32 v4, v4, v58, v59
v_cvt_pk_bf16_f32 v2, v60, v61
v_lshlrev_b32 v60, 16, v2
v_and_b32 v61, 0xffff0000, v2
v_cvt_pk_bf16_f32 v3, v62, v63
v_lshlrev_b32 v62, 16, v3
v_and_b32 v63, 0xffff0000, v3
v_mul_f32 v60, 0x3db504f3, v60
v_mul_f32 v61, 0x3db504f3, v61
v_mul_f32 v62, 0x3db504f3, v62
v_mul_f32 v63, 0x3db504f3, v63
v_cvt_pk_bf16_f32 v2, v60, v61
v_lshlrev_b32 v60, 16, v2
v_and_b32 v61, 0xffff0000, v2
v_cvt_pk_bf16_f32 v3, v62, v63
v_lshlrev_b32 v62, 16, v3
v_and_b32 v63, 0xffff0000, v3
v_max3_f32 v4, v4, v60, v61
v_max3_f32 v4, v4, v62, v63
s_waitcnt vmcnt(4)
s_add_u32 s63, s7, 32768
buffer_load_dwordx4 v[92:95], v0, s[12:15], s63 offen offset:3072 nt
s_waitcnt vmcnt(4)
s_add_u32 s63, s7, 65536
buffer_load_dwordx4 v[96:99], v0, s[12:15], s63 offen offset:0 nt
v_mov_b32 v5, v4
s_nop 1
v_permlane16_swap_b32 v4, v5
v_max_f32 v4, v4, v5
v_mov_b32 v5, v4
s_nop 1
v_permlane32_swap_b32 v4, v5
v_max_f32 v4, v4, v5
v_mul_f32 v6, 0xbfb8aa3b, v4
s_mov_b32 s60, 0x3fb8aa3b
s_mov_b32 s66, 0x00ff00ff
s_mov_b32 s67, 0x00ff00ff
v_mov_b32 v5, 0
v_fma_f32 v32, v32, s60, v6
v_fma_f32 v33, v33, s60, v6
v_fma_f32 v34, v34, s60, v6
v_fma_f32 v35, v35, s60, v6
v_exp_f32 v32, v32
v_exp_f32 v33, v33
v_exp_f32 v34, v34
v_exp_f32 v35, v35
v_add_f32 v7, v32, v33
v_add_f32 v8, v34, v35
v_cvt_pk_bf16_f32 v2, v32, v33
v_cvt_pk_bf16_f32 v3, v34, v35
v_add_f32 v5, v5, v7
v_add_f32 v5, v5, v8
v_cndmask_b32 v16, 0, v2, s[66:67]
v_cndmask_b32 v32, v2, 0, s[66:67]
v_cndmask_b32 v17, 0, v3, s[66:67]
v_cndmask_b32 v33, v3, 0, s[66:67]
v_fma_f32 v36, v36, s60, v6
v_fma_f32 v37, v37, s60, v6
v_fma_f32 v38, v38, s60, v6
v_fma_f32 v39, v39, s60, v6
v_exp_f32 v36, v36
v_exp_f32 v37, v37
v_exp_f32 v38, v38
v_exp_f32 v39, v39
v_add_f32 v7, v36, v37
v_add_f32 v8, v38, v39
v_cvt_pk_bf16_f32 v2, v36, v37
v_cvt_pk_bf16_f32 v3, v38, v39
v_add_f32 v5, v5, v7
v_add_f32 v5, v5, v8
v_cndmask_b32 v18, 0, v2, s[66:67]
v_cndmask_b32 v34, v2, 0, s[66:67]
v_cndmask_b32 v19, 0, v3, s[66:67]
v_cndmask_b32 v35, v3, 0, s[66:67]
v_fma_f32 v40, v40, s60, v6
v_fma_f32 v41, v41, s60, v6
v_fma_f32 v42, v42, s60, v6
v_fma_f32 v43, v43, s60, v6
v_exp_f32 v40, v40
v_exp_f32 v41, v41
v_exp_f32 v42, v42
v_exp_f32 v43, v43
v_add_f32 v7, v40, v41
v_add_f32 v8, v42, v43
v_cvt_pk_bf16_f32 v2, v40, v41
v_cvt_pk_bf16_f32 v3, v42, v43
v_add_f32 v5, v5, v7
v_add_f32 v5, v5, v8
v_cndmask_b32 v20, 0, v2, s[66:67]
v_cndmask_b32 v36, v2, 0, s[66:67]
v_cndmask_b32 v21, 0, v3, s[66:67]
v_cndmask_b32 v37, v3, 0, s[66:67]
v_fma_f32 v44, v44, s60, v6
v_fma_f32 v45, v45, s60, v6
v_fma_f32 v46, v46, s60, v6
v_fma_f32 v47, v47, s60, v6
v_exp_f32 v44, v44
v_exp_f32 v45, v45
v_exp_f32 v46, v46
v_exp_f32 v47, v47
v_add_f32 v7, v44, v45
v_add_f32 v8, v46, v47
v_cvt_pk_bf16_f32 v2, v44, v45
v_cvt_pk_bf16_f32 v3, v46, v47
v_add_f32 v5, v5, v7
v_add_f32 v5, v5, v8
v_cndmask_b32 v22, 0, v2, s[66:67]
v_cndmask_b32 v38, v2, 0, s[66:67]
v_cndmask_b32 v23, 0, v3, s[66:67]
v_cndmask_b32 v39, v3, 0, s[66:67]
v_fma_f32 v48, v48, s60, v6
v_fma_f32 v49, v49, s60, v6
v_fma_f32 v50, v50, s60, v6
v_fma_f32 v51, v51, s60, v6
v_exp_f32 v48, v48
v_exp_f32 v49, v49
v_exp_f32 v50, v50
v_exp_f32 v51, v51
v_add_f32 v7, v48, v49
v_add_f32 v8, v50, v51
v_cvt_pk_bf16_f32 v2, v48, v49
v_cvt_pk_bf16_f32 v3, v50, v51
v_add_f32 v5, v5, v7
v_add_f32 v5, v5, v8
v_cndmask_b32 v24, 0, v2, s[66:67]
v_cndmask_b32 v40, v2, 0, s[66:67]
v_cndmask_b32 v25, 0, v3, s[66:67]
v_cndmask_b32 v41, v3, 0, s[66:67]
v_fma_f32 v52, v52, s60, v6
v_fma_f32 v53, v53, s60, v6
v_fma_f32 v54, v54, s60, v6
v_fma_f32 v55, v55, s60, v6
v_exp_f32 v52, v52
v_exp_f32 v53, v53
v_exp_f32 v54, v54
v_exp_f32 v55, v55
v_add_f32 v7, v52, v53
v_add_f32 v8, v54, v55
v_cvt_pk_bf16_f32 v2, v52, v53
v_cvt_pk_bf16_f32 v3, v54, v55
v_add_f32 v5, v5, v7
v_add_f32 v5, v5, v8
v_cndmask_b32 v26, 0, v2, s[66:67]
v_cndmask_b32 v42, v2, 0, s[66:67]
v_cndmask_b32 v27, 0, v3, s[66:67]
v_cndmask_b32 v43, v3, 0, s[66:67]
v_fma_f32 v56, v56, s60, v6
v_fma_f32 v57, v57, s60, v6
v_fma_f32 v58, v58, s60, v6
v_fma_f32 v59, v59, s60, v6
v_exp_f32 v56, v56
v_exp_f32 v57, v57
v_exp_f32 v58, v58
v_exp_f32 v59, v59
v_add_f32 v7, v56, v57
v_add_f32 v8, v58, v59
v_cvt_pk_bf16_f32 v2, v56, v57
v_cvt_pk_bf16_f32 v3, v58, v59
v_add_f32 v5, v5, v7
v_add_f32 v5, v5, v8
v_cndmask_b32 v28, 0, v2, s[66:67]
v_cndmask_b32 v44, v2, 0, s[66:67]
v_cndmask_b32 v29, 0, v3, s[66:67]
v_cndmask_b32 v45, v3, 0, s[66:67]
v_fma_f32 v60, v60, s60, v6
v_fma_f32 v61, v61, s60, v6
v_fma_f32 v62, v62, s60, v6
v_fma_f32 v63, v63, s60, v6
v_exp_f32 v60, v60
v_exp_f32 v61, v61
v_exp_f32 v62, v62
v_exp_f32 v63, v63
v_add_f32 v7, v60, v61
v_add_f32 v8, v62, v63
v_cvt_pk_bf16_f32 v2, v60, v61
v_cvt_pk_bf16_f32 v3, v62, v63
v_add_f32 v5, v5, v7
v_add_f32 v5, v5, v8
v_cndmask_b32 v30, 0, v2, s[66:67]
v_cndmask_b32 v46, v2, 0, s[66:67]
v_cndmask_b32 v31, 0, v3, s[66:67]
v_cndmask_b32 v47, v3, 0, s[66:67]
v_mov_b32 v6, v5
s_nop 1
v_permlane16_swap_b32 v5, v6
v_add_f32 v5, v5, v6
v_mov_b32 v6, v5
s_nop 1
v_permlane32_swap_b32 v5, v6
v_add_f32 v5, v5, v6
s_lshl_b32 s60, s3, 6
s_add_u32 s60, s60, 49664
v_lshlrev_b32 v6, 3, v1
v_add_u32 v7, s60, v6
v_mov_b32 v8, 1
v_mov_b32 v9, 50176
s_mov_b32 exec_lo, 0xff
s_mov_b32 exec_hi, 0x0
ds_write_b64 v7, v[4:5]
s_mov_b64 exec, 1
ds_add_rtn_u32 v8, v9, v8
s_mov_b64 exec, -1
s_waitcnt lgkmcnt(0)
v_readfirstlane_b32 s60, v8
s_cmp_lg_u32 s60, 7
s_cbranch_scc1 L_Q_ml13
ds_read_b64 v[8:9], v6 offset:49664
s_waitcnt lgkmcnt(0)
v_max_f32_dpp v2, v8, v8 row_ror:8 row_mask:0xf bank_mask:0xf
v_mov_b32 v7, v2
s_nop 1
v_permlane16_swap_b32 v2, v7
v_max_f32 v2, v2, v7
v_mov_b32 v7, v2
s_nop 1
v_permlane32_swap_b32 v2, v7
v_max_f32 v2, v2, v7
v_sub_f32 v7, v8, v2
v_mul_f32 v7, 0x3fb8aa3b, v7
v_exp_f32 v7, v7
s_nop 0
v_mul_f32 v3, v9, v7
s_nop 1
v_add_f32_dpp v3, v3, v3 row_ror:8 row_mask:0xf bank_mask:0xf
v_mov_b32 v7, v3
s_nop 1
v_permlane16_swap_b32 v3, v7
v_add_f32 v3, v3, v7
v_mov_b32 v7, v3
s_nop 1
v_permlane32_swap_b32 v3, v7
v_add_f32 v3, v3, v7
s_lshl_b32 s60, s5, 7
s_add_u32 s60, s60, 131072
s_mov_b32 exec_lo, 0xff
s_mov_b32 exec_hi, 0x0
buffer_store_dwordx2 v[2:3], v6, s[16:19], s60 offen sc1
s_mov_b64 exec, -1
L_Q_ml13:
s_setprio 0
s_waitcnt vmcnt(3)
s_add_u32 s63, s7, 65536
buffer_load_dwordx4 v[100:103], v0, s[12:15], s63 offen offset:1024 nt
s_waitcnt vmcnt(3)
s_add_u32 s63, s7, 65536
buffer_load_dwordx4 v[104:107], v0, s[12:15], s63 offen offset:2048 nt
s_waitcnt vmcnt(3)
s_add_u32 s63, s7, 65536
buffer_load_dwordx4 v[108:111], v0, s[12:15], s63 offen offset:3072 nt
v_perm_b32 v160, v68, v64, s64
v_perm_b32 v161, v76, v72, s64
v_perm_b32 v162, v84, v80, s64
v_perm_b32 v163, v92, v88, s64
v_perm_b32 v164, v68, v64, s65
v_perm_b32 v165, v76, v72, s65
v_perm_b32 v166, v84, v80, s65
v_perm_b32 v167, v92, v88, s65
v_mfma_f32_16x16x32_bf16 v[48:51], v[160:163], v[16:19], 0
s_nop 0
v_mfma_f32_16x16x32_bf16 v[52:55], v[164:167], v[16:19], 0
v_perm_b32 v168, v69, v65, s64
v_perm_b32 v169, v77, v73, s64
v_perm_b32 v170, v85, v81, s64
v_perm_b32 v171, v93, v89, s64
v_perm_b32 v172, v69, v65, s65
v_perm_b32 v173, v77, v73, s65
v_perm_b32 v174, v85, v81, s65
v_perm_b32 v175, v93, v89, s65
v_mfma_f32_16x16x32_bf16 v[56:59], v[168:171], v[16:19], 0
s_nop 0
v_mfma_f32_16x16x32_bf16 v[60:63], v[172:175], v[16:19], 0
v_perm_b32 v160, v70, v66, s64
v_perm_b32 v161, v78, v74, s64
v_perm_b32 v162, v86, v82, s64
v_perm_b32 v163, v94, v90, s64
v_perm_b32 v164, v70, v66, s65
v_perm_b32 v165, v78, v74, s65
v_perm_b32 v166, v86, v82, s65
v_perm_b32 v167, v94, v90, s65
v_mfma_f32_16x16x32_bf16 v[48:51], v[160:163], v[32:35], v[48:51]
s_nop 0
v_mfma_f32_16x16x32_bf16 v[52:55], v[164:167], v[32:35], v[52:55]
v_perm_b32 v168, v71, v67, s64
v_perm_b32 v169, v79, v75, s64
v_perm_b32 v170, v87, v83, s64
v_perm_b32 v171, v95, v91, s64
v_perm_b32 v172, v71, v67, s65
v_perm_b32 v173, v79, v75, s65
v_perm_b32 v174, v87, v83, s65
v_perm_b32 v175, v95, v91, s65
v_mfma_f32_16x16x32_bf16 v[56:59], v[168:171], v[32:35], v[56:59]
s_nop 0
v_mfma_f32_16x16x32_bf16 v[60:63], v[172:175], v[32:35], v[60:63]
s_waitcnt vmcnt(3)
s_add_u32 s63, s7, 98304
buffer_load_dwordx4 v[112:115], v0, s[12:15], s63 offen offset:0 nt
s_waitcnt vmcnt(3)
s_add_u32 s63, s7, 98304
buffer_load_dwordx4 v[116:119], v0, s[12:15], s63 offen offset:1024 nt
s_waitcnt vmcnt(3)
s_add_u32 s63, s7, 98304
buffer_load_dwordx4 v[120:123], v0, s[12:15], s63 offen offset:2048 nt
s_waitcnt vmcnt(3)
s_add_u32 s63, s7, 98304
buffer_load_dwordx4 v[124:127], v0, s[12:15], s63 offen offset:3072 nt
s_waitcnt vmcnt(3)
s_add_u32 s63, s7, 131072
buffer_load_dwordx4 v[128:131], v0, s[12:15], s63 offen offset:0 nt
s_waitcnt vmcnt(3)
s_add_u32 s63, s7, 131072
buffer_load_dwordx4 v[132:135], v0, s[12:15], s63 offen offset:1024 nt
s_waitcnt vmcnt(3)
s_add_u32 s63, s7, 131072
buffer_load_dwordx4 v[136:139], v0, s[12:15], s63 offen offset:2048 nt
s_waitcnt vmcnt(3)
s_add_u32 s63, s7, 131072
buffer_load_dwordx4 v[140:143], v0, s[12:15], s63 offen offset:3072 nt
v_perm_b32 v64, v100, v96, s64
v_perm_b32 v65, v108, v104, s64
v_perm_b32 v66, v116, v112, s64
v_perm_b32 v67, v124, v120, s64
v_perm_b32 v68, v100, v96, s65
v_perm_b32 v69, v108, v104, s65
v_perm_b32 v70, v116, v112, s65
v_perm_b32 v71, v124, v120, s65
v_mfma_f32_16x16x32_bf16 v[48:51], v[64:67], v[20:23], v[48:51]
s_nop 0
v_mfma_f32_16x16x32_bf16 v[52:55], v[68:71], v[20:23], v[52:55]
v_perm_b32 v72, v101, v97, s64
v_perm_b32 v73, v109, v105, s64
v_perm_b32 v74, v117, v113, s64
v_perm_b32 v75, v125, v121, s64
v_perm_b32 v76, v101, v97, s65
v_perm_b32 v77, v109, v105, s65
v_perm_b32 v78, v117, v113, s65
v_perm_b32 v79, v125, v121, s65
v_mfma_f32_16x16x32_bf16 v[56:59], v[72:75], v[20:23], v[56:59]
s_nop 0
v_mfma_f32_16x16x32_bf16 v[60:63], v[76:79], v[20:23], v[60:63]
v_perm_b32 v64, v102, v98, s64
v_perm_b32 v65, v110, v106, s64
v_perm_b32 v66, v118, v114, s64
v_perm_b32 v67, v126, v122, s64
v_perm_b32 v68, v102, v98, s65
v_perm_b32 v69, v110, v106, s65
v_perm_b32 v70, v118, v114, s65
v_perm_b32 v71, v126, v122, s65
v_mfma_f32_16x16x32_bf16 v[48:51], v[64:67], v[36:39], v[48:51]
s_nop 0
v_mfma_f32_16x16x32_bf16 v[52:55], v[68:71], v[36:39], v[52:55]
v_perm_b32 v72, v103, v99, s64
v_perm_b32 v73, v111, v107, s64
v_perm_b32 v74, v119, v115, s64
v_perm_b32 v75, v127, v123, s64
v_perm_b32 v76, v103, v99, s65
v_perm_b32 v77, v111, v107, s65
v_perm_b32 v78, v119, v115, s65
v_perm_b32 v79, v127, v123, s65
v_mfma_f32_16x16x32_bf16 v[56:59], v[72:75], v[36:39], v[56:59]
s_nop 0
v_mfma_f32_16x16x32_bf16 v[60:63], v[76:79], v[36:39], v[60:63]
s_waitcnt vmcnt(3)
s_add_u32 s63, s7, 163840
buffer_load_dwordx4 v[144:147], v0, s[12:15], s63 offen offset:0 nt
s_waitcnt vmcnt(3)
s_add_u32 s63, s7, 163840
buffer_load_dwordx4 v[148:151], v0, s[12:15], s63 offen offset:1024 nt
s_waitcnt vmcnt(3)
s_add_u32 s63, s7, 163840
buffer_load_dwordx4 v[152:155], v0, s[12:15], s63 offen offset:2048 nt
s_waitcnt vmcnt(3)
s_add_u32 s63, s7, 163840
buffer_load_dwordx4 v[156:159], v0, s[12:15], s63 offen offset:3072 nt
s_waitcnt vmcnt(3)
s_add_u32 s63, s7, 196608
buffer_load_dwordx4 v[160:163], v0, s[12:15], s63 offen offset:0 nt
s_waitcnt vmcnt(3)
s_add_u32 s63, s7, 196608
buffer_load_dwordx4 v[164:167], v0, s[12:15], s63 offen offset:1024 nt
s_waitcnt vmcnt(3)
s_add_u32 s63, s7, 196608
buffer_load_dwordx4 v[168:171], v0, s[12:15], s63 offen offset:2048 nt
s_waitcnt vmcnt(3)
s_lshr_b32 s75, s5, 4
s_lshl_b32 s75, s75, 11
s_add_u32 s75, s75, 131072
v_lshrrev_b32 v2, 3, v1
v_lshlrev_b32 v2, 7, v2
v_and_b32 v3, 7, v1
v_lshl_add_u32 v2, v3, 3, v2
buffer_load_dwordx2 v[6:7], v2, s[16:19], s75 offen offset:0 sc1
buffer_load_dwordx2 v[8:9], v2, s[16:19], s75 offen offset:1024 sc1
v_perm_b32 v64, v132, v128, s64
v_perm_b32 v65, v140, v136, s64
v_perm_b32 v66, v148, v144, s64
v_perm_b32 v67, v156, v152, s64
v_perm_b32 v68, v132, v128, s65
v_perm_b32 v69, v140, v136, s65
v_perm_b32 v70, v148, v144, s65
v_perm_b32 v71, v156, v152, s65
v_mfma_f32_16x16x32_bf16 v[48:51], v[64:67], v[24:27], v[48:51]
s_nop 0
v_mfma_f32_16x16x32_bf16 v[52:55], v[68:71], v[24:27], v[52:55]
v_perm_b32 v72, v133, v129, s64
v_perm_b32 v73, v141, v137, s64
v_perm_b32 v74, v149, v145, s64
v_perm_b32 v75, v157, v153, s64
v_perm_b32 v76, v133, v129, s65
v_perm_b32 v77, v141, v137, s65
v_perm_b32 v78, v149, v145, s65
v_perm_b32 v79, v157, v153, s65
v_mfma_f32_16x16x32_bf16 v[56:59], v[72:75], v[24:27], v[56:59]
s_nop 0
v_mfma_f32_16x16x32_bf16 v[60:63], v[76:79], v[24:27], v[60:63]
v_perm_b32 v64, v134, v130, s64
v_perm_b32 v65, v142, v138, s64
v_perm_b32 v66, v150, v146, s64
v_perm_b32 v67, v158, v154, s64
v_perm_b32 v68, v134, v130, s65
v_perm_b32 v69, v142, v138, s65
v_perm_b32 v70, v150, v146, s65
v_perm_b32 v71, v158, v154, s65
v_mfma_f32_16x16x32_bf16 v[48:51], v[64:67], v[40:43], v[48:51]
s_nop 0
v_mfma_f32_16x16x32_bf16 v[52:55], v[68:71], v[40:43], v[52:55]
v_perm_b32 v72, v135, v131, s64
v_perm_b32 v73, v143, v139, s64
v_perm_b32 v74, v151, v147, s64
v_perm_b32 v75, v159, v155, s64
v_perm_b32 v76, v135, v131, s65
v_perm_b32 v77, v143, v139, s65
v_perm_b32 v78, v151, v147, s65
v_perm_b32 v79, v159, v155, s65
v_mfma_f32_16x16x32_bf16 v[56:59], v[72:75], v[40:43], v[56:59]
s_nop 0
v_mfma_f32_16x16x32_bf16 v[60:63], v[76:79], v[40:43], v[60:63]
s_waitcnt vmcnt(3)
s_add_u32 s63, s7, 196608
buffer_load_dwordx4 v[172:175], v0, s[12:15], s63 offen offset:3072 nt
s_waitcnt vmcnt(3)
s_add_u32 s63, s7, 229376
buffer_load_dwordx4 v[176:179], v0, s[12:15], s63 offen offset:0 nt
s_waitcnt vmcnt(3)
s_add_u32 s63, s7, 229376
buffer_load_dwordx4 v[180:183], v0, s[12:15], s63 offen offset:1024 nt
s_waitcnt vmcnt(3)
s_add_u32 s63, s7, 229376
buffer_load_dwordx4 v[184:187], v0, s[12:15], s63 offen offset:2048 nt
v_max_u32 v3, v6, v7
v_max3_u32 v3, v3, v8, v9
v_cmp_eq_u32 vcc, -1, v3
s_cbranch_vccz L_Q_ok14
s_mov_b32 s70, 0
L_Q_retry15:
buffer_load_dwordx2 v[6:7], v2, s[16:19], s75 offen offset:0 sc1
buffer_load_dwordx2 v[8:9], v2, s[16:19], s75 offen offset:1024 sc1
s_waitcnt vmcnt(0)
v_max_u32 v3, v6, v7
v_max3_u32 v3, v3, v8, v9
s_add_u32 s70, s70, 1
s_cmp_ge_u32 s70, 262144
s_cbranch_scc1 L_Q_ok14
v_cmp_eq_u32 vcc, -1, v3
s_cbranch_vccnz L_Q_retry15
L_Q_ok14:
v_max_f32 v3, v6, v8
v_sub_f32 v6, v6, v3
v_sub_f32 v8, v8, v3
v_mul_f32 v6, 0x3fb8aa3b, v6
v_mul_f32 v8, 0x3fb8aa3b, v8
v_exp_f32 v6, v6
v_exp_f32 v8, v8
v_mul_f32 v7, v7, v6
v_fmac_f32 v7, v9, v8
v_max_f32_dpp v6, v3, v3 row_ror:8 row_mask:0xf bank_mask:0xf
v_mov_b32 v9, v6
s_nop 1
v_permlane16_swap_b32 v6, v9
v_max_f32 v6, v6, v9
v_mov_b32 v9, v6
s_nop 1
v_permlane32_swap_b32 v6, v9
v_max_f32 v6, v6, v9
v_sub_f32 v9, v3, v6
v_mul_f32 v9, 0x3fb8aa3b, v9
v_exp_f32 v9, v9
s_nop 0
v_mul_f32 v8, v7, v9
s_nop 1
v_add_f32_dpp v8, v8, v8 row_ror:8 row_mask:0xf bank_mask:0xf
v_mov_b32 v9, v8
s_nop 1
v_permlane16_swap_b32 v8, v9
v_add_f32 v8, v8, v9
v_mov_b32 v9, v8
s_nop 1
v_permlane32_swap_b32 v8, v9
v_add_f32 v8, v8, v9
v_sub_f32 v4, v4, v6
v_mul_f32 v4, 0x3fb8aa3b, v4
v_exp_f32 v4, v4
v_rcp_f32 v8, v8
s_nop 0
v_mul_f32 v5, v4, v8
s_mul_i32 s60, s3, 4864
s_add_u32 s60, s60, 0
v_and_b32 v6, 7, v1
v_mul_u32_u24 v6, 592, v6
v_lshrrev_b32 v3, 4, v1
v_mul_u32_u24 v3, 144, v3
v_add_u32 v6, v3, v6
v_bfe_u32 v3, v1, 3, 1
v_lshl_add_u32 v6, v3, 6, v6
v_add_u32 v6, s60, v6
s_mul_i32 s60, s3, 592
s_add_u32 s60, s60, 0
v_lshrrev_b32 v7, 4, v1
v_mul_u32_u24 v7, 144, v7
v_bfe_u32 v3, v1, 1, 1
v_lshl_add_u32 v7, v3, 6, v7
v_and_b32 v3, 1, v1
v_lshl_add_u32 v7, v3, 5, v7
v_bfe_u32 v3, v1, 2, 2
v_lshl_add_u32 v7, v3, 2, v7
v_add_u32 v7, s60, v7
v_add_u32 v8, 16, v7
v_lshlrev_b32 v9, 2, v1
s_lshl_b32 s75, s5, 11
s_lshl_b32 s61, s3, 8
s_add_u32 s75, s75, s61
s_add_u32 s75, s75, 262144
s_waitcnt vmcnt(3)
s_add_u32 s63, s7, 229376
buffer_load_dwordx4 v[188:191], v0, s[12:15], s63 offen offset:3072 nt
s_waitcnt vmcnt(0)
v_perm_b32 v64, v164, v160, s64
v_perm_b32 v65, v172, v168, s64
v_perm_b32 v66, v180, v176, s64
v_perm_b32 v67, v188, v184, s64
v_perm_b32 v68, v164, v160, s65
v_perm_b32 v69, v172, v168, s65
v_perm_b32 v70, v180, v176, s65
v_perm_b32 v71, v188, v184, s65
v_mfma_f32_16x16x32_bf16 v[48:51], v[64:67], v[28:31], v[48:51]
s_nop 0
v_mfma_f32_16x16x32_bf16 v[52:55], v[68:71], v[28:31], v[52:55]
v_perm_b32 v72, v165, v161, s64
v_perm_b32 v73, v173, v169, s64
v_perm_b32 v74, v181, v177, s64
v_perm_b32 v75, v189, v185, s64
v_perm_b32 v76, v165, v161, s65
v_perm_b32 v77, v173, v169, s65
v_perm_b32 v78, v181, v177, s65
v_perm_b32 v79, v189, v185, s65
v_mfma_f32_16x16x32_bf16 v[56:59], v[72:75], v[28:31], v[56:59]
s_nop 0
v_mfma_f32_16x16x32_bf16 v[60:63], v[76:79], v[28:31], v[60:63]
v_perm_b32 v64, v166, v162, s64
v_perm_b32 v65, v174, v170, s64
v_perm_b32 v66, v182, v178, s64
v_perm_b32 v67, v190, v186, s64
v_perm_b32 v68, v166, v162, s65
v_perm_b32 v69, v174, v170, s65
v_perm_b32 v70, v182, v178, s65
v_perm_b32 v71, v190, v186, s65
v_mfma_f32_16x16x32_bf16 v[48:51], v[64:67], v[44:47], v[48:51]
s_nop 0
v_mfma_f32_16x16x32_bf16 v[52:55], v[68:71], v[44:47], v[52:55]
v_perm_b32 v72, v167, v163, s64
v_perm_b32 v73, v175, v171, s64
v_perm_b32 v74, v183, v179, s64
v_perm_b32 v75, v191, v187, s64
v_perm_b32 v76, v167, v163, s65
v_perm_b32 v77, v175, v171, s65
v_perm_b32 v78, v183, v179, s65
v_perm_b32 v79, v191, v187, s65
v_mfma_f32_16x16x32_bf16 v[56:59], v[72:75], v[44:47], v[56:59]
s_nop 0
v_mfma_f32_16x16x32_bf16 v[60:63], v[76:79], v[44:47], v[60:63]
v_pk_mul_f32 v[48:49], v[48:49], v[4:5] op_sel:[0,1] op_sel_hi:[1,1]
v_pk_mul_f32 v[50:51], v[50:51], v[4:5] op_sel:[0,1] op_sel_hi:[1,1]
ds_write_b128 v6, v[48:51] offset:0
v_pk_mul_f32 v[52:53], v[52:53], v[4:5] op_sel:[0,1] op_sel_hi:[1,1]
v_pk_mul_f32 v[54:55], v[54:55], v[4:5] op_sel:[0,1] op_sel_hi:[1,1]
ds_write_b128 v6, v[52:55] offset:16
v_pk_mul_f32 v[56:57], v[56:57], v[4:5] op_sel:[0,1] op_sel_hi:[1,1]
v_pk_mul_f32 v[58:59], v[58:59], v[4:5] op_sel:[0,1] op_sel_hi:[1,1]
ds_write_b128 v6, v[56:59] offset:32
v_pk_mul_f32 v[60:61], v[60:61], v[4:5] op_sel:[0,1] op_sel_hi:[1,1]
v_pk_mul_f32 v[62:63], v[62:63], v[4:5] op_sel:[0,1] op_sel_hi:[1,1]
ds_write_b128 v6, v[60:63] offset:48
s_waitcnt lgkmcnt(0)
s_barrier
ds_read2st64_b32 v[16:17], v7 offset0:0 offset1:19
ds_read2st64_b32 v[24:25], v8 offset0:0 offset1:19
ds_read2st64_b32 v[18:19], v7 offset0:38 offset1:57
ds_read2st64_b32 v[26:27], v8 offset0:38 offset1:57
ds_read2st64_b32 v[20:21], v7 offset0:76 offset1:95
ds_read2st64_b32 v[28:29], v8 offset0:76 offset1:95
ds_read2st64_b32 v[22:23], v7 offset0:114 offset1:133
ds_read2st64_b32 v[30:31], v8 offset0:114 offset1:133
s_waitcnt lgkmcnt(0)
v_pk_add_f32 v[16:17], v[16:17], v[20:21]
v_pk_add_f32 v[18:19], v[18:19], v[22:23]
v_pk_add_f32 v[24:25], v[24:25], v[28:29]
v_pk_add_f32 v[26:27], v[26:27], v[30:31]
v_pk_add_f32 v[16:17], v[16:17], v[18:19]
v_pk_add_f32 v[24:25], v[24:25], v[26:27]
v_add_f32 v16, v16, v17
v_add_f32 v24, v24, v25
v_cvt_pk_bf16_f32 v20, v16, v24
s_nop 1
v_mov_b32_dpp v21, v20 quad_perm:[1,1,1,1] row_mask:0xf bank_mask:0xf
v_mov_b32_dpp v22, v20 quad_perm:[2,2,2,2] row_mask:0xf bank_mask:0xf
v_mov_b32_dpp v23, v20 quad_perm:[3,3,3,3] row_mask:0xf bank_mask:0xf
s_mov_b32 exec_lo, 0x11111111
s_mov_b32 exec_hi, 0x11111111
buffer_store_dwordx4 v[20:23], v9, s[16:19], s75 offen sc1
s_mov_b64 exec, -1
s_mov_b32 s24, s44
s_mov_b32 s25, s45
s_mov_b32 s26, 0x700000
s_mov_b32 s27, 0x20000
s_mov_b32 s20, s46
s_mov_b32 s21, s47
s_mov_b32 s22, 0x700000
s_mov_b32 s23, 0x20000
s_sub_u32 s60, s4, 13
s_cmp_ge_u32 s60, 14
s_cbranch_scc1 L_Q_h616
s_lshl_b32 s60, s60, 3
s_add_u32 s60, s60, s3
s_add_u32 s61, s2, 1
s_and_b32 s61, s61, 7
s_lshl_b32 s61, s61, 7
v_lshrrev_b32 v15, 3, v1
v_lshlrev_b32 v15, 10, v15
v_and_b32 v14, 7, v1
v_lshl_add_u32 v15, v14, 4, v15
v_add_u32 v15, s61, v15
s_add_u32 s61, s60, 0
s_mul_i32 s62, s61, 2341
s_lshr_b32 s62, s62, 16
s_mul_i32 s62, s62, 672
s_lshl_b32 s61, s61, 3
s_add_u32 s62, s62, s61
s_add_u32 s62, s62, 672
s_lshl_b32 s62, s62, 10
s_waitcnt vmcnt(4)
buffer_load_dwordx4 v[252:255], v15, s[24:27], s62 offen
buffer_load_dwordx4 v[252:255], v15, s[20:23], s62 offen
s_add_u32 s61, s60, 112
s_mul_i32 s62, s61, 2341
s_lshr_b32 s62, s62, 16
s_mul_i32 s62, s62, 672
s_lshl_b32 s61, s61, 3
s_add_u32 s62, s62, s61
s_add_u32 s62, s62, 672
s_lshl_b32 s62, s62, 10
s_waitcnt vmcnt(4)
buffer_load_dwordx4 v[252:255], v15, s[24:27], s62 offen
buffer_load_dwordx4 v[252:255], v15, s[20:23], s62 offen
L_Q_h616:
s_mov_b32 s24, s48
s_mov_b32 s25, s49
s_mov_b32 s26, 0x700000
s_mov_b32 s27, 0x20000
s_sub_u32 s60, s4, 13
s_lshr_b32 s62, s60, 1
s_lshl_b32 s62, s62, 3
s_add_u32 s61, s2, 1
s_and_b32 s61, s61, 7
s_add_u32 s62, s62, s61
s_lshl_b32 s62, s62, 17
s_and_b32 s60, s60, 1
s_lshl_b32 s60, s60, 15
s_add_u32 s62, s62, s60
s_add_u32 s62, s62, s6
s_cmp_ge_u32 s62, 7340032
s_cbranch_scc1 L_Q_h517
s_add_u32 s63, s62, 0
buffer_load_dwordx4 v[252:255], v0, s[24:27], s63 offen offset:0
s_waitcnt vmcnt(1)
buffer_load_dwordx4 v[252:255], v0, s[24:27], s63 offen offset:1024
s_waitcnt vmcnt(1)
buffer_load_dwordx4 v[252:255], v0, s[24:27], s63 offen offset:2048
s_waitcnt vmcnt(1)
buffer_load_dwordx4 v[252:255], v0, s[24:27], s63 offen offset:3072
s_add_u32 s63, s62, 65536
s_waitcnt vmcnt(1)
buffer_load_dwordx4 v[252:255], v0, s[24:27], s63 offen offset:0
s_waitcnt vmcnt(1)
buffer_load_dwordx4 v[252:255], v0, s[24:27], s63 offen offset:1024
s_waitcnt vmcnt(1)
buffer_load_dwordx4 v[252:255], v0, s[24:27], s63 offen offset:2048
s_waitcnt vmcnt(1)
buffer_load_dwordx4 v[252:255], v0, s[24:27], s63 offen offset:3072
L_Q_h517:
s_endpgm
.p2align 6
L_class_P:
s_waitcnt lgkmcnt(0)
s_mov_b32 s8, s34
s_mov_b32 s9, s35
s_mov_b32 s16, s58
s_mov_b32 s17, s59
s_mov_b32 s18, 0x10000000
s_mov_b32 s19, 0x20000
v_mov_b32 v4, -1
v_mov_b32 v5, -1
v_mov_b32 v6, -1
v_mov_b32 v7, -1
s_mov_b32 s20, s52
s_mov_b32 s21, s53
s_mov_b32 s22, 0xc00000
s_mov_b32 s23, 0x20000
s_mov_b32 s24, s50
s_mov_b32 s25, s51
s_mov_b32 s26, 0x2000
s_mov_b32 s27, 0x20000
s_sub_u32 s61, s2, 183
s_cmp_ge_u32 s61, 32
s_cselect_b32 s60, 32, 0
s_sub_u32 s61, s61, s60
s_lshl_b32 s72, s61, 7
s_lshr_b32 s73, s61, 4
s_lshl_b32 s73, s73, 13
s_and_b32 s60, s61, 15
s_lshl_b32 s60, s60, 7
s_add_u32 s73, s73, s60
v_lshrrev_b32 v10, 3, v1
v_mul_u32_u24 v10, 98304, v10
v_and_b32 v3, 7, v1
v_lshl_add_u32 v10, v3, 4, v10
s_mul_i32 s74, s3, 1572864
s_add_u32 s74, s74, s72
v_lshrrev_b32 v11, 5, v1
v_lshlrev_b32 v11, 11, v11
v_and_b32 v3, 15, v1
v_lshl_add_u32 v11, v3, 4, v11
v_bfe_u32 v3, v1, 4, 1
v_lshl_add_u32 v11, v3, 3, v11
s_lshl_b32 s78, s3, 8
s_cmp_lg_u32 s3, 0
s_cbranch_scc1 L_P_clr1
s_setprio 3
v_bfe_u32 v2, v1, 3, 2
v_lshlrev_b32 v2, 11, v2
v_and_b32 v3, 7, v1
v_lshl_add_u32 v2, v3, 4, v2
s_mov_b32 exec_lo, 0xffffffff
s_mov_b32 exec_hi, 0x0
buffer_store_dwordx4 v[4:7], v2, s[16:19], s73 offen sc1
s_mov_b64 exec, -1
s_lshl_b32 s60, s5, 11
s_add_u32 s60, s60, 262144
buffer_store_dwordx4 v[4:7], v0, s[16:19], s60 offen sc1
buffer_store_dwordx4 v[4:7], v0, s[16:19], s60 offen offset:1024 sc1
s_lshl_b32 s60, s5, 7
s_add_u32 s60, s60, 131072
s_mov_b32 exec_lo, 0xff
s_mov_b32 exec_hi, 0x0
buffer_store_dwordx4 v[4:7], v0, s[16:19], s60 offen sc1
s_mov_b64 exec, -1
v_mov_b32 v8, 0
v_mov_b32 v9, 0
v_lshlrev_b32 v2, 3, v1
ds_write_b64 v2, v[8:9] offset:49152
ds_write_b32 v8, v8 offset:50176
s_setprio 0
L_P_clr1:
s_add_u32 s63, s78, 0
buffer_load_dwordx2 v[16:17], v11, s[24:27], s63 offen
s_add_u32 s63, s78, 4096
buffer_load_dwordx2 v[18:19], v11, s[24:27], s63 offen
s_add_u32 s63, s74, 0
buffer_load_dwordx4 v[64:67], v10, s[20:23], s63 offen nt
s_add_u32 s63, s74, 12288
buffer_load_dwordx4 v[68:71], v10, s[20:23], s63 offen nt
s_add_u32 s63, s74, 24576
buffer_load_dwordx4 v[72:75], v10, s[20:23], s63 offen nt
s_add_u32 s63, s74, 36864
buffer_load_dwordx4 v[76:79], v10, s[20:23], s63 offen nt
s_add_u32 s63, s74, 49152
buffer_load_dwordx4 v[80:83], v10, s[20:23], s63 offen nt
s_add_u32 s63, s74, 61440
buffer_load_dwordx4 v[84:87], v10, s[20:23], s63 offen nt
s_add_u32 s63, s74, 73728
buffer_load_dwordx4 v[88:91], v10, s[20:23], s63 offen nt
s_add_u32 s63, s74, 86016
buffer_load_dwordx4 v[92:95], v10, s[20:23], s63 offen nt
s_add_u32 s63, s74, 786432
buffer_load_dwordx4 v[96:99], v10, s[20:23], s63 offen nt
s_add_u32 s63, s74, 798720
buffer_load_dwordx4 v[100:103], v10, s[20:23], s63 offen nt
s_add_u32 s63, s74, 811008
buffer_load_dwordx4 v[104:107], v10, s[20:23], s63 offen nt
s_add_u32 s63, s74, 823296
buffer_load_dwordx4 v[108:111], v10, s[20:23], s63 offen nt
s_add_u32 s63, s74, 835584
buffer_load_dwordx4 v[112:115], v10, s[20:23], s63 offen nt
s_add_u32 s63, s74, 847872
buffer_load_dwordx4 v[116:119], v10, s[20:23], s63 offen nt
s_add_u32 s63, s74, 860160
buffer_load_dwordx4 v[120:123], v10, s[20:23], s63 offen nt
s_add_u32 s63, s74, 872448
buffer_load_dwordx4 v[124:127], v10, s[20:23], s63 offen nt
s_mov_b32 s12, s36
s_mov_b32 s13, s37
s_mov_b32 s14, 0x4000000
s_mov_b32 s15, 0x20000
s_mov_b32 s28, s56
s_mov_b32 s29, s57
s_mov_b32 s30, 0x100
s_mov_b32 s31, 0x20000
s_mov_b32 s64, 0x05040100
s_mov_b32 s65, 0x07060302
s_lshl_b32 s60, s3, 12
v_lshrrev_b32 v6, 4, v1
v_lshlrev_b32 v7, 2, v6
v_xor_b32 v7, v7, v1
v_and_b32 v7, 15, v7
v_lshlrev_b32 v7, 4, v7
v_lshl_add_u32 v2, v6, 8, v7
v_add_u32 v2, s60, v2
v_xor_b32 v3, 16, v2
v_xor_b32 v4, 32, v2
v_xor_b32 v5, 48, v2
v_xor_b32 v7, v6, v1
v_and_b32 v7, 15, v7
v_lshlrev_b32 v7, 4, v7
v_and_b32 v8, 3, v1
v_lshl_add_u32 v7, v8, 10, v7
v_bfe_u32 v8, v1, 2, 2
v_lshl_add_u32 v7, v8, 8, v7
v_add_u32 v6, s60, v7
v_xor_b32 v7, 64, v6
v_xor_b32 v8, 128, v6
v_xor_b32 v9, 192, v6
s_cmp_lg_u32 s3, 0
s_cbranch_scc1 L_P_arr2
s_waitcnt vmcnt(18) lgkmcnt(0)
s_mov_b32 s60, 1
s_atomic_add s60, s[56:57], 128
s_mov_b32 s60, 1
s_atomic_add s60, s[56:57], 0
L_P_arr2:
s_barrier
s_waitcnt vmcnt(16)
s_lshl_b32 s60, s3, 10
s_add_u32 s60, s60, 40960
v_lshrrev_b32 v12, 5, v1
v_lshlrev_b32 v12, 8, v12
v_and_b32 v20, 15, v1
v_lshl_add_u32 v12, v20, 4, v12
v_bfe_u32 v20, v1, 4, 1
v_lshl_add_u32 v12, v20, 3, v12
v_add_u32 v12, s60, v12
v_lshlrev_b32 v20, 16, v16
v_and_b32 v21, 0xffff0000, v16
v_mul_f32 v22, 0xbfb8aa3b, v20
v_mul_f32 v23, 0xbfb8aa3b, v21
v_exp_f32 v22, v22
v_exp_f32 v23, v23
v_add_f32 v22, 1.0, v22
v_add_f32 v23, 1.0, v23
v_rcp_f32 v24, v22
v_rcp_f32 v25, v23
v_mul_f32 v26, v20, v24
v_mul_f32 v27, v21, v25
v_cvt_pk_bf16_f32 v16, v26, v27
v_lshlrev_b32 v20, 16, v17
v_and_b32 v21, 0xffff0000, v17
v_mul_f32 v22, 0xbfb8aa3b, v20
v_mul_f32 v23, 0xbfb8aa3b, v21
v_exp_f32 v22, v22
v_exp_f32 v23, v23
v_add_f32 v22, 1.0, v22
v_add_f32 v23, 1.0, v23
v_rcp_f32 v24, v22
v_rcp_f32 v25, v23
v_mul_f32 v26, v20, v24
v_mul_f32 v27, v21, v25
v_cvt_pk_bf16_f32 v17, v26, v27
v_lshlrev_b32 v20, 16, v18
v_and_b32 v21, 0xffff0000, v18
v_mul_f32 v22, 0xbfb8aa3b, v20
v_mul_f32 v23, 0xbfb8aa3b, v21
v_exp_f32 v22, v22
v_exp_f32 v23, v23
v_add_f32 v22, 1.0, v22
v_add_f32 v23, 1.0, v23
v_rcp_f32 v24, v22
v_rcp_f32 v25, v23
v_mul_f32 v26, v20, v24
v_mul_f32 v27, v21, v25
v_cvt_pk_bf16_f32 v18, v26, v27
v_lshlrev_b32 v20, 16, v19
v_and_b32 v21, 0xffff0000, v19
v_mul_f32 v22, 0xbfb8aa3b, v20
v_mul_f32 v23, 0xbfb8aa3b, v21
v_exp_f32 v22, v22
v_exp_f32 v23, v23
v_add_f32 v22, 1.0, v22
v_add_f32 v23, 1.0, v23
v_rcp_f32 v24, v22
v_rcp_f32 v25, v23
v_mul_f32 v26, v20, v24
v_mul_f32 v27, v21, v25
v_cvt_pk_bf16_f32 v19, v26, v27
ds_write_b64 v12, v[16:17]
ds_write_b64 v12, v[18:19] offset:512
s_waitcnt vmcnt(8)
v_perm_b32 v32, v68, v64, s64
v_perm_b32 v33, v76, v72, s64
v_perm_b32 v34, v84, v80, s64
v_perm_b32 v35, v92, v88, s64
v_perm_b32 v36, v68, v64, s65
v_perm_b32 v37, v76, v72, s65
v_perm_b32 v38, v84, v80, s65
v_perm_b32 v39, v92, v88, s65
v_perm_b32 v40, v69, v65, s64
v_perm_b32 v41, v77, v73, s64
v_perm_b32 v42, v85, v81, s64
v_perm_b32 v43, v93, v89, s64
v_perm_b32 v44, v69, v65, s65
v_perm_b32 v45, v77, v73, s65
v_perm_b32 v46, v85, v81, s65
v_perm_b32 v47, v93, v89, s65
v_perm_b32 v48, v70, v66, s64
v_perm_b32 v49, v78, v74, s64
v_perm_b32 v50, v86, v82, s64
v_perm_b32 v51, v94, v90, s64
v_perm_b32 v52, v70, v66, s65
v_perm_b32 v53, v78, v74, s65
v_perm_b32 v54, v86, v82, s65
v_perm_b32 v55, v94, v90, s65
v_perm_b32 v56, v71, v67, s64
v_perm_b32 v57, v79, v75, s64
v_perm_b32 v58, v87, v83, s64
v_perm_b32 v59, v95, v91, s64
v_perm_b32 v60, v71, v67, s65
v_perm_b32 v61, v79, v75, s65
v_perm_b32 v62, v87, v83, s65
v_perm_b32 v63, v95, v91, s65
s_waitcnt vmcnt(3)
s_add_u32 s63, s7, 0
buffer_load_dwordx4 v[128:131], v0, s[8:11], s63 offen offset:0 nt
s_waitcnt vmcnt(3)
s_add_u32 s63, s7, 0
buffer_load_dwordx4 v[132:135], v0, s[8:11], s63 offen offset:1024 nt
s_waitcnt vmcnt(3)
s_add_u32 s63, s7, 0
buffer_load_dwordx4 v[136:139], v0, s[8:11], s63 offen offset:2048 nt
s_waitcnt vmcnt(3)
s_add_u32 s63, s7, 0
buffer_load_dwordx4 v[140:143], v0, s[8:11], s63 offen offset:3072 nt
v_perm_b32 v64, v100, v96, s64
v_perm_b32 v65, v108, v104, s64
v_perm_b32 v66, v116, v112, s64
v_perm_b32 v67, v124, v120, s64
v_perm_b32 v68, v100, v96, s65
v_perm_b32 v69, v108, v104, s65
v_perm_b32 v70, v116, v112, s65
v_perm_b32 v71, v124, v120, s65
v_perm_b32 v72, v101, v97, s64
v_perm_b32 v73, v109, v105, s64
v_perm_b32 v74, v117, v113, s64
v_perm_b32 v75, v125, v121, s64
v_perm_b32 v76, v101, v97, s65
v_perm_b32 v77, v109, v105, s65
v_perm_b32 v78, v117, v113, s65
v_perm_b32 v79, v125, v121, s65
v_perm_b32 v80, v102, v98, s64
v_perm_b32 v81, v110, v106, s64
v_perm_b32 v82, v118, v114, s64
v_perm_b32 v83, v126, v122, s64
v_perm_b32 v84, v102, v98, s65
v_perm_b32 v85, v110, v106, s65
v_perm_b32 v86, v118, v114, s65
v_perm_b32 v87, v126, v122, s65
v_perm_b32 v88, v103, v99, s64
v_perm_b32 v89, v111, v107, s64
v_perm_b32 v90, v119, v115, s64
v_perm_b32 v91, v127, v123, s64
v_perm_b32 v92, v103, v99, s65
v_perm_b32 v93, v111, v107, s65
v_perm_b32 v94, v119, v115, s65
v_perm_b32 v95, v127, v123, s65
s_lshl_b32 s60, s3, 10
s_add_u32 s60, s60, 40960
v_and_b32 v12, 3, v1
v_lshlrev_b32 v12, 8, v12
v_lshrrev_b32 v14, 4, v1
v_lshl_add_u32 v12, v14, 5, v12
v_bfe_u32 v14, v1, 3, 1
v_lshl_add_u32 v12, v14, 4, v12
v_add_u32 v12, s60, v12
s_mov_b32 s66, 0x0f0f0f0f
s_mov_b32 s67, 0x0f0f0f0f
v_mov_b32 v14, 49152
v_cndmask_b32 v13, v12, v14, s[66:67]
v_cndmask_b32 v12, v14, v12, s[66:67]
ds_read_b128 v[96:99], v12 offset:0
ds_read_b128 v[100:103], v13 offset:0
ds_read_b128 v[104:107], v12 offset:128
ds_read_b128 v[108:111], v13 offset:128
s_lshl_b32 s60, s3, 11
s_add_u32 s60, s60, 60416
v_lshrrev_b32 v12, 5, v1
v_lshlrev_b32 v12, 10, v12
v_and_b32 v14, 3, v1
v_lshl_add_u32 v12, v14, 8, v12
v_bfe_u32 v14, v1, 2, 1
v_lshl_add_u32 v12, v14, 7, v12
v_bfe_u32 v14, v1, 4, 1
v_lshl_add_u32 v12, v14, 4, v12
v_add_u32 v12, s60, v12
s_waitcnt lgkmcnt(0)
v_mfma_f32_16x16x32_bf16 v[112:115], v[32:35], v[96:99], 0
v_mfma_f32_16x16x32_bf16 v[116:119], v[36:39], v[96:99], 0
v_mfma_f32_16x16x32_bf16 v[120:123], v[40:43], v[96:99], 0
v_mfma_f32_16x16x32_bf16 v[124:127], v[44:47], v[96:99], 0
v_mfma_f32_16x16x32_bf16 v[112:115], v[48:51], v[100:103], v[112:115]
v_mfma_f32_16x16x32_bf16 v[116:119], v[52:55], v[100:103], v[116:119]
v_mfma_f32_16x16x32_bf16 v[120:123], v[56:59], v[100:103], v[120:123]
v_mfma_f32_16x16x32_bf16 v[124:127], v[60:63], v[100:103], v[124:127]
v_mfma_f32_16x16x32_bf16 v[112:115], v[64:67], v[104:107], v[112:115]
v_mfma_f32_16x16x32_bf16 v[116:119], v[68:71], v[104:107], v[116:119]
v_mfma_f32_16x16x32_bf16 v[120:123], v[72:75], v[104:107], v[120:123]
v_mfma_f32_16x16x32_bf16 v[124:127], v[76:79], v[104:107], v[124:127]
v_mfma_f32_16x16x32_bf16 v[112:115], v[80:83], v[108:111], v[112:115]
v_mfma_f32_16x16x32_bf16 v[116:119], v[84:87], v[108:111], v[116:119]
v_mfma_f32_16x16x32_bf16 v[120:123], v[88:91], v[108:111], v[120:123]
v_mfma_f32_16x16x32_bf16 v[124:127], v[92:95], v[108:111], v[124:127]
s_mov_b32 exec_lo, 0xff00ff
s_mov_b32 exec_hi, 0xff00ff00
s_nop 2
ds_write_b128 v12, v[112:115] offset:0
ds_write_b128 v12, v[116:119] offset:32
ds_write_b128 v12, v[120:123] offset:64
ds_write_b128 v12, v[124:127] offset:96
s_mov_b64 exec, -1
s_lshl_b32 s60, s3, 8
s_add_u32 s60, s60, 60416
v_bfe_u32 v13, v1, 2, 1
v_lshlrev_b32 v13, 7, v13
v_and_b32 v14, 3, v1
v_lshl_add_u32 v13, v14, 5, v13
v_lshrrev_b32 v14, 5, v1
v_lshl_add_u32 v13, v14, 4, v13
v_bfe_u32 v14, v1, 3, 2
v_lshl_add_u32 v13, v14, 2, v13
v_add_u32 v13, s60, v13
s_waitcnt lgkmcnt(0)
s_barrier
s_cmp_ge_u32 s3, 4
s_cbranch_scc1 L_P_fin3
ds_read2st64_b32 v[96:97], v13 offset0:0 offset1:4
ds_read2st64_b32 v[98:99], v13 offset0:8 offset1:12
ds_read2st64_b32 v[100:101], v13 offset0:16 offset1:20
ds_read2st64_b32 v[102:103], v13 offset0:24 offset1:28
ds_read2st64_b32 v[104:105], v13 offset0:32 offset1:36
ds_read2st64_b32 v[106:107], v13 offset0:40 offset1:44
ds_read2st64_b32 v[108:109], v13 offset0:48 offset1:52
ds_read2st64_b32 v[110:111], v13 offset0:56 offset1:60
s_mul_i32 s60, s3, 2048
s_add_u32 s60, s60, s73
v_lshlrev_b32 v12, 1, v1
s_waitcnt lgkmcnt(0)
v_add_f32 v96, v96, v104
v_add_f32 v97, v97, v105
v_add_f32 v98, v98, v106
v_add_f32 v99, v99, v107
v_add_f32 v100, v100, v108
v_add_f32 v101, v101, v109
v_add_f32 v102, v102, v110
v_add_f32 v103, v103, v111
v_add_f32 v96, v96, v100
v_add_f32 v97, v97, v101
v_add_f32 v98, v98, v102
v_add_f32 v99, v99, v103
v_add_f32 v96, v96, v98
v_add_f32 v97, v97, v99
v_add_f32 v96, v96, v97
s_nop 1
v_mov_b32_dpp v97, v96 quad_perm:[1,1,3,3] row_mask:0xf bank_mask:0xf
v_cvt_pk_bf16_f32 v112, v96, v97
s_nop 1
v_mov_b32_dpp v113, v112 row_shl:2 row_mask:0xf bank_mask:0xf
v_mov_b32_dpp v114, v112 row_shl:4 row_mask:0xf bank_mask:0xf
v_mov_b32_dpp v115, v112 row_shl:6 row_mask:0xf bank_mask:0xf
s_mov_b32 exec_lo, 0x1010101
s_mov_b32 exec_hi, 0x1010101
buffer_store_dwordx4 v[112:115], v12, s[16:19], s60 offen sc1
s_mov_b64 exec, -1
L_P_fin3:
s_waitcnt vmcnt(3)
s_add_u32 s63, s7, 32768
buffer_load_dwordx4 v[144:147], v0, s[8:11], s63 offen offset:0 nt
s_waitcnt vmcnt(3)
s_add_u32 s63, s7, 32768
buffer_load_dwordx4 v[148:151], v0, s[8:11], s63 offen offset:1024 nt
s_waitcnt vmcnt(3)
s_add_u32 s63, s7, 32768
buffer_load_dwordx4 v[152:155], v0, s[8:11], s63 offen offset:2048 nt
s_waitcnt vmcnt(3)
s_add_u32 s63, s7, 32768
buffer_load_dwordx4 v[156:159], v0, s[8:11], s63 offen offset:3072 nt
ds_write_b128 v2, v[128:131] offset:0
ds_write_b128 v3, v[132:135] offset:1024
ds_write_b128 v4, v[136:139] offset:2048
ds_write_b128 v5, v[140:143] offset:3072
ds_read_b128 v[128:131], v6
ds_read_b128 v[132:135], v7
ds_read_b128 v[136:139], v8
ds_read_b128 v[140:143], v9
s_waitcnt vmcnt(3)
s_add_u32 s63, s7, 65536
buffer_load_dwordx4 v[160:163], v0, s[8:11], s63 offen offset:0 nt
s_waitcnt vmcnt(3)
s_add_u32 s63, s7, 65536
buffer_load_dwordx4 v[164:167], v0, s[8:11], s63 offen offset:1024 nt
s_waitcnt vmcnt(3)
s_add_u32 s63, s7, 65536
buffer_load_dwordx4 v[168:171], v0, s[8:11], s63 offen offset:2048 nt
s_waitcnt vmcnt(3)
s_add_u32 s63, s7, 65536
buffer_load_dwordx4 v[172:175], v0, s[8:11], s63 offen offset:3072 nt
ds_write_b128 v2, v[144:147] offset:0
ds_write_b128 v3, v[148:151] offset:1024
ds_write_b128 v4, v[152:155] offset:2048
ds_write_b128 v5, v[156:159] offset:3072
ds_read_b128 v[144:147], v6
ds_read_b128 v[148:151], v7
ds_read_b128 v[152:155], v8
ds_read_b128 v[156:159], v9
s_waitcnt vmcnt(3)
s_add_u32 s63, s7, 98304
buffer_load_dwordx4 v[176:179], v0, s[8:11], s63 offen offset:0 nt
s_waitcnt vmcnt(3)
s_add_u32 s63, s7, 98304
buffer_load_dwordx4 v[180:183], v0, s[8:11], s63 offen offset:1024 nt
s_waitcnt vmcnt(3)
s_add_u32 s63, s7, 98304
buffer_load_dwordx4 v[184:187], v0, s[8:11], s63 offen offset:2048 nt
s_waitcnt vmcnt(3)
s_add_u32 s63, s7, 98304
buffer_load_dwordx4 v[188:191], v0, s[8:11], s63 offen offset:3072 nt
ds_write_b128 v2, v[160:163] offset:0
ds_write_b128 v3, v[164:167] offset:1024
ds_write_b128 v4, v[168:171] offset:2048
ds_write_b128 v5, v[172:175] offset:3072
ds_read_b128 v[160:163], v6
ds_read_b128 v[164:167], v7
ds_read_b128 v[168:171], v8
ds_read_b128 v[172:175], v9
s_waitcnt vmcnt(3)
s_add_u32 s63, s7, 131072
buffer_load_dwordx4 v[192:195], v0, s[8:11], s63 offen offset:0 nt
s_waitcnt vmcnt(3)
s_add_u32 s63, s7, 131072
buffer_load_dwordx4 v[196:199], v0, s[8:11], s63 offen offset:1024 nt
s_waitcnt vmcnt(3)
s_add_u32 s63, s7, 131072
buffer_load_dwordx4 v[200:203], v0, s[8:11], s63 offen offset:2048 nt
s_waitcnt vmcnt(3)
s_add_u32 s63, s7, 131072
buffer_load_dwordx4 v[204:207], v0, s[8:11], s63 offen offset:3072 nt
ds_write_b128 v2, v[176:179] offset:0
ds_write_b128 v3, v[180:183] offset:1024
ds_write_b128 v4, v[184:187] offset:2048
ds_write_b128 v5, v[188:191] offset:3072
ds_read_b128 v[176:179], v6
ds_read_b128 v[180:183], v7
ds_read_b128 v[184:187], v8
ds_read_b128 v[188:191], v9
s_waitcnt vmcnt(3)
s_mov_b32 s24, s46
s_mov_b32 s25, s47
s_mov_b32 s26, 0x700000
s_mov_b32 s27, 0x20000
s_sub_u32 s62, s2, 184
s_lshl_b32 s62, s62, 3
s_add_u32 s62, s62, s3
s_mul_i32 s62, s62, 16384
s_add_u32 s62, s62, 4194688
v_lshrrev_b32 v15, 3, v1
v_lshlrev_b32 v15, 10, v15
v_and_b32 v252, 7, v1
v_lshl_add_u32 v15, v252, 4, v15
s_min_u32 s62, s62, 7324032
buffer_load_dwordx4 v[252:255], v15, s[24:27], s62 offen
s_add_u32 s62, s62, 8192
buffer_load_dwordx4 v[252:255], v15, s[24:27], s62 offen
s_waitcnt vmcnt(3)
s_add_u32 s63, s7, 163840
buffer_load_dwordx4 v[208:211], v0, s[8:11], s63 offen offset:0 nt
s_waitcnt vmcnt(3)
s_add_u32 s63, s7, 163840
buffer_load_dwordx4 v[212:215], v0, s[8:11], s63 offen offset:1024 nt
ds_write_b128 v2, v[192:195] offset:0
ds_write_b128 v3, v[196:199] offset:1024
ds_write_b128 v4, v[200:203] offset:2048
ds_write_b128 v5, v[204:207] offset:3072
ds_read_b128 v[192:195], v6
ds_read_b128 v[196:199], v7
ds_read_b128 v[200:203], v8
ds_read_b128 v[204:207], v9
s_waitcnt vmcnt(3)
s_add_u32 s63, s7, 163840
buffer_load_dwordx4 v[216:219], v0, s[8:11], s63 offen offset:2048 nt
s_waitcnt vmcnt(3)
s_add_u32 s63, s7, 163840
buffer_load_dwordx4 v[220:223], v0, s[8:11], s63 offen offset:3072 nt
s_waitcnt vmcnt(3)
buffer_load_dword v10, off, s[28:31], 0 offset:0 sc1
s_waitcnt vmcnt(3)
s_add_u32 s63, s7, 196608
buffer_load_dwordx4 v[224:227], v0, s[8:11], s63 offen offset:0 nt
s_waitcnt vmcnt(3)
s_add_u32 s63, s7, 196608
buffer_load_dwordx4 v[228:231], v0, s[8:11], s63 offen offset:1024 nt
s_waitcnt vmcnt(3)
s_add_u32 s63, s7, 196608
buffer_load_dwordx4 v[232:235], v0, s[8:11], s63 offen offset:2048 nt
ds_write_b128 v2, v[208:211] offset:0
ds_write_b128 v3, v[212:215] offset:1024
ds_write_b128 v4, v[216:219] offset:2048
ds_write_b128 v5, v[220:223] offset:3072
ds_read_b128 v[208:211], v6
ds_read_b128 v[212:215], v7
ds_read_b128 v[216:219], v8
ds_read_b128 v[220:223], v9
s_waitcnt vmcnt(3)
s_add_u32 s63, s7, 196608
buffer_load_dwordx4 v[236:239], v0, s[8:11], s63 offen offset:3072 nt
s_waitcnt vmcnt(3)
s_add_u32 s63, s7, 229376
buffer_load_dwordx4 v[240:243], v0, s[8:11], s63 offen offset:0 nt
s_waitcnt vmcnt(3)
s_add_u32 s63, s7, 229376
buffer_load_dwordx4 v[244:247], v0, s[8:11], s63 offen offset:1024 nt
s_waitcnt vmcnt(3)
s_add_u32 s63, s7, 229376
buffer_load_dwordx4 v[248:251], v0, s[8:11], s63 offen offset:2048 nt
s_waitcnt vmcnt(3)
s_add_u32 s63, s7, 229376
buffer_load_dwordx4 v[252:255], v0, s[8:11], s63 offen offset:3072 nt
ds_write_b128 v2, v[224:227] offset:0
ds_write_b128 v3, v[228:231] offset:1024
ds_write_b128 v4, v[232:235] offset:2048
ds_write_b128 v5, v[236:239] offset:3072
ds_read_b128 v[224:227], v6
ds_read_b128 v[228:231], v7
ds_read_b128 v[232:235], v8
ds_read_b128 v[236:239], v9
v_readfirstlane_b32 s60, v10
s_mov_b32 s70, 0
s_cmp_ge_u32 s60, 256
s_cbranch_scc1 L_P_cok4
L_P_cretry5:
buffer_load_dword v10, off, s[28:31], 0 offset:0 sc1
s_waitcnt vmcnt(0)
v_readfirstlane_b32 s60, v10
s_add_u32 s70, s70, 1
s_cmp_ge_u32 s70, 262144
s_cbranch_scc1 L_P_cok4
s_cmp_lt_u32 s60, 256
s_cbranch_scc1 L_P_cretry5
L_P_cok4:
s_waitcnt vmcnt(3)
s_lshr_b32 s75, s5, 4
s_lshl_b32 s75, s75, 11
s_add_u32 s75, s75, 65536
buffer_load_dwordx4 v[16:19], v0, s[16:19], s75 offen offset:0 sc1
buffer_load_dwordx4 v[20:23], v0, s[16:19], s75 offen offset:1024 sc1
s_waitcnt vmcnt(3)
s_add_u32 s63, s7, 0
buffer_load_dwordx4 v[64:67], v0, s[12:15], s63 offen offset:0 nt
s_waitcnt vmcnt(3)
s_add_u32 s63, s7, 0
buffer_load_dwordx4 v[68:71], v0, s[12:15], s63 offen offset:1024 nt
ds_write_b128 v2, v[240:243] offset:0
ds_write_b128 v3, v[244:247] offset:1024
ds_write_b128 v4, v[248:251] offset:2048
ds_write_b128 v5, v[252:255] offset:3072
ds_read_b128 v[240:243], v6
ds_read_b128 v[244:247], v7
ds_read_b128 v[248:251], v8
ds_read_b128 v[252:255], v9
s_cmp_lt_u32 s3, 4
s_cbranch_scc1 L_P_pr6
s_setprio 1
L_P_pr6:
s_lshl_b32 s60, s3, 12
v_and_b32 v10, 3, v1
v_lshlrev_b32 v10, 2, v10
v_bfe_u32 v11, v1, 2, 1
v_or_b32 v10, v10, v11
v_lshrrev_b32 v11, 4, v1
v_xor_b32 v10, v10, v11
v_lshlrev_b32 v10, 4, v10
v_and_b32 v11, 7, v1
v_lshl_add_u32 v10, v11, 8, v10
v_add_u32 v6, s60, v10
v_xor_b32 v7, 64, v6
v_xor_b32 v8, 128, v6
v_xor_b32 v9, 192, v6
s_waitcnt vmcnt(3)
s_add_u32 s63, s7, 0
buffer_load_dwordx4 v[72:75], v0, s[12:15], s63 offen offset:2048 nt
s_waitcnt vmcnt(3)
s_add_u32 s63, s7, 0
buffer_load_dwordx4 v[76:79], v0, s[12:15], s63 offen offset:3072 nt
v_max_u32 v10, v16, v17
v_max3_u32 v10, v10, v18, v19
v_max3_u32 v10, v10, v20, v21
v_max3_u32 v10, v10, v22, v23
v_cmp_eq_u32 vcc, -1, v10
s_cbranch_vccz L_P_ok7
s_mov_b32 s70, 0
L_P_retry8:
buffer_load_dwordx4 v[16:19], v0, s[16:19], s75 offen offset:0 sc1
buffer_load_dwordx4 v[20:23], v0, s[16:19], s75 offen offset:1024 sc1
s_waitcnt vmcnt(0)
v_max_u32 v10, v16, v17
v_max3_u32 v10, v10, v18, v19
v_max3_u32 v10, v10, v20, v21
v_max3_u32 v10, v10, v22, v23
s_add_u32 s70, s70, 1
s_cmp_ge_u32 s70, 262144
s_cbranch_scc1 L_P_ok7
v_cmp_eq_u32 vcc, -1, v10
s_cbranch_vccnz L_P_retry8
L_P_ok7:
ds_write_b128 v2, v[16:19] offset:0
ds_write_b128 v3, v[20:23] offset:1024
ds_read_b128 v[16:19], v6
ds_read_b128 v[20:23], v7
ds_read_b128 v[24:27], v8
ds_read_b128 v[28:31], v9
s_waitcnt lgkmcnt(0)
v_mfma_f32_16x16x32_bf16 v[32:35], v[128:131], v[16:19], 0
v_mfma_f32_16x16x32_bf16 v[32:35], v[132:135], v[20:23], v[32:35]
v_mfma_f32_16x16x32_bf16 v[32:35], v[136:139], v[24:27], v[32:35]
v_mfma_f32_16x16x32_bf16 v[32:35], v[140:143], v[28:31], v[32:35]
v_mfma_f32_16x16x32_bf16 v[36:39], v[144:147], v[16:19], 0
v_mfma_f32_16x16x32_bf16 v[36:39], v[148:151], v[20:23], v[36:39]
v_mfma_f32_16x16x32_bf16 v[36:39], v[152:155], v[24:27], v[36:39]
v_mfma_f32_16x16x32_bf16 v[36:39], v[156:159], v[28:31], v[36:39]
s_add_u32 s63, s7, 32768
buffer_load_dwordx4 v[80:83], v0, s[12:15], s63 offen offset:0 nt
s_add_u32 s63, s7, 32768
buffer_load_dwordx4 v[84:87], v0, s[12:15], s63 offen offset:1024 nt
v_mfma_f32_16x16x32_bf16 v[40:43], v[160:163], v[16:19], 0
v_mfma_f32_16x16x32_bf16 v[40:43], v[164:167], v[20:23], v[40:43]
v_mfma_f32_16x16x32_bf16 v[40:43], v[168:171], v[24:27], v[40:43]
v_mfma_f32_16x16x32_bf16 v[40:43], v[172:175], v[28:31], v[40:43]
v_mfma_f32_16x16x32_bf16 v[44:47], v[176:179], v[16:19], 0
v_mfma_f32_16x16x32_bf16 v[44:47], v[180:183], v[20:23], v[44:47]
v_mfma_f32_16x16x32_bf16 v[44:47], v[184:187], v[24:27], v[44:47]
v_mfma_f32_16x16x32_bf16 v[44:47], v[188:191], v[28:31], v[44:47]
v_mfma_f32_16x16x32_bf16 v[48:51], v[192:195], v[16:19], 0
v_mfma_f32_16x16x32_bf16 v[48:51], v[196:199], v[20:23], v[48:51]
v_mfma_f32_16x16x32_bf16 v[48:51], v[200:203], v[24:27], v[48:51]
v_mfma_f32_16x16x32_bf16 v[48:51], v[204:207], v[28:31], v[48:51]
v_mfma_f32_16x16x32_bf16 v[52:55], v[208:211], v[16:19], 0
v_mfma_f32_16x16x32_bf16 v[52:55], v[212:215], v[20:23], v[52:55]
v_mfma_f32_16x16x32_bf16 v[52:55], v[216:219], v[24:27], v[52:55]
v_mfma_f32_16x16x32_bf16 v[52:55], v[220:223], v[28:31], v[52:55]
v_mfma_f32_16x16x32_bf16 v[56:59], v[224:227], v[16:19], 0
v_mfma_f32_16x16x32_bf16 v[56:59], v[228:231], v[20:23], v[56:59]
v_mfma_f32_16x16x32_bf16 v[56:59], v[232:235], v[24:27], v[56:59]
v_mfma_f32_16x16x32_bf16 v[56:59], v[236:239], v[28:31], v[56:59]
v_mfma_f32_16x16x32_bf16 v[60:63], v[240:243], v[16:19], 0
v_mfma_f32_16x16x32_bf16 v[60:63], v[244:247], v[20:23], v[60:63]
v_mfma_f32_16x16x32_bf16 v[60:63], v[248:251], v[24:27], v[60:63]
v_mfma_f32_16x16x32_bf16 v[60:63], v[252:255], v[28:31], v[60:63]
s_add_u32 s63, s7, 32768
buffer_load_dwordx4 v[88:91], v0, s[12:15], s63 offen offset:2048 nt
v_cvt_pk_bf16_f32 v2, v32, v33
v_lshlrev_b32 v32, 16, v2
v_and_b32 v33, 0xffff0000, v2
v_cvt_pk_bf16_f32 v3, v34, v35
v_lshlrev_b32 v34, 16, v3
v_and_b32 v35, 0xffff0000, v3
v_mul_f32 v32, 0x3db504f3, v32
v_mul_f32 v33, 0x3db504f3, v33
v_mul_f32 v34, 0x3db504f3, v34
v_mul_f32 v35, 0x3db504f3, v35
v_cvt_pk_bf16_f32 v2, v32, v33
v_lshlrev_b32 v32, 16, v2
v_and_b32 v33, 0xffff0000, v2
v_cvt_pk_bf16_f32 v3, v34, v35
v_lshlrev_b32 v34, 16, v3
v_and_b32 v35, 0xffff0000, v3
v_max_f32 v4, v32, v33
v_max3_f32 v4, v4, v34, v35
v_cvt_pk_bf16_f32 v2, v36, v37
v_lshlrev_b32 v36, 16, v2
v_and_b32 v37, 0xffff0000, v2
v_cvt_pk_bf16_f32 v3, v38, v39
v_lshlrev_b32 v38, 16, v3
v_and_b32 v39, 0xffff0000, v3
v_mul_f32 v36, 0x3db504f3, v36
v_mul_f32 v37, 0x3db504f3, v37
v_mul_f32 v38, 0x3db504f3, v38
v_mul_f32 v39, 0x3db504f3, v39
v_cvt_pk_bf16_f32 v2, v36, v37
v_lshlrev_b32 v36, 16, v2
v_and_b32 v37, 0xffff0000, v2
v_cvt_pk_bf16_f32 v3, v38, v39
v_lshlrev_b32 v38, 16, v3
v_and_b32 v39, 0xffff0000, v3
v_max3_f32 v4, v4, v36, v37
v_max3_f32 v4, v4, v38, v39
v_cvt_pk_bf16_f32 v2, v40, v41
v_lshlrev_b32 v40, 16, v2
v_and_b32 v41, 0xffff0000, v2
v_cvt_pk_bf16_f32 v3, v42, v43
v_lshlrev_b32 v42, 16, v3
v_and_b32 v43, 0xffff0000, v3
v_mul_f32 v40, 0x3db504f3, v40
v_mul_f32 v41, 0x3db504f3, v41
v_mul_f32 v42, 0x3db504f3, v42
v_mul_f32 v43, 0x3db504f3, v43
v_cvt_pk_bf16_f32 v2, v40, v41
v_lshlrev_b32 v40, 16, v2
v_and_b32 v41, 0xffff0000, v2
v_cvt_pk_bf16_f32 v3, v42, v43
v_lshlrev_b32 v42, 16, v3
v_and_b32 v43, 0xffff0000, v3
v_max3_f32 v4, v4, v40, v41
v_max3_f32 v4, v4, v42, v43
v_cvt_pk_bf16_f32 v2, v44, v45
v_lshlrev_b32 v44, 16, v2
v_and_b32 v45, 0xffff0000, v2
v_cvt_pk_bf16_f32 v3, v46, v47
v_lshlrev_b32 v46, 16, v3
v_and_b32 v47, 0xffff0000, v3
v_mul_f32 v44, 0x3db504f3, v44
v_mul_f32 v45, 0x3db504f3, v45
v_mul_f32 v46, 0x3db504f3, v46
v_mul_f32 v47, 0x3db504f3, v47
v_cvt_pk_bf16_f32 v2, v44, v45
v_lshlrev_b32 v44, 16, v2
v_and_b32 v45, 0xffff0000, v2
v_cvt_pk_bf16_f32 v3, v46, v47
v_lshlrev_b32 v46, 16, v3
v_and_b32 v47, 0xffff0000, v3
v_max3_f32 v4, v4, v44, v45
v_max3_f32 v4, v4, v46, v47
v_cvt_pk_bf16_f32 v2, v48, v49
v_lshlrev_b32 v48, 16, v2
v_and_b32 v49, 0xffff0000, v2
v_cvt_pk_bf16_f32 v3, v50, v51
v_lshlrev_b32 v50, 16, v3
v_and_b32 v51, 0xffff0000, v3
v_mul_f32 v48, 0x3db504f3, v48
v_mul_f32 v49, 0x3db504f3, v49
v_mul_f32 v50, 0x3db504f3, v50
v_mul_f32 v51, 0x3db504f3, v51
v_cvt_pk_bf16_f32 v2, v48, v49
v_lshlrev_b32 v48, 16, v2
v_and_b32 v49, 0xffff0000, v2
v_cvt_pk_bf16_f32 v3, v50, v51
v_lshlrev_b32 v50, 16, v3
v_and_b32 v51, 0xffff0000, v3
v_max3_f32 v4, v4, v48, v49
v_max3_f32 v4, v4, v50, v51
v_cvt_pk_bf16_f32 v2, v52, v53
v_lshlrev_b32 v52, 16, v2
v_and_b32 v53, 0xffff0000, v2
v_cvt_pk_bf16_f32 v3, v54, v55
v_lshlrev_b32 v54, 16, v3
v_and_b32 v55, 0xffff0000, v3
v_mul_f32 v52, 0x3db504f3, v52
v_mul_f32 v53, 0x3db504f3, v53
v_mul_f32 v54, 0x3db504f3, v54
v_mul_f32 v55, 0x3db504f3, v55
v_cvt_pk_bf16_f32 v2, v52, v53
v_lshlrev_b32 v52, 16, v2
v_and_b32 v53, 0xffff0000, v2
v_cvt_pk_bf16_f32 v3, v54, v55
v_lshlrev_b32 v54, 16, v3
v_and_b32 v55, 0xffff0000, v3
v_max3_f32 v4, v4, v52, v53
v_max3_f32 v4, v4, v54, v55
v_cvt_pk_bf16_f32 v2, v56, v57
v_lshlrev_b32 v56, 16, v2
v_and_b32 v57, 0xffff0000, v2
v_cvt_pk_bf16_f32 v3, v58, v59
v_lshlrev_b32 v58, 16, v3
v_and_b32 v59, 0xffff0000, v3
v_mul_f32 v56, 0x3db504f3, v56
v_mul_f32 v57, 0x3db504f3, v57
v_mul_f32 v58, 0x3db504f3, v58
v_mul_f32 v59, 0x3db504f3, v59
v_cvt_pk_bf16_f32 v2, v56, v57
v_lshlrev_b32 v56, 16, v2
v_and_b32 v57, 0xffff0000, v2
v_cvt_pk_bf16_f32 v3, v58, v59
v_lshlrev_b32 v58, 16, v3
v_and_b32 v59, 0xffff0000, v3
v_max3_f32 v4, v4, v56, v57
v_max3_f32 v4, v4, v58, v59
v_cvt_pk_bf16_f32 v2, v60, v61
v_lshlrev_b32 v60, 16, v2
v_and_b32 v61, 0xffff0000, v2
v_cvt_pk_bf16_f32 v3, v62, v63
v_lshlrev_b32 v62, 16, v3
v_and_b32 v63, 0xffff0000, v3
v_mul_f32 v60, 0x3db504f3, v60
v_mul_f32 v61, 0x3db504f3, v61
v_mul_f32 v62, 0x3db504f3, v62
v_mul_f32 v63, 0x3db504f3, v63
v_cvt_pk_bf16_f32 v2, v60, v61
v_lshlrev_b32 v60, 16, v2
v_and_b32 v61, 0xffff0000, v2
v_cvt_pk_bf16_f32 v3, v62, v63
v_lshlrev_b32 v62, 16, v3
v_and_b32 v63, 0xffff0000, v3
v_max3_f32 v4, v4, v60, v61
v_max3_f32 v4, v4, v62, v63
s_waitcnt vmcnt(4)
s_add_u32 s63, s7, 32768
buffer_load_dwordx4 v[92:95], v0, s[12:15], s63 offen offset:3072 nt
s_waitcnt vmcnt(4)
s_add_u32 s63, s7, 65536
buffer_load_dwordx4 v[96:99], v0, s[12:15], s63 offen offset:0 nt
v_mov_b32 v5, v4
s_nop 1
v_permlane16_swap_b32 v4, v5
v_max_f32 v4, v4, v5
v_mov_b32 v5, v4
s_nop 1
v_permlane32_swap_b32 v4, v5
v_max_f32 v4, v4, v5
v_mul_f32 v6, 0xbfb8aa3b, v4
s_mov_b32 s60, 0x3fb8aa3b
s_mov_b32 s66, 0x00ff00ff
s_mov_b32 s67, 0x00ff00ff
v_mov_b32 v5, 0
v_fma_f32 v32, v32, s60, v6
v_fma_f32 v33, v33, s60, v6
v_fma_f32 v34, v34, s60, v6
v_fma_f32 v35, v35, s60, v6
v_exp_f32 v32, v32
v_exp_f32 v33, v33
v_exp_f32 v34, v34
v_exp_f32 v35, v35
v_add_f32 v7, v32, v33
v_add_f32 v8, v34, v35
v_cvt_pk_bf16_f32 v2, v32, v33
v_cvt_pk_bf16_f32 v3, v34, v35
v_add_f32 v5, v5, v7
v_add_f32 v5, v5, v8
v_cndmask_b32 v16, 0, v2, s[66:67]
v_cndmask_b32 v32, v2, 0, s[66:67]
v_cndmask_b32 v17, 0, v3, s[66:67]
v_cndmask_b32 v33, v3, 0, s[66:67]
v_fma_f32 v36, v36, s60, v6
v_fma_f32 v37, v37, s60, v6
v_fma_f32 v38, v38, s60, v6
v_fma_f32 v39, v39, s60, v6
v_exp_f32 v36, v36
v_exp_f32 v37, v37
v_exp_f32 v38, v38
v_exp_f32 v39, v39
v_add_f32 v7, v36, v37
v_add_f32 v8, v38, v39
v_cvt_pk_bf16_f32 v2, v36, v37
v_cvt_pk_bf16_f32 v3, v38, v39
v_add_f32 v5, v5, v7
v_add_f32 v5, v5, v8
v_cndmask_b32 v18, 0, v2, s[66:67]
v_cndmask_b32 v34, v2, 0, s[66:67]
v_cndmask_b32 v19, 0, v3, s[66:67]
v_cndmask_b32 v35, v3, 0, s[66:67]
v_fma_f32 v40, v40, s60, v6
v_fma_f32 v41, v41, s60, v6
v_fma_f32 v42, v42, s60, v6
v_fma_f32 v43, v43, s60, v6
v_exp_f32 v40, v40
v_exp_f32 v41, v41
v_exp_f32 v42, v42
v_exp_f32 v43, v43
v_add_f32 v7, v40, v41
v_add_f32 v8, v42, v43
v_cvt_pk_bf16_f32 v2, v40, v41
v_cvt_pk_bf16_f32 v3, v42, v43
v_add_f32 v5, v5, v7
v_add_f32 v5, v5, v8
v_cndmask_b32 v20, 0, v2, s[66:67]
v_cndmask_b32 v36, v2, 0, s[66:67]
v_cndmask_b32 v21, 0, v3, s[66:67]
v_cndmask_b32 v37, v3, 0, s[66:67]
v_fma_f32 v44, v44, s60, v6
v_fma_f32 v45, v45, s60, v6
v_fma_f32 v46, v46, s60, v6
v_fma_f32 v47, v47, s60, v6
v_exp_f32 v44, v44
v_exp_f32 v45, v45
v_exp_f32 v46, v46
v_exp_f32 v47, v47
v_add_f32 v7, v44, v45
v_add_f32 v8, v46, v47
v_cvt_pk_bf16_f32 v2, v44, v45
v_cvt_pk_bf16_f32 v3, v46, v47
v_add_f32 v5, v5, v7
v_add_f32 v5, v5, v8
v_cndmask_b32 v22, 0, v2, s[66:67]
v_cndmask_b32 v38, v2, 0, s[66:67]
v_cndmask_b32 v23, 0, v3, s[66:67]
v_cndmask_b32 v39, v3, 0, s[66:67]
v_fma_f32 v48, v48, s60, v6
v_fma_f32 v49, v49, s60, v6
v_fma_f32 v50, v50, s60, v6
v_fma_f32 v51, v51, s60, v6
v_exp_f32 v48, v48
v_exp_f32 v49, v49
v_exp_f32 v50, v50
v_exp_f32 v51, v51
v_add_f32 v7, v48, v49
v_add_f32 v8, v50, v51
v_cvt_pk_bf16_f32 v2, v48, v49
v_cvt_pk_bf16_f32 v3, v50, v51
v_add_f32 v5, v5, v7
v_add_f32 v5, v5, v8
v_cndmask_b32 v24, 0, v2, s[66:67]
v_cndmask_b32 v40, v2, 0, s[66:67]
v_cndmask_b32 v25, 0, v3, s[66:67]
v_cndmask_b32 v41, v3, 0, s[66:67]
v_fma_f32 v52, v52, s60, v6
v_fma_f32 v53, v53, s60, v6
v_fma_f32 v54, v54, s60, v6
v_fma_f32 v55, v55, s60, v6
v_exp_f32 v52, v52
v_exp_f32 v53, v53
v_exp_f32 v54, v54
v_exp_f32 v55, v55
v_add_f32 v7, v52, v53
v_add_f32 v8, v54, v55
v_cvt_pk_bf16_f32 v2, v52, v53
v_cvt_pk_bf16_f32 v3, v54, v55
v_add_f32 v5, v5, v7
v_add_f32 v5, v5, v8
v_cndmask_b32 v26, 0, v2, s[66:67]
v_cndmask_b32 v42, v2, 0, s[66:67]
v_cndmask_b32 v27, 0, v3, s[66:67]
v_cndmask_b32 v43, v3, 0, s[66:67]
v_fma_f32 v56, v56, s60, v6
v_fma_f32 v57, v57, s60, v6
v_fma_f32 v58, v58, s60, v6
v_fma_f32 v59, v59, s60, v6
v_exp_f32 v56, v56
v_exp_f32 v57, v57
v_exp_f32 v58, v58
v_exp_f32 v59, v59
v_add_f32 v7, v56, v57
v_add_f32 v8, v58, v59
v_cvt_pk_bf16_f32 v2, v56, v57
v_cvt_pk_bf16_f32 v3, v58, v59
v_add_f32 v5, v5, v7
v_add_f32 v5, v5, v8
v_cndmask_b32 v28, 0, v2, s[66:67]
v_cndmask_b32 v44, v2, 0, s[66:67]
v_cndmask_b32 v29, 0, v3, s[66:67]
v_cndmask_b32 v45, v3, 0, s[66:67]
v_fma_f32 v60, v60, s60, v6
v_fma_f32 v61, v61, s60, v6
v_fma_f32 v62, v62, s60, v6
v_fma_f32 v63, v63, s60, v6
v_exp_f32 v60, v60
v_exp_f32 v61, v61
v_exp_f32 v62, v62
v_exp_f32 v63, v63
v_add_f32 v7, v60, v61
v_add_f32 v8, v62, v63
v_cvt_pk_bf16_f32 v2, v60, v61
v_cvt_pk_bf16_f32 v3, v62, v63
v_add_f32 v5, v5, v7
v_add_f32 v5, v5, v8
v_cndmask_b32 v30, 0, v2, s[66:67]
v_cndmask_b32 v46, v2, 0, s[66:67]
v_cndmask_b32 v31, 0, v3, s[66:67]
v_cndmask_b32 v47, v3, 0, s[66:67]
v_mov_b32 v6, v5
s_nop 1
v_permlane16_swap_b32 v5, v6
v_add_f32 v5, v5, v6
v_mov_b32 v6, v5
s_nop 1
v_permlane32_swap_b32 v5, v6
v_add_f32 v5, v5, v6
s_lshl_b32 s60, s3, 6
s_add_u32 s60, s60, 49664
v_lshlrev_b32 v6, 3, v1
v_add_u32 v7, s60, v6
v_mov_b32 v8, 1
v_mov_b32 v9, 50176
s_mov_b32 exec_lo, 0xff
s_mov_b32 exec_hi, 0x0
ds_write_b64 v7, v[4:5]
s_mov_b64 exec, 1
ds_add_rtn_u32 v8, v9, v8
s_mov_b64 exec, -1
s_waitcnt lgkmcnt(0)
v_readfirstlane_b32 s60, v8
s_cmp_lg_u32 s60, 7
s_cbranch_scc1 L_P_ml9
ds_read_b64 v[8:9], v6 offset:49664
s_waitcnt lgkmcnt(0)
v_max_f32_dpp v2, v8, v8 row_ror:8 row_mask:0xf bank_mask:0xf
v_mov_b32 v7, v2
s_nop 1
v_permlane16_swap_b32 v2, v7
v_max_f32 v2, v2, v7
v_mov_b32 v7, v2
s_nop 1
v_permlane32_swap_b32 v2, v7
v_max_f32 v2, v2, v7
v_sub_f32 v7, v8, v2
v_mul_f32 v7, 0x3fb8aa3b, v7
v_exp_f32 v7, v7
s_nop 0
v_mul_f32 v3, v9, v7
s_nop 1
v_add_f32_dpp v3, v3, v3 row_ror:8 row_mask:0xf bank_mask:0xf
v_mov_b32 v7, v3
s_nop 1
v_permlane16_swap_b32 v3, v7
v_add_f32 v3, v3, v7
v_mov_b32 v7, v3
s_nop 1
v_permlane32_swap_b32 v3, v7
v_add_f32 v3, v3, v7
s_lshl_b32 s60, s5, 7
s_add_u32 s60, s60, 131072
s_mov_b32 exec_lo, 0xff
s_mov_b32 exec_hi, 0x0
buffer_store_dwordx2 v[2:3], v6, s[16:19], s60 offen sc1
s_mov_b64 exec, -1
L_P_ml9:
s_setprio 0
s_waitcnt vmcnt(3)
s_add_u32 s63, s7, 65536
buffer_load_dwordx4 v[100:103], v0, s[12:15], s63 offen offset:1024 nt
s_waitcnt vmcnt(3)
s_add_u32 s63, s7, 65536
buffer_load_dwordx4 v[104:107], v0, s[12:15], s63 offen offset:2048 nt
s_waitcnt vmcnt(3)
s_add_u32 s63, s7, 65536
buffer_load_dwordx4 v[108:111], v0, s[12:15], s63 offen offset:3072 nt
v_perm_b32 v160, v68, v64, s64
v_perm_b32 v161, v76, v72, s64
v_perm_b32 v162, v84, v80, s64
v_perm_b32 v163, v92, v88, s64
v_perm_b32 v164, v68, v64, s65
v_perm_b32 v165, v76, v72, s65
v_perm_b32 v166, v84, v80, s65
v_perm_b32 v167, v92, v88, s65
v_mfma_f32_16x16x32_bf16 v[48:51], v[160:163], v[16:19], 0
s_nop 0
v_mfma_f32_16x16x32_bf16 v[52:55], v[164:167], v[16:19], 0
v_perm_b32 v168, v69, v65, s64
v_perm_b32 v169, v77, v73, s64
v_perm_b32 v170, v85, v81, s64
v_perm_b32 v171, v93, v89, s64
v_perm_b32 v172, v69, v65, s65
v_perm_b32 v173, v77, v73, s65
v_perm_b32 v174, v85, v81, s65
v_perm_b32 v175, v93, v89, s65
v_mfma_f32_16x16x32_bf16 v[56:59], v[168:171], v[16:19], 0
s_nop 0
v_mfma_f32_16x16x32_bf16 v[60:63], v[172:175], v[16:19], 0
v_perm_b32 v160, v70, v66, s64
v_perm_b32 v161, v78, v74, s64
v_perm_b32 v162, v86, v82, s64
v_perm_b32 v163, v94, v90, s64
v_perm_b32 v164, v70, v66, s65
v_perm_b32 v165, v78, v74, s65
v_perm_b32 v166, v86, v82, s65
v_perm_b32 v167, v94, v90, s65
v_mfma_f32_16x16x32_bf16 v[48:51], v[160:163], v[32:35], v[48:51]
s_nop 0
v_mfma_f32_16x16x32_bf16 v[52:55], v[164:167], v[32:35], v[52:55]
v_perm_b32 v168, v71, v67, s64
v_perm_b32 v169, v79, v75, s64
v_perm_b32 v170, v87, v83, s64
v_perm_b32 v171, v95, v91, s64
v_perm_b32 v172, v71, v67, s65
v_perm_b32 v173, v79, v75, s65
v_perm_b32 v174, v87, v83, s65
v_perm_b32 v175, v95, v91, s65
v_mfma_f32_16x16x32_bf16 v[56:59], v[168:171], v[32:35], v[56:59]
s_nop 0
v_mfma_f32_16x16x32_bf16 v[60:63], v[172:175], v[32:35], v[60:63]
s_waitcnt vmcnt(3)
s_add_u32 s63, s7, 98304
buffer_load_dwordx4 v[112:115], v0, s[12:15], s63 offen offset:0 nt
s_waitcnt vmcnt(3)
s_add_u32 s63, s7, 98304
buffer_load_dwordx4 v[116:119], v0, s[12:15], s63 offen offset:1024 nt
s_waitcnt vmcnt(3)
s_add_u32 s63, s7, 98304
buffer_load_dwordx4 v[120:123], v0, s[12:15], s63 offen offset:2048 nt
s_waitcnt vmcnt(3)
s_add_u32 s63, s7, 98304
buffer_load_dwordx4 v[124:127], v0, s[12:15], s63 offen offset:3072 nt
s_waitcnt vmcnt(3)
s_add_u32 s63, s7, 131072
buffer_load_dwordx4 v[128:131], v0, s[12:15], s63 offen offset:0 nt
s_waitcnt vmcnt(3)
s_add_u32 s63, s7, 131072
buffer_load_dwordx4 v[132:135], v0, s[12:15], s63 offen offset:1024 nt
s_waitcnt vmcnt(3)
s_add_u32 s63, s7, 131072
buffer_load_dwordx4 v[136:139], v0, s[12:15], s63 offen offset:2048 nt
s_waitcnt vmcnt(3)
s_add_u32 s63, s7, 131072
buffer_load_dwordx4 v[140:143], v0, s[12:15], s63 offen offset:3072 nt
v_perm_b32 v64, v100, v96, s64
v_perm_b32 v65, v108, v104, s64
v_perm_b32 v66, v116, v112, s64
v_perm_b32 v67, v124, v120, s64
v_perm_b32 v68, v100, v96, s65
v_perm_b32 v69, v108, v104, s65
v_perm_b32 v70, v116, v112, s65
v_perm_b32 v71, v124, v120, s65
v_mfma_f32_16x16x32_bf16 v[48:51], v[64:67], v[20:23], v[48:51]
s_nop 0
v_mfma_f32_16x16x32_bf16 v[52:55], v[68:71], v[20:23], v[52:55]
v_perm_b32 v72, v101, v97, s64
v_perm_b32 v73, v109, v105, s64
v_perm_b32 v74, v117, v113, s64
v_perm_b32 v75, v125, v121, s64
v_perm_b32 v76, v101, v97, s65
v_perm_b32 v77, v109, v105, s65
v_perm_b32 v78, v117, v113, s65
v_perm_b32 v79, v125, v121, s65
v_mfma_f32_16x16x32_bf16 v[56:59], v[72:75], v[20:23], v[56:59]
s_nop 0
v_mfma_f32_16x16x32_bf16 v[60:63], v[76:79], v[20:23], v[60:63]
v_perm_b32 v64, v102, v98, s64
v_perm_b32 v65, v110, v106, s64
v_perm_b32 v66, v118, v114, s64
v_perm_b32 v67, v126, v122, s64
v_perm_b32 v68, v102, v98, s65
v_perm_b32 v69, v110, v106, s65
v_perm_b32 v70, v118, v114, s65
v_perm_b32 v71, v126, v122, s65
v_mfma_f32_16x16x32_bf16 v[48:51], v[64:67], v[36:39], v[48:51]
s_nop 0
v_mfma_f32_16x16x32_bf16 v[52:55], v[68:71], v[36:39], v[52:55]
v_perm_b32 v72, v103, v99, s64
v_perm_b32 v73, v111, v107, s64
v_perm_b32 v74, v119, v115, s64
v_perm_b32 v75, v127, v123, s64
v_perm_b32 v76, v103, v99, s65
v_perm_b32 v77, v111, v107, s65
v_perm_b32 v78, v119, v115, s65
v_perm_b32 v79, v127, v123, s65
v_mfma_f32_16x16x32_bf16 v[56:59], v[72:75], v[36:39], v[56:59]
s_nop 0
v_mfma_f32_16x16x32_bf16 v[60:63], v[76:79], v[36:39], v[60:63]
s_waitcnt vmcnt(3)
s_add_u32 s63, s7, 163840
buffer_load_dwordx4 v[144:147], v0, s[12:15], s63 offen offset:0 nt
s_waitcnt vmcnt(3)
s_add_u32 s63, s7, 163840
buffer_load_dwordx4 v[148:151], v0, s[12:15], s63 offen offset:1024 nt
s_waitcnt vmcnt(3)
s_add_u32 s63, s7, 163840
buffer_load_dwordx4 v[152:155], v0, s[12:15], s63 offen offset:2048 nt
s_waitcnt vmcnt(3)
s_add_u32 s63, s7, 163840
buffer_load_dwordx4 v[156:159], v0, s[12:15], s63 offen offset:3072 nt
s_waitcnt vmcnt(3)
s_add_u32 s63, s7, 196608
buffer_load_dwordx4 v[160:163], v0, s[12:15], s63 offen offset:0 nt
s_waitcnt vmcnt(3)
s_add_u32 s63, s7, 196608
buffer_load_dwordx4 v[164:167], v0, s[12:15], s63 offen offset:1024 nt
s_waitcnt vmcnt(3)
s_add_u32 s63, s7, 196608
buffer_load_dwordx4 v[168:171], v0, s[12:15], s63 offen offset:2048 nt
s_waitcnt vmcnt(3)
s_lshr_b32 s75, s5, 4
s_lshl_b32 s75, s75, 11
s_add_u32 s75, s75, 131072
v_lshrrev_b32 v2, 3, v1
v_lshlrev_b32 v2, 7, v2
v_and_b32 v3, 7, v1
v_lshl_add_u32 v2, v3, 3, v2
buffer_load_dwordx2 v[6:7], v2, s[16:19], s75 offen offset:0 sc1
buffer_load_dwordx2 v[8:9], v2, s[16:19], s75 offen offset:1024 sc1
v_perm_b32 v64, v132, v128, s64
v_perm_b32 v65, v140, v136, s64
v_perm_b32 v66, v148, v144, s64
v_perm_b32 v67, v156, v152, s64
v_perm_b32 v68, v132, v128, s65
v_perm_b32 v69, v140, v136, s65
v_perm_b32 v70, v148, v144, s65
v_perm_b32 v71, v156, v152, s65
v_mfma_f32_16x16x32_bf16 v[48:51], v[64:67], v[24:27], v[48:51]
s_nop 0
v_mfma_f32_16x16x32_bf16 v[52:55], v[68:71], v[24:27], v[52:55]
v_perm_b32 v72, v133, v129, s64
v_perm_b32 v73, v141, v137, s64
v_perm_b32 v74, v149, v145, s64
v_perm_b32 v75, v157, v153, s64
v_perm_b32 v76, v133, v129, s65
v_perm_b32 v77, v141, v137, s65
v_perm_b32 v78, v149, v145, s65
v_perm_b32 v79, v157, v153, s65
v_mfma_f32_16x16x32_bf16 v[56:59], v[72:75], v[24:27], v[56:59]
s_nop 0
v_mfma_f32_16x16x32_bf16 v[60:63], v[76:79], v[24:27], v[60:63]
v_perm_b32 v64, v134, v130, s64
v_perm_b32 v65, v142, v138, s64
v_perm_b32 v66, v150, v146, s64
v_perm_b32 v67, v158, v154, s64
v_perm_b32 v68, v134, v130, s65
v_perm_b32 v69, v142, v138, s65
v_perm_b32 v70, v150, v146, s65
v_perm_b32 v71, v158, v154, s65
v_mfma_f32_16x16x32_bf16 v[48:51], v[64:67], v[40:43], v[48:51]
s_nop 0
v_mfma_f32_16x16x32_bf16 v[52:55], v[68:71], v[40:43], v[52:55]
v_perm_b32 v72, v135, v131, s64
v_perm_b32 v73, v143, v139, s64
v_perm_b32 v74, v151, v147, s64
v_perm_b32 v75, v159, v155, s64
v_perm_b32 v76, v135, v131, s65
v_perm_b32 v77, v143, v139, s65
v_perm_b32 v78, v151, v147, s65
v_perm_b32 v79, v159, v155, s65
v_mfma_f32_16x16x32_bf16 v[56:59], v[72:75], v[40:43], v[56:59]
s_nop 0
v_mfma_f32_16x16x32_bf16 v[60:63], v[76:79], v[40:43], v[60:63]
s_waitcnt vmcnt(3)
s_add_u32 s63, s7, 196608
buffer_load_dwordx4 v[172:175], v0, s[12:15], s63 offen offset:3072 nt
s_waitcnt vmcnt(3)
s_add_u32 s63, s7, 229376
buffer_load_dwordx4 v[176:179], v0, s[12:15], s63 offen offset:0 nt
s_waitcnt vmcnt(3)
s_add_u32 s63, s7, 229376
buffer_load_dwordx4 v[180:183], v0, s[12:15], s63 offen offset:1024 nt
s_waitcnt vmcnt(3)
s_add_u32 s63, s7, 229376
buffer_load_dwordx4 v[184:187], v0, s[12:15], s63 offen offset:2048 nt
v_max_u32 v3, v6, v7
v_max3_u32 v3, v3, v8, v9
v_cmp_eq_u32 vcc, -1, v3
s_cbranch_vccz L_P_ok10
s_mov_b32 s70, 0
L_P_retry11:
buffer_load_dwordx2 v[6:7], v2, s[16:19], s75 offen offset:0 sc1
buffer_load_dwordx2 v[8:9], v2, s[16:19], s75 offen offset:1024 sc1
s_waitcnt vmcnt(0)
v_max_u32 v3, v6, v7
v_max3_u32 v3, v3, v8, v9
s_add_u32 s70, s70, 1
s_cmp_ge_u32 s70, 262144
s_cbranch_scc1 L_P_ok10
v_cmp_eq_u32 vcc, -1, v3
s_cbranch_vccnz L_P_retry11
L_P_ok10:
v_max_f32 v3, v6, v8
v_sub_f32 v6, v6, v3
v_sub_f32 v8, v8, v3
v_mul_f32 v6, 0x3fb8aa3b, v6
v_mul_f32 v8, 0x3fb8aa3b, v8
v_exp_f32 v6, v6
v_exp_f32 v8, v8
v_mul_f32 v7, v7, v6
v_fmac_f32 v7, v9, v8
v_max_f32_dpp v6, v3, v3 row_ror:8 row_mask:0xf bank_mask:0xf
v_mov_b32 v9, v6
s_nop 1
v_permlane16_swap_b32 v6, v9
v_max_f32 v6, v6, v9
v_mov_b32 v9, v6
s_nop 1
v_permlane32_swap_b32 v6, v9
v_max_f32 v6, v6, v9
v_sub_f32 v9, v3, v6
v_mul_f32 v9, 0x3fb8aa3b, v9
v_exp_f32 v9, v9
s_nop 0
v_mul_f32 v8, v7, v9
s_nop 1
v_add_f32_dpp v8, v8, v8 row_ror:8 row_mask:0xf bank_mask:0xf
v_mov_b32 v9, v8
s_nop 1
v_permlane16_swap_b32 v8, v9
v_add_f32 v8, v8, v9
v_mov_b32 v9, v8
s_nop 1
v_permlane32_swap_b32 v8, v9
v_add_f32 v8, v8, v9
v_sub_f32 v4, v4, v6
v_mul_f32 v4, 0x3fb8aa3b, v4
v_exp_f32 v4, v4
v_rcp_f32 v8, v8
s_nop 0
v_mul_f32 v5, v4, v8
s_mul_i32 s60, s3, 4864
s_add_u32 s60, s60, 0
v_and_b32 v6, 7, v1
v_mul_u32_u24 v6, 592, v6
v_lshrrev_b32 v3, 4, v1
v_mul_u32_u24 v3, 144, v3
v_add_u32 v6, v3, v6
v_bfe_u32 v3, v1, 3, 1
v_lshl_add_u32 v6, v3, 6, v6
v_add_u32 v6, s60, v6
s_mul_i32 s60, s3, 592
s_add_u32 s60, s60, 0
v_lshrrev_b32 v7, 4, v1
v_mul_u32_u24 v7, 144, v7
v_bfe_u32 v3, v1, 1, 1
v_lshl_add_u32 v7, v3, 6, v7
v_and_b32 v3, 1, v1
v_lshl_add_u32 v7, v3, 5, v7
v_bfe_u32 v3, v1, 2, 2
v_lshl_add_u32 v7, v3, 2, v7
v_add_u32 v7, s60, v7
v_add_u32 v8, 16, v7
v_lshlrev_b32 v9, 2, v1
s_lshl_b32 s75, s5, 11
s_lshl_b32 s61, s3, 8
s_add_u32 s75, s75, s61
s_add_u32 s75, s75, 262144
s_waitcnt vmcnt(3)
s_add_u32 s63, s7, 229376
buffer_load_dwordx4 v[188:191], v0, s[12:15], s63 offen offset:3072 nt
s_waitcnt vmcnt(0)
v_perm_b32 v64, v164, v160, s64
v_perm_b32 v65, v172, v168, s64
v_perm_b32 v66, v180, v176, s64
v_perm_b32 v67, v188, v184, s64
v_perm_b32 v68, v164, v160, s65
v_perm_b32 v69, v172, v168, s65
v_perm_b32 v70, v180, v176, s65
v_perm_b32 v71, v188, v184, s65
v_mfma_f32_16x16x32_bf16 v[48:51], v[64:67], v[28:31], v[48:51]
s_nop 0
v_mfma_f32_16x16x32_bf16 v[52:55], v[68:71], v[28:31], v[52:55]
v_perm_b32 v72, v165, v161, s64
v_perm_b32 v73, v173, v169, s64
v_perm_b32 v74, v181, v177, s64
v_perm_b32 v75, v189, v185, s64
v_perm_b32 v76, v165, v161, s65
v_perm_b32 v77, v173, v169, s65
v_perm_b32 v78, v181, v177, s65
v_perm_b32 v79, v189, v185, s65
v_mfma_f32_16x16x32_bf16 v[56:59], v[72:75], v[28:31], v[56:59]
s_nop 0
v_mfma_f32_16x16x32_bf16 v[60:63], v[76:79], v[28:31], v[60:63]
v_perm_b32 v64, v166, v162, s64
v_perm_b32 v65, v174, v170, s64
v_perm_b32 v66, v182, v178, s64
v_perm_b32 v67, v190, v186, s64
v_perm_b32 v68, v166, v162, s65
v_perm_b32 v69, v174, v170, s65
v_perm_b32 v70, v182, v178, s65
v_perm_b32 v71, v190, v186, s65
v_mfma_f32_16x16x32_bf16 v[48:51], v[64:67], v[44:47], v[48:51]
s_nop 0
v_mfma_f32_16x16x32_bf16 v[52:55], v[68:71], v[44:47], v[52:55]
v_perm_b32 v72, v167, v163, s64
v_perm_b32 v73, v175, v171, s64
v_perm_b32 v74, v183, v179, s64
v_perm_b32 v75, v191, v187, s64
v_perm_b32 v76, v167, v163, s65
v_perm_b32 v77, v175, v171, s65
v_perm_b32 v78, v183, v179, s65
v_perm_b32 v79, v191, v187, s65
v_mfma_f32_16x16x32_bf16 v[56:59], v[72:75], v[44:47], v[56:59]
s_nop 0
v_mfma_f32_16x16x32_bf16 v[60:63], v[76:79], v[44:47], v[60:63]
v_pk_mul_f32 v[48:49], v[48:49], v[4:5] op_sel:[0,1] op_sel_hi:[1,1]
v_pk_mul_f32 v[50:51], v[50:51], v[4:5] op_sel:[0,1] op_sel_hi:[1,1]
ds_write_b128 v6, v[48:51] offset:0
v_pk_mul_f32 v[52:53], v[52:53], v[4:5] op_sel:[0,1] op_sel_hi:[1,1]
v_pk_mul_f32 v[54:55], v[54:55], v[4:5] op_sel:[0,1] op_sel_hi:[1,1]
ds_write_b128 v6, v[52:55] offset:16
v_pk_mul_f32 v[56:57], v[56:57], v[4:5] op_sel:[0,1] op_sel_hi:[1,1]
v_pk_mul_f32 v[58:59], v[58:59], v[4:5] op_sel:[0,1] op_sel_hi:[1,1]
ds_write_b128 v6, v[56:59] offset:32
v_pk_mul_f32 v[60:61], v[60:61], v[4:5] op_sel:[0,1] op_sel_hi:[1,1]
v_pk_mul_f32 v[62:63], v[62:63], v[4:5] op_sel:[0,1] op_sel_hi:[1,1]
ds_write_b128 v6, v[60:63] offset:48
s_waitcnt lgkmcnt(0)
s_barrier
ds_read2st64_b32 v[16:17], v7 offset0:0 offset1:19
ds_read2st64_b32 v[24:25], v8 offset0:0 offset1:19
ds_read2st64_b32 v[18:19], v7 offset0:38 offset1:57
ds_read2st64_b32 v[26:27], v8 offset0:38 offset1:57
ds_read2st64_b32 v[20:21], v7 offset0:76 offset1:95
ds_read2st64_b32 v[28:29], v8 offset0:76 offset1:95
ds_read2st64_b32 v[22:23], v7 offset0:114 offset1:133
ds_read2st64_b32 v[30:31], v8 offset0:114 offset1:133
s_waitcnt lgkmcnt(0)
v_pk_add_f32 v[16:17], v[16:17], v[20:21]
v_pk_add_f32 v[18:19], v[18:19], v[22:23]
v_pk_add_f32 v[24:25], v[24:25], v[28:29]
v_pk_add_f32 v[26:27], v[26:27], v[30:31]
v_pk_add_f32 v[16:17], v[16:17], v[18:19]
v_pk_add_f32 v[24:25], v[24:25], v[26:27]
v_add_f32 v16, v16, v17
v_add_f32 v24, v24, v25
v_cvt_pk_bf16_f32 v20, v16, v24
s_nop 1
v_mov_b32_dpp v21, v20 quad_perm:[1,1,1,1] row_mask:0xf bank_mask:0xf
v_mov_b32_dpp v22, v20 quad_perm:[2,2,2,2] row_mask:0xf bank_mask:0xf
v_mov_b32_dpp v23, v20 quad_perm:[3,3,3,3] row_mask:0xf bank_mask:0xf
s_mov_b32 exec_lo, 0x11111111
s_mov_b32 exec_hi, 0x11111111
buffer_store_dwordx4 v[20:23], v9, s[16:19], s75 offen sc1
s_mov_b64 exec, -1
s_mov_b32 s24, s44
s_mov_b32 s25, s45
s_mov_b32 s26, 0x700000
s_mov_b32 s27, 0x20000
s_mov_b32 s20, s46
s_mov_b32 s21, s47
s_mov_b32 s22, 0x700000
s_mov_b32 s23, 0x20000
s_sub_u32 s60, s4, 23
s_cmp_ge_u32 s60, 14
s_cbranch_scc1 L_P_h612
s_lshl_b32 s60, s60, 3
s_add_u32 s60, s60, s3
s_add_u32 s61, s2, 1
s_and_b32 s61, s61, 7
s_lshl_b32 s61, s61, 7
v_lshrrev_b32 v15, 3, v1
v_lshlrev_b32 v15, 10, v15
v_and_b32 v14, 7, v1
v_lshl_add_u32 v15, v14, 4, v15
v_add_u32 v15, s61, v15
s_add_u32 s61, s60, 0
s_mul_i32 s62, s61, 2341
s_lshr_b32 s62, s62, 16
s_mul_i32 s62, s62, 672
s_lshl_b32 s61, s61, 3
s_add_u32 s62, s62, s61
s_add_u32 s62, s62, 672
s_lshl_b32 s62, s62, 10
s_waitcnt vmcnt(4)
buffer_load_dwordx4 v[252:255], v15, s[24:27], s62 offen
buffer_load_dwordx4 v[252:255], v15, s[20:23], s62 offen
s_add_u32 s61, s60, 112
s_mul_i32 s62, s61, 2341
s_lshr_b32 s62, s62, 16
s_mul_i32 s62, s62, 672
s_lshl_b32 s61, s61, 3
s_add_u32 s62, s62, s61
s_add_u32 s62, s62, 672
s_lshl_b32 s62, s62, 10
s_waitcnt vmcnt(4)
buffer_load_dwordx4 v[252:255], v15, s[24:27], s62 offen
buffer_load_dwordx4 v[252:255], v15, s[20:23], s62 offen
L_P_h612:
s_mov_b32 s24, s48
s_mov_b32 s25, s49
s_mov_b32 s26, 0x700000
s_mov_b32 s27, 0x20000
s_sub_u32 s60, s4, 23
s_lshr_b32 s62, s60, 1
s_lshl_b32 s62, s62, 3
s_add_u32 s61, s2, 1
s_and_b32 s61, s61, 7
s_add_u32 s62, s62, s61
s_lshl_b32 s62, s62, 17
s_and_b32 s60, s60, 1
s_lshl_b32 s60, s60, 15
s_add_u32 s62, s62, s60
s_add_u32 s62, s62, s6
s_cmp_ge_u32 s62, 7340032
s_cbranch_scc1 L_P_h513
s_add_u32 s63, s62, 0
buffer_load_dwordx4 v[252:255], v0, s[24:27], s63 offen offset:0
s_waitcnt vmcnt(1)
buffer_load_dwordx4 v[252:255], v0, s[24:27], s63 offen offset:1024
s_waitcnt vmcnt(1)
buffer_load_dwordx4 v[252:255], v0, s[24:27], s63 offen offset:2048
s_waitcnt vmcnt(1)
buffer_load_dwordx4 v[252:255], v0, s[24:27], s63 offen offset:3072
s_add_u32 s63, s62, 65536
s_waitcnt vmcnt(1)
buffer_load_dwordx4 v[252:255], v0, s[24:27], s63 offen offset:0
s_waitcnt vmcnt(1)
buffer_load_dwordx4 v[252:255], v0, s[24:27], s63 offen offset:1024
s_waitcnt vmcnt(1)
buffer_load_dwordx4 v[252:255], v0, s[24:27], s63 offen offset:2048
s_waitcnt vmcnt(1)
buffer_load_dwordx4 v[252:255], v0, s[24:27], s63 offen offset:3072
L_P_h513:
s_endpgm
.p2align 6
L_class_PR:
s_waitcnt lgkmcnt(0)
s_mov_b32 s8, s34
s_mov_b32 s9, s35
s_mov_b32 s16, s58
s_mov_b32 s17, s59
s_mov_b32 s18, 0x10000000
s_mov_b32 s19, 0x20000
v_mov_b32 v4, -1
v_mov_b32 v5, -1
v_mov_b32 v6, -1
v_mov_b32 v7, -1
s_mov_b32 s20, s52
s_mov_b32 s21, s53
s_mov_b32 s22, 0xc00000
s_mov_b32 s23, 0x20000
s_mov_b32 s24, s50
s_mov_b32 s25, s51
s_mov_b32 s26, 0x2000
s_mov_b32 s27, 0x20000
s_sub_u32 s61, s2, 183
s_cmp_ge_u32 s61, 32
s_cselect_b32 s60, 32, 0
s_sub_u32 s61, s61, s60
s_lshl_b32 s72, s61, 7
s_lshr_b32 s73, s61, 4
s_lshl_b32 s73, s73, 13
s_and_b32 s60, s61, 15
s_lshl_b32 s60, s60, 7
s_add_u32 s73, s73, s60
v_lshrrev_b32 v10, 3, v1
v_mul_u32_u24 v10, 98304, v10
v_and_b32 v3, 7, v1
v_lshl_add_u32 v10, v3, 4, v10
s_mul_i32 s74, s3, 1572864
s_add_u32 s74, s74, s72
v_lshrrev_b32 v11, 5, v1
v_lshlrev_b32 v11, 11, v11
v_and_b32 v3, 15, v1
v_lshl_add_u32 v11, v3, 4, v11
v_bfe_u32 v3, v1, 4, 1
v_lshl_add_u32 v11, v3, 3, v11
s_lshl_b32 s78, s3, 8
s_sub_u32 s61, s2, 199
s_cmp_ge_u32 s61, 16
s_cselect_b32 s60, 16, 0
s_sub_u32 s61, s61, s60
s_add_u32 s61, s61, 80
s_lshl_b32 s77, s61, 7
s_lshr_b32 s76, s61, 4
s_lshl_b32 s76, s76, 13
s_and_b32 s60, s61, 15
s_lshl_b32 s60, s60, 7
s_add_u32 s76, s76, s60
s_cmp_lg_u32 s3, 0
s_cbranch_scc1 L_PR_clr1
s_setprio 3
v_bfe_u32 v2, v1, 3, 2
v_lshlrev_b32 v2, 11, v2
v_and_b32 v3, 7, v1
v_lshl_add_u32 v2, v3, 4, v2
s_mov_b32 exec_lo, 0xffffffff
s_mov_b32 exec_hi, 0x0
buffer_store_dwordx4 v[4:7], v2, s[16:19], s73 offen sc1
s_mov_b64 exec, -1
v_bfe_u32 v2, v1, 3, 2
v_lshlrev_b32 v2, 11, v2
v_and_b32 v3, 7, v1
v_lshl_add_u32 v2, v3, 4, v2
s_mov_b32 exec_lo, 0xffffffff
s_mov_b32 exec_hi, 0x0
buffer_store_dwordx4 v[4:7], v2, s[16:19], s76 offen sc1
s_mov_b64 exec, -1
s_lshl_b32 s60, s5, 11
s_add_u32 s60, s60, 262144
buffer_store_dwordx4 v[4:7], v0, s[16:19], s60 offen sc1
buffer_store_dwordx4 v[4:7], v0, s[16:19], s60 offen offset:1024 sc1
s_lshl_b32 s60, s5, 7
s_add_u32 s60, s60, 131072
s_mov_b32 exec_lo, 0xff
s_mov_b32 exec_hi, 0x0
buffer_store_dwordx4 v[4:7], v0, s[16:19], s60 offen sc1
s_mov_b64 exec, -1
v_mov_b32 v8, 0
v_mov_b32 v9, 0
v_lshlrev_b32 v2, 3, v1
ds_write_b64 v2, v[8:9] offset:49152
ds_write_b32 v8, v8 offset:50176
s_setprio 0
L_PR_clr1:
s_add_u32 s63, s78, 0
buffer_load_dwordx2 v[16:17], v11, s[24:27], s63 offen
s_add_u32 s63, s78, 4096
buffer_load_dwordx2 v[18:19], v11, s[24:27], s63 offen
s_add_u32 s63, s74, 0
buffer_load_dwordx4 v[64:67], v10, s[20:23], s63 offen nt
s_add_u32 s63, s74, 12288
buffer_load_dwordx4 v[68:71], v10, s[20:23], s63 offen nt
s_add_u32 s63, s74, 24576
buffer_load_dwordx4 v[72:75], v10, s[20:23], s63 offen nt
s_add_u32 s63, s74, 36864
buffer_load_dwordx4 v[76:79], v10, s[20:23], s63 offen nt
s_add_u32 s63, s74, 49152
buffer_load_dwordx4 v[80:83], v10, s[20:23], s63 offen nt
s_add_u32 s63, s74, 61440
buffer_load_dwordx4 v[84:87], v10, s[20:23], s63 offen nt
s_add_u32 s63, s74, 73728
buffer_load_dwordx4 v[88:91], v10, s[20:23], s63 offen nt
s_add_u32 s63, s74, 86016
buffer_load_dwordx4 v[92:95], v10, s[20:23], s63 offen nt
s_add_u32 s63, s74, 786432
buffer_load_dwordx4 v[96:99], v10, s[20:23], s63 offen nt
s_add_u32 s63, s74, 798720
buffer_load_dwordx4 v[100:103], v10, s[20:23], s63 offen nt
s_add_u32 s63, s74, 811008
buffer_load_dwordx4 v[104:107], v10, s[20:23], s63 offen nt
s_add_u32 s63, s74, 823296
buffer_load_dwordx4 v[108:111], v10, s[20:23], s63 offen nt
s_add_u32 s63, s74, 835584
buffer_load_dwordx4 v[112:115], v10, s[20:23], s63 offen nt
s_add_u32 s63, s74, 847872
buffer_load_dwordx4 v[116:119], v10, s[20:23], s63 offen nt
s_add_u32 s63, s74, 860160
buffer_load_dwordx4 v[120:123], v10, s[20:23], s63 offen nt
s_add_u32 s63, s74, 872448
buffer_load_dwordx4 v[124:127], v10, s[20:23], s63 offen nt
s_mov_b32 s12, s36
s_mov_b32 s13, s37
s_mov_b32 s14, 0x4000000
s_mov_b32 s15, 0x20000
s_mov_b32 s28, s56
s_mov_b32 s29, s57
s_mov_b32 s30, 0x100
s_mov_b32 s31, 0x20000
s_mov_b32 s64, 0x05040100
s_mov_b32 s65, 0x07060302
s_lshl_b32 s60, s3, 12
v_lshrrev_b32 v6, 4, v1
v_lshlrev_b32 v7, 2, v6
v_xor_b32 v7, v7, v1
v_and_b32 v7, 15, v7
v_lshlrev_b32 v7, 4, v7
v_lshl_add_u32 v2, v6, 8, v7
v_add_u32 v2, s60, v2
v_xor_b32 v3, 16, v2
v_xor_b32 v4, 32, v2
v_xor_b32 v5, 48, v2
v_xor_b32 v7, v6, v1
v_and_b32 v7, 15, v7
v_lshlrev_b32 v7, 4, v7
v_and_b32 v8, 3, v1
v_lshl_add_u32 v7, v8, 10, v7
v_bfe_u32 v8, v1, 2, 2
v_lshl_add_u32 v7, v8, 8, v7
v_add_u32 v6, s60, v7
v_xor_b32 v7, 64, v6
v_xor_b32 v8, 128, v6
v_xor_b32 v9, 192, v6
s_cmp_lg_u32 s3, 0
s_cbranch_scc1 L_PR_arr2
s_waitcnt vmcnt(18) lgkmcnt(0)
s_mov_b32 s60, 1
s_atomic_add s60, s[56:57], 128
s_mov_b32 s60, 1
s_atomic_add s60, s[56:57], 0
L_PR_arr2:
s_barrier
s_waitcnt vmcnt(16)
s_lshl_b32 s60, s3, 10
s_add_u32 s60, s60, 40960
v_lshrrev_b32 v12, 5, v1
v_lshlrev_b32 v12, 8, v12
v_and_b32 v20, 15, v1
v_lshl_add_u32 v12, v20, 4, v12
v_bfe_u32 v20, v1, 4, 1
v_lshl_add_u32 v12, v20, 3, v12
v_add_u32 v12, s60, v12
v_lshlrev_b32 v20, 16, v16
v_and_b32 v21, 0xffff0000, v16
v_mul_f32 v22, 0xbfb8aa3b, v20
v_mul_f32 v23, 0xbfb8aa3b, v21
v_exp_f32 v22, v22
v_exp_f32 v23, v23
v_add_f32 v22, 1.0, v22
v_add_f32 v23, 1.0, v23
v_rcp_f32 v24, v22
v_rcp_f32 v25, v23
v_mul_f32 v26, v20, v24
v_mul_f32 v27, v21, v25
v_cvt_pk_bf16_f32 v16, v26, v27
v_lshlrev_b32 v20, 16, v17
v_and_b32 v21, 0xffff0000, v17
v_mul_f32 v22, 0xbfb8aa3b, v20
v_mul_f32 v23, 0xbfb8aa3b, v21
v_exp_f32 v22, v22
v_exp_f32 v23, v23
v_add_f32 v22, 1.0, v22
v_add_f32 v23, 1.0, v23
v_rcp_f32 v24, v22
v_rcp_f32 v25, v23
v_mul_f32 v26, v20, v24
v_mul_f32 v27, v21, v25
v_cvt_pk_bf16_f32 v17, v26, v27
v_lshlrev_b32 v20, 16, v18
v_and_b32 v21, 0xffff0000, v18
v_mul_f32 v22, 0xbfb8aa3b, v20
v_mul_f32 v23, 0xbfb8aa3b, v21
v_exp_f32 v22, v22
v_exp_f32 v23, v23
v_add_f32 v22, 1.0, v22
v_add_f32 v23, 1.0, v23
v_rcp_f32 v24, v22
v_rcp_f32 v25, v23
v_mul_f32 v26, v20, v24
v_mul_f32 v27, v21, v25
v_cvt_pk_bf16_f32 v18, v26, v27
v_lshlrev_b32 v20, 16, v19
v_and_b32 v21, 0xffff0000, v19
v_mul_f32 v22, 0xbfb8aa3b, v20
v_mul_f32 v23, 0xbfb8aa3b, v21
v_exp_f32 v22, v22
v_exp_f32 v23, v23
v_add_f32 v22, 1.0, v22
v_add_f32 v23, 1.0, v23
v_rcp_f32 v24, v22
v_rcp_f32 v25, v23
v_mul_f32 v26, v20, v24
v_mul_f32 v27, v21, v25
v_cvt_pk_bf16_f32 v19, v26, v27
ds_write_b64 v12, v[16:17]
ds_write_b64 v12, v[18:19] offset:512
s_waitcnt vmcnt(8)
v_perm_b32 v32, v68, v64, s64
v_perm_b32 v33, v76, v72, s64
v_perm_b32 v34, v84, v80, s64
v_perm_b32 v35, v92, v88, s64
v_perm_b32 v36, v68, v64, s65
v_perm_b32 v37, v76, v72, s65
v_perm_b32 v38, v84, v80, s65
v_perm_b32 v39, v92, v88, s65
v_perm_b32 v40, v69, v65, s64
v_perm_b32 v41, v77, v73, s64
v_perm_b32 v42, v85, v81, s64
v_perm_b32 v43, v93, v89, s64
v_perm_b32 v44, v69, v65, s65
v_perm_b32 v45, v77, v73, s65
v_perm_b32 v46, v85, v81, s65
v_perm_b32 v47, v93, v89, s65
v_perm_b32 v48, v70, v66, s64
v_perm_b32 v49, v78, v74, s64
v_perm_b32 v50, v86, v82, s64
v_perm_b32 v51, v94, v90, s64
v_perm_b32 v52, v70, v66, s65
v_perm_b32 v53, v78, v74, s65
v_perm_b32 v54, v86, v82, s65
v_perm_b32 v55, v94, v90, s65
v_perm_b32 v56, v71, v67, s64
v_perm_b32 v57, v79, v75, s64
v_perm_b32 v58, v87, v83, s64
v_perm_b32 v59, v95, v91, s64
v_perm_b32 v60, v71, v67, s65
v_perm_b32 v61, v79, v75, s65
v_perm_b32 v62, v87, v83, s65
v_perm_b32 v63, v95, v91, s65
s_waitcnt vmcnt(3)
s_add_u32 s63, s7, 0
buffer_load_dwordx4 v[128:131], v0, s[8:11], s63 offen offset:0 nt
s_waitcnt vmcnt(3)
s_add_u32 s63, s7, 0
buffer_load_dwordx4 v[132:135], v0, s[8:11], s63 offen offset:1024 nt
s_waitcnt vmcnt(3)
s_add_u32 s63, s7, 0
buffer_load_dwordx4 v[136:139], v0, s[8:11], s63 offen offset:2048 nt
s_waitcnt vmcnt(3)
s_add_u32 s63, s7, 0
buffer_load_dwordx4 v[140:143], v0, s[8:11], s63 offen offset:3072 nt
v_perm_b32 v64, v100, v96, s64
v_perm_b32 v65, v108, v104, s64
v_perm_b32 v66, v116, v112, s64
v_perm_b32 v67, v124, v120, s64
v_perm_b32 v68, v100, v96, s65
v_perm_b32 v69, v108, v104, s65
v_perm_b32 v70, v116, v112, s65
v_perm_b32 v71, v124, v120, s65
v_perm_b32 v72, v101, v97, s64
v_perm_b32 v73, v109, v105, s64
v_perm_b32 v74, v117, v113, s64
v_perm_b32 v75, v125, v121, s64
v_perm_b32 v76, v101, v97, s65
v_perm_b32 v77, v109, v105, s65
v_perm_b32 v78, v117, v113, s65
v_perm_b32 v79, v125, v121, s65
v_perm_b32 v80, v102, v98, s64
v_perm_b32 v81, v110, v106, s64
v_perm_b32 v82, v118, v114, s64
v_perm_b32 v83, v126, v122, s64
v_perm_b32 v84, v102, v98, s65
v_perm_b32 v85, v110, v106, s65
v_perm_b32 v86, v118, v114, s65
v_perm_b32 v87, v126, v122, s65
v_perm_b32 v88, v103, v99, s64
v_perm_b32 v89, v111, v107, s64
v_perm_b32 v90, v119, v115, s64
v_perm_b32 v91, v127, v123, s64
v_perm_b32 v92, v103, v99, s65
v_perm_b32 v93, v111, v107, s65
v_perm_b32 v94, v119, v115, s65
v_perm_b32 v95, v127, v123, s65
s_lshl_b32 s60, s3, 10
s_add_u32 s60, s60, 40960
v_and_b32 v12, 3, v1
v_lshlrev_b32 v12, 8, v12
v_lshrrev_b32 v14, 4, v1
v_lshl_add_u32 v12, v14, 5, v12
v_bfe_u32 v14, v1, 3, 1
v_lshl_add_u32 v12, v14, 4, v12
v_add_u32 v12, s60, v12
s_mov_b32 s66, 0x0f0f0f0f
s_mov_b32 s67, 0x0f0f0f0f
v_mov_b32 v14, 49152
v_cndmask_b32 v13, v12, v14, s[66:67]
v_cndmask_b32 v12, v14, v12, s[66:67]
ds_read_b128 v[96:99], v12 offset:0
ds_read_b128 v[100:103], v13 offset:0
ds_read_b128 v[104:107], v12 offset:128
ds_read_b128 v[108:111], v13 offset:128
s_lshl_b32 s60, s3, 11
s_add_u32 s60, s60, 60416
v_lshrrev_b32 v12, 5, v1
v_lshlrev_b32 v12, 10, v12
v_and_b32 v14, 3, v1
v_lshl_add_u32 v12, v14, 8, v12
v_bfe_u32 v14, v1, 2, 1
v_lshl_add_u32 v12, v14, 7, v12
v_bfe_u32 v14, v1, 4, 1
v_lshl_add_u32 v12, v14, 4, v12
v_add_u32 v12, s60, v12
s_waitcnt lgkmcnt(0)
v_mfma_f32_16x16x32_bf16 v[112:115], v[32:35], v[96:99], 0
v_mfma_f32_16x16x32_bf16 v[116:119], v[36:39], v[96:99], 0
v_mfma_f32_16x16x32_bf16 v[120:123], v[40:43], v[96:99], 0
v_mfma_f32_16x16x32_bf16 v[124:127], v[44:47], v[96:99], 0
v_mfma_f32_16x16x32_bf16 v[112:115], v[48:51], v[100:103], v[112:115]
v_mfma_f32_16x16x32_bf16 v[116:119], v[52:55], v[100:103], v[116:119]
v_mfma_f32_16x16x32_bf16 v[120:123], v[56:59], v[100:103], v[120:123]
v_mfma_f32_16x16x32_bf16 v[124:127], v[60:63], v[100:103], v[124:127]
v_mfma_f32_16x16x32_bf16 v[112:115], v[64:67], v[104:107], v[112:115]
v_mfma_f32_16x16x32_bf16 v[116:119], v[68:71], v[104:107], v[116:119]
v_mfma_f32_16x16x32_bf16 v[120:123], v[72:75], v[104:107], v[120:123]
v_mfma_f32_16x16x32_bf16 v[124:127], v[76:79], v[104:107], v[124:127]
v_mfma_f32_16x16x32_bf16 v[112:115], v[80:83], v[108:111], v[112:115]
v_mfma_f32_16x16x32_bf16 v[116:119], v[84:87], v[108:111], v[116:119]
v_mfma_f32_16x16x32_bf16 v[120:123], v[88:91], v[108:111], v[120:123]
v_mfma_f32_16x16x32_bf16 v[124:127], v[92:95], v[108:111], v[124:127]
s_mov_b32 exec_lo, 0xff00ff
s_mov_b32 exec_hi, 0xff00ff00
s_nop 2
ds_write_b128 v12, v[112:115] offset:0
ds_write_b128 v12, v[116:119] offset:32
ds_write_b128 v12, v[120:123] offset:64
ds_write_b128 v12, v[124:127] offset:96
s_mov_b64 exec, -1
s_lshl_b32 s60, s3, 8
s_add_u32 s60, s60, 60416
v_bfe_u32 v13, v1, 2, 1
v_lshlrev_b32 v13, 7, v13
v_and_b32 v14, 3, v1
v_lshl_add_u32 v13, v14, 5, v13
v_lshrrev_b32 v14, 5, v1
v_lshl_add_u32 v13, v14, 4, v13
v_bfe_u32 v14, v1, 3, 2
v_lshl_add_u32 v13, v14, 2, v13
v_add_u32 v13, s60, v13
s_waitcnt lgkmcnt(0)
s_barrier
s_cmp_ge_u32 s3, 4
s_cbranch_scc1 L_PR_fin3
ds_read2st64_b32 v[96:97], v13 offset0:0 offset1:4
ds_read2st64_b32 v[98:99], v13 offset0:8 offset1:12
ds_read2st64_b32 v[100:101], v13 offset0:16 offset1:20
ds_read2st64_b32 v[102:103], v13 offset0:24 offset1:28
ds_read2st64_b32 v[104:105], v13 offset0:32 offset1:36
ds_read2st64_b32 v[106:107], v13 offset0:40 offset1:44
ds_read2st64_b32 v[108:109], v13 offset0:48 offset1:52
ds_read2st64_b32 v[110:111], v13 offset0:56 offset1:60
s_mul_i32 s60, s3, 2048
s_add_u32 s60, s60, s73
v_lshlrev_b32 v12, 1, v1
s_waitcnt lgkmcnt(0)
v_add_f32 v96, v96, v104
v_add_f32 v97, v97, v105
v_add_f32 v98, v98, v106
v_add_f32 v99, v99, v107
v_add_f32 v100, v100, v108
v_add_f32 v101, v101, v109
v_add_f32 v102, v102, v110
v_add_f32 v103, v103, v111
v_add_f32 v96, v96, v100
v_add_f32 v97, v97, v101
v_add_f32 v98, v98, v102
v_add_f32 v99, v99, v103
v_add_f32 v96, v96, v98
v_add_f32 v97, v97, v99
v_add_f32 v96, v96, v97
s_nop 1
v_mov_b32_dpp v97, v96 quad_perm:[1,1,3,3] row_mask:0xf bank_mask:0xf
v_cvt_pk_bf16_f32 v112, v96, v97
s_nop 1
v_mov_b32_dpp v113, v112 row_shl:2 row_mask:0xf bank_mask:0xf
v_mov_b32_dpp v114, v112 row_shl:4 row_mask:0xf bank_mask:0xf
v_mov_b32_dpp v115, v112 row_shl:6 row_mask:0xf bank_mask:0xf
s_mov_b32 exec_lo, 0x1010101
s_mov_b32 exec_hi, 0x1010101
buffer_store_dwordx4 v[112:115], v12, s[16:19], s60 offen sc1
s_mov_b64 exec, -1
L_PR_fin3:
s_waitcnt vmcnt(3)
s_add_u32 s63, s7, 32768
buffer_load_dwordx4 v[144:147], v0, s[8:11], s63 offen offset:0 nt
s_waitcnt vmcnt(3)
s_add_u32 s63, s7, 32768
buffer_load_dwordx4 v[148:151], v0, s[8:11], s63 offen offset:1024 nt
s_waitcnt vmcnt(3)
s_add_u32 s63, s7, 32768
buffer_load_dwordx4 v[152:155], v0, s[8:11], s63 offen offset:2048 nt
s_waitcnt vmcnt(3)
s_add_u32 s63, s7, 32768
buffer_load_dwordx4 v[156:159], v0, s[8:11], s63 offen offset:3072 nt
ds_write_b128 v2, v[128:131] offset:0
ds_write_b128 v3, v[132:135] offset:1024
ds_write_b128 v4, v[136:139] offset:2048
ds_write_b128 v5, v[140:143] offset:3072
ds_read_b128 v[128:131], v6
ds_read_b128 v[132:135], v7
ds_read_b128 v[136:139], v8
ds_read_b128 v[140:143], v9
s_waitcnt vmcnt(3)
s_add_u32 s63, s7, 65536
buffer_load_dwordx4 v[160:163], v0, s[8:11], s63 offen offset:0 nt
s_waitcnt vmcnt(3)
s_add_u32 s63, s7, 65536
buffer_load_dwordx4 v[164:167], v0, s[8:11], s63 offen offset:1024 nt
s_waitcnt vmcnt(3)
s_add_u32 s63, s7, 65536
buffer_load_dwordx4 v[168:171], v0, s[8:11], s63 offen offset:2048 nt
s_waitcnt vmcnt(3)
s_add_u32 s63, s7, 65536
buffer_load_dwordx4 v[172:175], v0, s[8:11], s63 offen offset:3072 nt
ds_write_b128 v2, v[144:147] offset:0
ds_write_b128 v3, v[148:151] offset:1024
ds_write_b128 v4, v[152:155] offset:2048
ds_write_b128 v5, v[156:159] offset:3072
ds_read_b128 v[144:147], v6
ds_read_b128 v[148:151], v7
ds_read_b128 v[152:155], v8
ds_read_b128 v[156:159], v9
s_waitcnt vmcnt(3)
s_add_u32 s63, s7, 98304
buffer_load_dwordx4 v[176:179], v0, s[8:11], s63 offen offset:0 nt
s_waitcnt vmcnt(3)
s_add_u32 s63, s7, 98304
buffer_load_dwordx4 v[180:183], v0, s[8:11], s63 offen offset:1024 nt
s_waitcnt vmcnt(3)
s_add_u32 s63, s7, 98304
buffer_load_dwordx4 v[184:187], v0, s[8:11], s63 offen offset:2048 nt
s_waitcnt vmcnt(3)
s_add_u32 s63, s7, 98304
buffer_load_dwordx4 v[188:191], v0, s[8:11], s63 offen offset:3072 nt
ds_write_b128 v2, v[160:163] offset:0
ds_write_b128 v3, v[164:167] offset:1024
ds_write_b128 v4, v[168:171] offset:2048
ds_write_b128 v5, v[172:175] offset:3072
ds_read_b128 v[160:163], v6
ds_read_b128 v[164:167], v7
ds_read_b128 v[168:171], v8
ds_read_b128 v[172:175], v9
s_waitcnt vmcnt(3)
s_add_u32 s63, s7, 131072
buffer_load_dwordx4 v[192:195], v0, s[8:11], s63 offen offset:0 nt
s_waitcnt vmcnt(3)
s_add_u32 s63, s7, 131072
buffer_load_dwordx4 v[196:199], v0, s[8:11], s63 offen offset:1024 nt
s_waitcnt vmcnt(3)
s_add_u32 s63, s7, 131072
buffer_load_dwordx4 v[200:203], v0, s[8:11], s63 offen offset:2048 nt
s_waitcnt vmcnt(3)
s_add_u32 s63, s7, 131072
buffer_load_dwordx4 v[204:207], v0, s[8:11], s63 offen offset:3072 nt
ds_write_b128 v2, v[176:179] offset:0
ds_write_b128 v3, v[180:183] offset:1024
ds_write_b128 v4, v[184:187] offset:2048
ds_write_b128 v5, v[188:191] offset:3072
ds_read_b128 v[176:179], v6
ds_read_b128 v[180:183], v7
ds_read_b128 v[184:187], v8
ds_read_b128 v[188:191], v9
s_waitcnt vmcnt(3)
s_mov_b32 s24, s46
s_mov_b32 s25, s47
s_mov_b32 s26, 0x700000
s_mov_b32 s27, 0x20000
s_sub_u32 s62, s2, 200
s_lshl_b32 s62, s62, 3
s_add_u32 s62, s62, s3
s_mul_i32 s62, s62, 8192
s_add_u32 s62, s62, 6291840
v_lshrrev_b32 v15, 3, v1
v_lshlrev_b32 v15, 10, v15
v_and_b32 v252, 7, v1
v_lshl_add_u32 v15, v252, 4, v15
s_min_u32 s62, s62, 7332224
buffer_load_dwordx4 v[252:255], v15, s[24:27], s62 offen
s_waitcnt vmcnt(3)
s_add_u32 s63, s7, 163840
buffer_load_dwordx4 v[208:211], v0, s[8:11], s63 offen offset:0 nt
s_waitcnt vmcnt(3)
s_add_u32 s63, s7, 163840
buffer_load_dwordx4 v[212:215], v0, s[8:11], s63 offen offset:1024 nt
s_waitcnt vmcnt(3)
s_add_u32 s63, s7, 163840
buffer_load_dwordx4 v[216:219], v0, s[8:11], s63 offen offset:2048 nt
ds_write_b128 v2, v[192:195] offset:0
ds_write_b128 v3, v[196:199] offset:1024
ds_write_b128 v4, v[200:203] offset:2048
ds_write_b128 v5, v[204:207] offset:3072
ds_read_b128 v[192:195], v6
ds_read_b128 v[196:199], v7
ds_read_b128 v[200:203], v8
ds_read_b128 v[204:207], v9
s_waitcnt vmcnt(3)
s_add_u32 s63, s7, 163840
buffer_load_dwordx4 v[220:223], v0, s[8:11], s63 offen offset:3072 nt
s_waitcnt vmcnt(3)
buffer_load_dword v10, off, s[28:31], 0 offset:0 sc1
s_waitcnt vmcnt(3)
s_add_u32 s63, s7, 196608
buffer_load_dwordx4 v[224:227], v0, s[8:11], s63 offen offset:0 nt
s_waitcnt vmcnt(3)
s_add_u32 s63, s7, 196608
buffer_load_dwordx4 v[228:231], v0, s[8:11], s63 offen offset:1024 nt
s_waitcnt vmcnt(3)
s_add_u32 s63, s7, 196608
buffer_load_dwordx4 v[232:235], v0, s[8:11], s63 offen offset:2048 nt
ds_write_b128 v2, v[208:211] offset:0
ds_write_b128 v3, v[212:215] offset:1024
ds_write_b128 v4, v[216:219] offset:2048
ds_write_b128 v5, v[220:223] offset:3072
ds_read_b128 v[208:211], v6
ds_read_b128 v[212:215], v7
ds_read_b128 v[216:219], v8
ds_read_b128 v[220:223], v9
s_waitcnt vmcnt(3)
s_add_u32 s63, s7, 196608
buffer_load_dwordx4 v[236:239], v0, s[8:11], s63 offen offset:3072 nt
s_waitcnt vmcnt(3)
s_add_u32 s63, s7, 229376
buffer_load_dwordx4 v[240:243], v0, s[8:11], s63 offen offset:0 nt
s_waitcnt vmcnt(3)
s_add_u32 s63, s7, 229376
buffer_load_dwordx4 v[244:247], v0, s[8:11], s63 offen offset:1024 nt
s_waitcnt vmcnt(3)
s_add_u32 s63, s7, 229376
buffer_load_dwordx4 v[248:251], v0, s[8:11], s63 offen offset:2048 nt
s_waitcnt vmcnt(3)
s_add_u32 s63, s7, 229376
buffer_load_dwordx4 v[252:255], v0, s[8:11], s63 offen offset:3072 nt
ds_write_b128 v2, v[224:227] offset:0
ds_write_b128 v3, v[228:231] offset:1024
ds_write_b128 v4, v[232:235] offset:2048
ds_write_b128 v5, v[236:239] offset:3072
ds_read_b128 v[224:227], v6
ds_read_b128 v[228:231], v7
ds_read_b128 v[232:235], v8
ds_read_b128 v[236:239], v9
v_readfirstlane_b32 s60, v10
s_mov_b32 s70, 0
s_cmp_ge_u32 s60, 256
s_cbranch_scc1 L_PR_cok4
L_PR_cretry5:
buffer_load_dword v10, off, s[28:31], 0 offset:0 sc1
s_waitcnt vmcnt(0)
v_readfirstlane_b32 s60, v10
s_add_u32 s70, s70, 1
s_cmp_ge_u32 s70, 262144
s_cbranch_scc1 L_PR_cok4
s_cmp_lt_u32 s60, 256
s_cbranch_scc1 L_PR_cretry5
L_PR_cok4:
s_waitcnt vmcnt(3)
s_lshr_b32 s75, s5, 4
s_lshl_b32 s75, s75, 11
s_add_u32 s75, s75, 65536
buffer_load_dwordx4 v[16:19], v0, s[16:19], s75 offen offset:0 sc1
buffer_load_dwordx4 v[20:23], v0, s[16:19], s75 offen offset:1024 sc1
s_waitcnt vmcnt(3)
s_add_u32 s63, s7, 0
buffer_load_dwordx4 v[64:67], v0, s[12:15], s63 offen offset:0 nt
s_waitcnt vmcnt(3)
s_add_u32 s63, s7, 0
buffer_load_dwordx4 v[68:71], v0, s[12:15], s63 offen offset:1024 nt
ds_write_b128 v2, v[240:243] offset:0
ds_write_b128 v3, v[244:247] offset:1024
ds_write_b128 v4, v[248:251] offset:2048
ds_write_b128 v5, v[252:255] offset:3072
ds_read_b128 v[240:243], v6
ds_read_b128 v[244:247], v7
ds_read_b128 v[248:251], v8
ds_read_b128 v[252:255], v9
s_mov_b32 s20, s52
s_mov_b32 s21, s53
s_mov_b32 s22, 0xc00000
s_mov_b32 s23, 0x20000
s_mov_b32 s24, s50
s_mov_b32 s25, s51
s_mov_b32 s26, 0x2000
s_mov_b32 s27, 0x20000
v_lshrrev_b32 v12, 3, v1
v_mul_u32_u24 v12, 98304, v12
v_and_b32 v13, 7, v1
v_lshl_add_u32 v12, v13, 4, v12
s_mul_i32 s74, s3, 1572864
s_add_u32 s74, s74, s77
v_lshrrev_b32 v13, 5, v1
v_lshlrev_b32 v13, 11, v13
v_and_b32 v14, 15, v1
v_lshl_add_u32 v13, v14, 4, v13
v_bfe_u32 v14, v1, 4, 1
v_lshl_add_u32 v13, v14, 3, v13
s_lshl_b32 s78, s3, 8
s_cmp_lt_u32 s3, 4
s_cbranch_scc1 L_PR_pr6
s_setprio 1
L_PR_pr6:
s_lshl_b32 s60, s3, 12
v_and_b32 v10, 3, v1
v_lshlrev_b32 v10, 2, v10
v_bfe_u32 v11, v1, 2, 1
v_or_b32 v10, v10, v11
v_lshrrev_b32 v11, 4, v1
v_xor_b32 v10, v10, v11
v_lshlrev_b32 v10, 4, v10
v_and_b32 v11, 7, v1
v_lshl_add_u32 v10, v11, 8, v10
v_add_u32 v6, s60, v10
v_xor_b32 v7, 64, v6
v_xor_b32 v8, 128, v6
v_xor_b32 v9, 192, v6
s_waitcnt vmcnt(3)
s_add_u32 s63, s7, 0
buffer_load_dwordx4 v[72:75], v0, s[12:15], s63 offen offset:2048 nt
s_waitcnt vmcnt(3)
s_add_u32 s63, s7, 0
buffer_load_dwordx4 v[76:79], v0, s[12:15], s63 offen offset:3072 nt
v_max_u32 v10, v16, v17
v_max3_u32 v10, v10, v18, v19
v_max3_u32 v10, v10, v20, v21
v_max3_u32 v10, v10, v22, v23
v_cmp_eq_u32 vcc, -1, v10
s_cbranch_vccz L_PR_ok7
s_mov_b32 s70, 0
L_PR_retry8:
buffer_load_dwordx4 v[16:19], v0, s[16:19], s75 offen offset:0 sc1
buffer_load_dwordx4 v[20:23], v0, s[16:19], s75 offen offset:1024 sc1
s_waitcnt vmcnt(0)
v_max_u32 v10, v16, v17
v_max3_u32 v10, v10, v18, v19
v_max3_u32 v10, v10, v20, v21
v_max3_u32 v10, v10, v22, v23
s_add_u32 s70, s70, 1
s_cmp_ge_u32 s70, 262144
s_cbranch_scc1 L_PR_ok7
v_cmp_eq_u32 vcc, -1, v10
s_cbranch_vccnz L_PR_retry8
L_PR_ok7:
ds_write_b128 v2, v[16:19] offset:0
ds_write_b128 v3, v[20:23] offset:1024
ds_read_b128 v[16:19], v6
ds_read_b128 v[20:23], v7
ds_read_b128 v[24:27], v8
ds_read_b128 v[28:31], v9
s_waitcnt lgkmcnt(0)
v_mfma_f32_16x16x32_bf16 v[32:35], v[128:131], v[16:19], 0
v_mfma_f32_16x16x32_bf16 v[32:35], v[132:135], v[20:23], v[32:35]
v_mfma_f32_16x16x32_bf16 v[32:35], v[136:139], v[24:27], v[32:35]
v_mfma_f32_16x16x32_bf16 v[32:35], v[140:143], v[28:31], v[32:35]
v_mfma_f32_16x16x32_bf16 v[36:39], v[144:147], v[16:19], 0
v_mfma_f32_16x16x32_bf16 v[36:39], v[148:151], v[20:23], v[36:39]
v_mfma_f32_16x16x32_bf16 v[36:39], v[152:155], v[24:27], v[36:39]
v_mfma_f32_16x16x32_bf16 v[36:39], v[156:159], v[28:31], v[36:39]
s_add_u32 s63, s7, 32768
buffer_load_dwordx4 v[80:83], v0, s[12:15], s63 offen offset:0 nt
s_add_u32 s63, s7, 32768
buffer_load_dwordx4 v[84:87], v0, s[12:15], s63 offen offset:1024 nt
v_mfma_f32_16x16x32_bf16 v[40:43], v[160:163], v[16:19], 0
v_mfma_f32_16x16x32_bf16 v[40:43], v[164:167], v[20:23], v[40:43]
v_mfma_f32_16x16x32_bf16 v[40:43], v[168:171], v[24:27], v[40:43]
v_mfma_f32_16x16x32_bf16 v[40:43], v[172:175], v[28:31], v[40:43]
v_mfma_f32_16x16x32_bf16 v[44:47], v[176:179], v[16:19], 0
v_mfma_f32_16x16x32_bf16 v[44:47], v[180:183], v[20:23], v[44:47]
v_mfma_f32_16x16x32_bf16 v[44:47], v[184:187], v[24:27], v[44:47]
v_mfma_f32_16x16x32_bf16 v[44:47], v[188:191], v[28:31], v[44:47]
v_mfma_f32_16x16x32_bf16 v[48:51], v[192:195], v[16:19], 0
v_mfma_f32_16x16x32_bf16 v[48:51], v[196:199], v[20:23], v[48:51]
v_mfma_f32_16x16x32_bf16 v[48:51], v[200:203], v[24:27], v[48:51]
v_mfma_f32_16x16x32_bf16 v[48:51], v[204:207], v[28:31], v[48:51]
v_mfma_f32_16x16x32_bf16 v[52:55], v[208:211], v[16:19], 0
v_mfma_f32_16x16x32_bf16 v[52:55], v[212:215], v[20:23], v[52:55]
v_mfma_f32_16x16x32_bf16 v[52:55], v[216:219], v[24:27], v[52:55]
v_mfma_f32_16x16x32_bf16 v[52:55], v[220:223], v[28:31], v[52:55]
v_mfma_f32_16x16x32_bf16 v[56:59], v[224:227], v[16:19], 0
v_mfma_f32_16x16x32_bf16 v[56:59], v[228:231], v[20:23], v[56:59]
v_mfma_f32_16x16x32_bf16 v[56:59], v[232:235], v[24:27], v[56:59]
v_mfma_f32_16x16x32_bf16 v[56:59], v[236:239], v[28:31], v[56:59]
v_mfma_f32_16x16x32_bf16 v[60:63], v[240:243], v[16:19], 0
v_mfma_f32_16x16x32_bf16 v[60:63], v[244:247], v[20:23], v[60:63]
v_mfma_f32_16x16x32_bf16 v[60:63], v[248:251], v[24:27], v[60:63]
v_mfma_f32_16x16x32_bf16 v[60:63], v[252:255], v[28:31], v[60:63]
s_add_u32 s63, s7, 32768
buffer_load_dwordx4 v[88:91], v0, s[12:15], s63 offen offset:2048 nt
v_cvt_pk_bf16_f32 v2, v32, v33
v_lshlrev_b32 v32, 16, v2
v_and_b32 v33, 0xffff0000, v2
v_cvt_pk_bf16_f32 v3, v34, v35
v_lshlrev_b32 v34, 16, v3
v_and_b32 v35, 0xffff0000, v3
v_mul_f32 v32, 0x3db504f3, v32
v_mul_f32 v33, 0x3db504f3, v33
v_mul_f32 v34, 0x3db504f3, v34
v_mul_f32 v35, 0x3db504f3, v35
v_cvt_pk_bf16_f32 v2, v32, v33
v_lshlrev_b32 v32, 16, v2
v_and_b32 v33, 0xffff0000, v2
v_cvt_pk_bf16_f32 v3, v34, v35
v_lshlrev_b32 v34, 16, v3
v_and_b32 v35, 0xffff0000, v3
v_max_f32 v4, v32, v33
v_max3_f32 v4, v4, v34, v35
v_cvt_pk_bf16_f32 v2, v36, v37
v_lshlrev_b32 v36, 16, v2
v_and_b32 v37, 0xffff0000, v2
v_cvt_pk_bf16_f32 v3, v38, v39
v_lshlrev_b32 v38, 16, v3
v_and_b32 v39, 0xffff0000, v3
v_mul_f32 v36, 0x3db504f3, v36
v_mul_f32 v37, 0x3db504f3, v37
v_mul_f32 v38, 0x3db504f3, v38
v_mul_f32 v39, 0x3db504f3, v39
v_cvt_pk_bf16_f32 v2, v36, v37
v_lshlrev_b32 v36, 16, v2
v_and_b32 v37, 0xffff0000, v2
v_cvt_pk_bf16_f32 v3, v38, v39
v_lshlrev_b32 v38, 16, v3
v_and_b32 v39, 0xffff0000, v3
v_max3_f32 v4, v4, v36, v37
v_max3_f32 v4, v4, v38, v39
v_cvt_pk_bf16_f32 v2, v40, v41
v_lshlrev_b32 v40, 16, v2
v_and_b32 v41, 0xffff0000, v2
v_cvt_pk_bf16_f32 v3, v42, v43
v_lshlrev_b32 v42, 16, v3
v_and_b32 v43, 0xffff0000, v3
v_mul_f32 v40, 0x3db504f3, v40
v_mul_f32 v41, 0x3db504f3, v41
v_mul_f32 v42, 0x3db504f3, v42
v_mul_f32 v43, 0x3db504f3, v43
v_cvt_pk_bf16_f32 v2, v40, v41
v_lshlrev_b32 v40, 16, v2
v_and_b32 v41, 0xffff0000, v2
v_cvt_pk_bf16_f32 v3, v42, v43
v_lshlrev_b32 v42, 16, v3
v_and_b32 v43, 0xffff0000, v3
v_max3_f32 v4, v4, v40, v41
v_max3_f32 v4, v4, v42, v43
v_cvt_pk_bf16_f32 v2, v44, v45
v_lshlrev_b32 v44, 16, v2
v_and_b32 v45, 0xffff0000, v2
v_cvt_pk_bf16_f32 v3, v46, v47
v_lshlrev_b32 v46, 16, v3
v_and_b32 v47, 0xffff0000, v3
v_mul_f32 v44, 0x3db504f3, v44
v_mul_f32 v45, 0x3db504f3, v45
v_mul_f32 v46, 0x3db504f3, v46
v_mul_f32 v47, 0x3db504f3, v47
v_cvt_pk_bf16_f32 v2, v44, v45
v_lshlrev_b32 v44, 16, v2
v_and_b32 v45, 0xffff0000, v2
v_cvt_pk_bf16_f32 v3, v46, v47
v_lshlrev_b32 v46, 16, v3
v_and_b32 v47, 0xffff0000, v3
v_max3_f32 v4, v4, v44, v45
v_max3_f32 v4, v4, v46, v47
v_cvt_pk_bf16_f32 v2, v48, v49
v_lshlrev_b32 v48, 16, v2
v_and_b32 v49, 0xffff0000, v2
v_cvt_pk_bf16_f32 v3, v50, v51
v_lshlrev_b32 v50, 16, v3
v_and_b32 v51, 0xffff0000, v3
v_mul_f32 v48, 0x3db504f3, v48
v_mul_f32 v49, 0x3db504f3, v49
v_mul_f32 v50, 0x3db504f3, v50
v_mul_f32 v51, 0x3db504f3, v51
v_cvt_pk_bf16_f32 v2, v48, v49
v_lshlrev_b32 v48, 16, v2
v_and_b32 v49, 0xffff0000, v2
v_cvt_pk_bf16_f32 v3, v50, v51
v_lshlrev_b32 v50, 16, v3
v_and_b32 v51, 0xffff0000, v3
v_max3_f32 v4, v4, v48, v49
v_max3_f32 v4, v4, v50, v51
v_cvt_pk_bf16_f32 v2, v52, v53
v_lshlrev_b32 v52, 16, v2
v_and_b32 v53, 0xffff0000, v2
v_cvt_pk_bf16_f32 v3, v54, v55
v_lshlrev_b32 v54, 16, v3
v_and_b32 v55, 0xffff0000, v3
v_mul_f32 v52, 0x3db504f3, v52
v_mul_f32 v53, 0x3db504f3, v53
v_mul_f32 v54, 0x3db504f3, v54
v_mul_f32 v55, 0x3db504f3, v55
v_cvt_pk_bf16_f32 v2, v52, v53
v_lshlrev_b32 v52, 16, v2
v_and_b32 v53, 0xffff0000, v2
v_cvt_pk_bf16_f32 v3, v54, v55
v_lshlrev_b32 v54, 16, v3
v_and_b32 v55, 0xffff0000, v3
v_max3_f32 v4, v4, v52, v53
v_max3_f32 v4, v4, v54, v55
v_cvt_pk_bf16_f32 v2, v56, v57
v_lshlrev_b32 v56, 16, v2
v_and_b32 v57, 0xffff0000, v2
v_cvt_pk_bf16_f32 v3, v58, v59
v_lshlrev_b32 v58, 16, v3
v_and_b32 v59, 0xffff0000, v3
v_mul_f32 v56, 0x3db504f3, v56
v_mul_f32 v57, 0x3db504f3, v57
v_mul_f32 v58, 0x3db504f3, v58
v_mul_f32 v59, 0x3db504f3, v59
v_cvt_pk_bf16_f32 v2, v56, v57
v_lshlrev_b32 v56, 16, v2
v_and_b32 v57, 0xffff0000, v2
v_cvt_pk_bf16_f32 v3, v58, v59
v_lshlrev_b32 v58, 16, v3
v_and_b32 v59, 0xffff0000, v3
v_max3_f32 v4, v4, v56, v57
v_max3_f32 v4, v4, v58, v59
v_cvt_pk_bf16_f32 v2, v60, v61
v_lshlrev_b32 v60, 16, v2
v_and_b32 v61, 0xffff0000, v2
v_cvt_pk_bf16_f32 v3, v62, v63
v_lshlrev_b32 v62, 16, v3
v_and_b32 v63, 0xffff0000, v3
v_mul_f32 v60, 0x3db504f3, v60
v_mul_f32 v61, 0x3db504f3, v61
v_mul_f32 v62, 0x3db504f3, v62
v_mul_f32 v63, 0x3db504f3, v63
v_cvt_pk_bf16_f32 v2, v60, v61
v_lshlrev_b32 v60, 16, v2
v_and_b32 v61, 0xffff0000, v2
v_cvt_pk_bf16_f32 v3, v62, v63
v_lshlrev_b32 v62, 16, v3
v_and_b32 v63, 0xffff0000, v3
v_max3_f32 v4, v4, v60, v61
v_max3_f32 v4, v4, v62, v63
s_waitcnt vmcnt(4)
s_add_u32 s63, s7, 32768
buffer_load_dwordx4 v[92:95], v0, s[12:15], s63 offen offset:3072 nt
s_waitcnt vmcnt(4)
s_add_u32 s63, s7, 65536
buffer_load_dwordx4 v[96:99], v0, s[12:15], s63 offen offset:0 nt
v_mov_b32 v5, v4
s_nop 1
v_permlane16_swap_b32 v4, v5
v_max_f32 v4, v4, v5
v_mov_b32 v5, v4
s_nop 1
v_permlane32_swap_b32 v4, v5
v_max_f32 v4, v4, v5
v_mul_f32 v6, 0xbfb8aa3b, v4
s_mov_b32 s60, 0x3fb8aa3b
s_mov_b32 s66, 0x00ff00ff
s_mov_b32 s67, 0x00ff00ff
v_mov_b32 v5, 0
v_fma_f32 v32, v32, s60, v6
v_fma_f32 v33, v33, s60, v6
v_fma_f32 v34, v34, s60, v6
v_fma_f32 v35, v35, s60, v6
v_exp_f32 v32, v32
v_exp_f32 v33, v33
v_exp_f32 v34, v34
v_exp_f32 v35, v35
v_add_f32 v7, v32, v33
v_add_f32 v8, v34, v35
v_cvt_pk_bf16_f32 v2, v32, v33
v_cvt_pk_bf16_f32 v3, v34, v35
v_add_f32 v5, v5, v7
v_add_f32 v5, v5, v8
v_cndmask_b32 v16, 0, v2, s[66:67]
v_cndmask_b32 v32, v2, 0, s[66:67]
v_cndmask_b32 v17, 0, v3, s[66:67]
v_cndmask_b32 v33, v3, 0, s[66:67]
v_fma_f32 v36, v36, s60, v6
v_fma_f32 v37, v37, s60, v6
v_fma_f32 v38, v38, s60, v6
v_fma_f32 v39, v39, s60, v6
v_exp_f32 v36, v36
v_exp_f32 v37, v37
v_exp_f32 v38, v38
v_exp_f32 v39, v39
v_add_f32 v7, v36, v37
v_add_f32 v8, v38, v39
v_cvt_pk_bf16_f32 v2, v36, v37
v_cvt_pk_bf16_f32 v3, v38, v39
v_add_f32 v5, v5, v7
v_add_f32 v5, v5, v8
v_cndmask_b32 v18, 0, v2, s[66:67]
v_cndmask_b32 v34, v2, 0, s[66:67]
v_cndmask_b32 v19, 0, v3, s[66:67]
v_cndmask_b32 v35, v3, 0, s[66:67]
v_fma_f32 v40, v40, s60, v6
v_fma_f32 v41, v41, s60, v6
v_fma_f32 v42, v42, s60, v6
v_fma_f32 v43, v43, s60, v6
v_exp_f32 v40, v40
v_exp_f32 v41, v41
v_exp_f32 v42, v42
v_exp_f32 v43, v43
v_add_f32 v7, v40, v41
v_add_f32 v8, v42, v43
v_cvt_pk_bf16_f32 v2, v40, v41
v_cvt_pk_bf16_f32 v3, v42, v43
v_add_f32 v5, v5, v7
v_add_f32 v5, v5, v8
v_cndmask_b32 v20, 0, v2, s[66:67]
v_cndmask_b32 v36, v2, 0, s[66:67]
v_cndmask_b32 v21, 0, v3, s[66:67]
v_cndmask_b32 v37, v3, 0, s[66:67]
v_fma_f32 v44, v44, s60, v6
v_fma_f32 v45, v45, s60, v6
v_fma_f32 v46, v46, s60, v6
v_fma_f32 v47, v47, s60, v6
v_exp_f32 v44, v44
v_exp_f32 v45, v45
v_exp_f32 v46, v46
v_exp_f32 v47, v47
v_add_f32 v7, v44, v45
v_add_f32 v8, v46, v47
v_cvt_pk_bf16_f32 v2, v44, v45
v_cvt_pk_bf16_f32 v3, v46, v47
v_add_f32 v5, v5, v7
v_add_f32 v5, v5, v8
v_cndmask_b32 v22, 0, v2, s[66:67]
v_cndmask_b32 v38, v2, 0, s[66:67]
v_cndmask_b32 v23, 0, v3, s[66:67]
v_cndmask_b32 v39, v3, 0, s[66:67]
v_fma_f32 v48, v48, s60, v6
v_fma_f32 v49, v49, s60, v6
v_fma_f32 v50, v50, s60, v6
v_fma_f32 v51, v51, s60, v6
v_exp_f32 v48, v48
v_exp_f32 v49, v49
v_exp_f32 v50, v50
v_exp_f32 v51, v51
v_add_f32 v7, v48, v49
v_add_f32 v8, v50, v51
v_cvt_pk_bf16_f32 v2, v48, v49
v_cvt_pk_bf16_f32 v3, v50, v51
v_add_f32 v5, v5, v7
v_add_f32 v5, v5, v8
v_cndmask_b32 v24, 0, v2, s[66:67]
v_cndmask_b32 v40, v2, 0, s[66:67]
v_cndmask_b32 v25, 0, v3, s[66:67]
v_cndmask_b32 v41, v3, 0, s[66:67]
v_fma_f32 v52, v52, s60, v6
v_fma_f32 v53, v53, s60, v6
v_fma_f32 v54, v54, s60, v6
v_fma_f32 v55, v55, s60, v6
v_exp_f32 v52, v52
v_exp_f32 v53, v53
v_exp_f32 v54, v54
v_exp_f32 v55, v55
v_add_f32 v7, v52, v53
v_add_f32 v8, v54, v55
v_cvt_pk_bf16_f32 v2, v52, v53
v_cvt_pk_bf16_f32 v3, v54, v55
v_add_f32 v5, v5, v7
v_add_f32 v5, v5, v8
v_cndmask_b32 v26, 0, v2, s[66:67]
v_cndmask_b32 v42, v2, 0, s[66:67]
v_cndmask_b32 v27, 0, v3, s[66:67]
v_cndmask_b32 v43, v3, 0, s[66:67]
v_fma_f32 v56, v56, s60, v6
v_fma_f32 v57, v57, s60, v6
v_fma_f32 v58, v58, s60, v6
v_fma_f32 v59, v59, s60, v6
v_exp_f32 v56, v56
v_exp_f32 v57, v57
v_exp_f32 v58, v58
v_exp_f32 v59, v59
v_add_f32 v7, v56, v57
v_add_f32 v8, v58, v59
v_cvt_pk_bf16_f32 v2, v56, v57
v_cvt_pk_bf16_f32 v3, v58, v59
v_add_f32 v5, v5, v7
v_add_f32 v5, v5, v8
v_cndmask_b32 v28, 0, v2, s[66:67]
v_cndmask_b32 v44, v2, 0, s[66:67]
v_cndmask_b32 v29, 0, v3, s[66:67]
v_cndmask_b32 v45, v3, 0, s[66:67]
v_fma_f32 v60, v60, s60, v6
v_fma_f32 v61, v61, s60, v6
v_fma_f32 v62, v62, s60, v6
v_fma_f32 v63, v63, s60, v6
v_exp_f32 v60, v60
v_exp_f32 v61, v61
v_exp_f32 v62, v62
v_exp_f32 v63, v63
v_add_f32 v7, v60, v61
v_add_f32 v8, v62, v63
v_cvt_pk_bf16_f32 v2, v60, v61
v_cvt_pk_bf16_f32 v3, v62, v63
v_add_f32 v5, v5, v7
v_add_f32 v5, v5, v8
v_cndmask_b32 v30, 0, v2, s[66:67]
v_cndmask_b32 v46, v2, 0, s[66:67]
v_cndmask_b32 v31, 0, v3, s[66:67]
v_cndmask_b32 v47, v3, 0, s[66:67]
v_mov_b32 v6, v5
s_nop 1
v_permlane16_swap_b32 v5, v6
v_add_f32 v5, v5, v6
v_mov_b32 v6, v5
s_nop 1
v_permlane32_swap_b32 v5, v6
v_add_f32 v5, v5, v6
s_lshl_b32 s60, s3, 6
s_add_u32 s60, s60, 49664
v_lshlrev_b32 v6, 3, v1
v_add_u32 v7, s60, v6
v_mov_b32 v8, 1
v_mov_b32 v9, 50176
s_mov_b32 exec_lo, 0xff
s_mov_b32 exec_hi, 0x0
ds_write_b64 v7, v[4:5]
s_mov_b64 exec, 1
ds_add_rtn_u32 v8, v9, v8
s_mov_b64 exec, -1
s_waitcnt lgkmcnt(0)
v_readfirstlane_b32 s60, v8
s_cmp_lg_u32 s60, 7
s_cbranch_scc1 L_PR_ml9
ds_read_b64 v[8:9], v6 offset:49664
s_waitcnt lgkmcnt(0)
v_max_f32_dpp v2, v8, v8 row_ror:8 row_mask:0xf bank_mask:0xf
v_mov_b32 v7, v2
s_nop 1
v_permlane16_swap_b32 v2, v7
v_max_f32 v2, v2, v7
v_mov_b32 v7, v2
s_nop 1
v_permlane32_swap_b32 v2, v7
v_max_f32 v2, v2, v7
v_sub_f32 v7, v8, v2
v_mul_f32 v7, 0x3fb8aa3b, v7
v_exp_f32 v7, v7
s_nop 0
v_mul_f32 v3, v9, v7
s_nop 1
v_add_f32_dpp v3, v3, v3 row_ror:8 row_mask:0xf bank_mask:0xf
v_mov_b32 v7, v3
s_nop 1
v_permlane16_swap_b32 v3, v7
v_add_f32 v3, v3, v7
v_mov_b32 v7, v3
s_nop 1
v_permlane32_swap_b32 v3, v7
v_add_f32 v3, v3, v7
s_lshl_b32 s60, s5, 7
s_add_u32 s60, s60, 131072
s_mov_b32 exec_lo, 0xff
s_mov_b32 exec_hi, 0x0
buffer_store_dwordx2 v[2:3], v6, s[16:19], s60 offen sc1
s_mov_b64 exec, -1
L_PR_ml9:
s_setprio 0
s_waitcnt vmcnt(3)
s_add_u32 s63, s7, 65536
buffer_load_dwordx4 v[100:103], v0, s[12:15], s63 offen offset:1024 nt
s_waitcnt vmcnt(3)
s_add_u32 s63, s7, 65536
buffer_load_dwordx4 v[104:107], v0, s[12:15], s63 offen offset:2048 nt
s_waitcnt vmcnt(3)
s_add_u32 s63, s7, 65536
buffer_load_dwordx4 v[108:111], v0, s[12:15], s63 offen offset:3072 nt
v_perm_b32 v160, v68, v64, s64
v_perm_b32 v161, v76, v72, s64
v_perm_b32 v162, v84, v80, s64
v_perm_b32 v163, v92, v88, s64
v_perm_b32 v164, v68, v64, s65
v_perm_b32 v165, v76, v72, s65
v_perm_b32 v166, v84, v80, s65
v_perm_b32 v167, v92, v88, s65
v_mfma_f32_16x16x32_bf16 v[48:51], v[160:163], v[16:19], 0
s_nop 0
v_mfma_f32_16x16x32_bf16 v[52:55], v[164:167], v[16:19], 0
v_perm_b32 v168, v69, v65, s64
v_perm_b32 v169, v77, v73, s64
v_perm_b32 v170, v85, v81, s64
v_perm_b32 v171, v93, v89, s64
v_perm_b32 v172, v69, v65, s65
v_perm_b32 v173, v77, v73, s65
v_perm_b32 v174, v85, v81, s65
v_perm_b32 v175, v93, v89, s65
v_mfma_f32_16x16x32_bf16 v[56:59], v[168:171], v[16:19], 0
s_nop 0
v_mfma_f32_16x16x32_bf16 v[60:63], v[172:175], v[16:19], 0
v_perm_b32 v160, v70, v66, s64
v_perm_b32 v161, v78, v74, s64
v_perm_b32 v162, v86, v82, s64
v_perm_b32 v163, v94, v90, s64
v_perm_b32 v164, v70, v66, s65
v_perm_b32 v165, v78, v74, s65
v_perm_b32 v166, v86, v82, s65
v_perm_b32 v167, v94, v90, s65
v_mfma_f32_16x16x32_bf16 v[48:51], v[160:163], v[32:35], v[48:51]
s_nop 0
v_mfma_f32_16x16x32_bf16 v[52:55], v[164:167], v[32:35], v[52:55]
v_perm_b32 v168, v71, v67, s64
v_perm_b32 v169, v79, v75, s64
v_perm_b32 v170, v87, v83, s64
v_perm_b32 v171, v95, v91, s64
v_perm_b32 v172, v71, v67, s65
v_perm_b32 v173, v79, v75, s65
v_perm_b32 v174, v87, v83, s65
v_perm_b32 v175, v95, v91, s65
v_mfma_f32_16x16x32_bf16 v[56:59], v[168:171], v[32:35], v[56:59]
s_nop 0
v_mfma_f32_16x16x32_bf16 v[60:63], v[172:175], v[32:35], v[60:63]
s_waitcnt vmcnt(3)
s_add_u32 s63, s7, 98304
buffer_load_dwordx4 v[112:115], v0, s[12:15], s63 offen offset:0 nt
s_waitcnt vmcnt(3)
s_add_u32 s63, s7, 98304
buffer_load_dwordx4 v[116:119], v0, s[12:15], s63 offen offset:1024 nt
s_waitcnt vmcnt(3)
s_add_u32 s63, s7, 98304
buffer_load_dwordx4 v[120:123], v0, s[12:15], s63 offen offset:2048 nt
s_waitcnt vmcnt(3)
s_add_u32 s63, s7, 98304
buffer_load_dwordx4 v[124:127], v0, s[12:15], s63 offen offset:3072 nt
s_waitcnt vmcnt(3)
s_add_u32 s63, s7, 131072
buffer_load_dwordx4 v[128:131], v0, s[12:15], s63 offen offset:0 nt
s_waitcnt vmcnt(3)
s_add_u32 s63, s7, 131072
buffer_load_dwordx4 v[132:135], v0, s[12:15], s63 offen offset:1024 nt
s_waitcnt vmcnt(3)
s_add_u32 s63, s7, 131072
buffer_load_dwordx4 v[136:139], v0, s[12:15], s63 offen offset:2048 nt
s_waitcnt vmcnt(3)
s_add_u32 s63, s7, 131072
buffer_load_dwordx4 v[140:143], v0, s[12:15], s63 offen offset:3072 nt
v_perm_b32 v64, v100, v96, s64
v_perm_b32 v65, v108, v104, s64
v_perm_b32 v66, v116, v112, s64
v_perm_b32 v67, v124, v120, s64
v_perm_b32 v68, v100, v96, s65
v_perm_b32 v69, v108, v104, s65
v_perm_b32 v70, v116, v112, s65
v_perm_b32 v71, v124, v120, s65
v_mfma_f32_16x16x32_bf16 v[48:51], v[64:67], v[20:23], v[48:51]
s_nop 0
v_mfma_f32_16x16x32_bf16 v[52:55], v[68:71], v[20:23], v[52:55]
v_perm_b32 v72, v101, v97, s64
v_perm_b32 v73, v109, v105, s64
v_perm_b32 v74, v117, v113, s64
v_perm_b32 v75, v125, v121, s64
v_perm_b32 v76, v101, v97, s65
v_perm_b32 v77, v109, v105, s65
v_perm_b32 v78, v117, v113, s65
v_perm_b32 v79, v125, v121, s65
v_mfma_f32_16x16x32_bf16 v[56:59], v[72:75], v[20:23], v[56:59]
s_nop 0
v_mfma_f32_16x16x32_bf16 v[60:63], v[76:79], v[20:23], v[60:63]
v_perm_b32 v64, v102, v98, s64
v_perm_b32 v65, v110, v106, s64
v_perm_b32 v66, v118, v114, s64
v_perm_b32 v67, v126, v122, s64
v_perm_b32 v68, v102, v98, s65
v_perm_b32 v69, v110, v106, s65
v_perm_b32 v70, v118, v114, s65
v_perm_b32 v71, v126, v122, s65
v_mfma_f32_16x16x32_bf16 v[48:51], v[64:67], v[36:39], v[48:51]
s_nop 0
v_mfma_f32_16x16x32_bf16 v[52:55], v[68:71], v[36:39], v[52:55]
v_perm_b32 v72, v103, v99, s64
v_perm_b32 v73, v111, v107, s64
v_perm_b32 v74, v119, v115, s64
v_perm_b32 v75, v127, v123, s64
v_perm_b32 v76, v103, v99, s65
v_perm_b32 v77, v111, v107, s65
v_perm_b32 v78, v119, v115, s65
v_perm_b32 v79, v127, v123, s65
v_mfma_f32_16x16x32_bf16 v[56:59], v[72:75], v[36:39], v[56:59]
s_nop 0
v_mfma_f32_16x16x32_bf16 v[60:63], v[76:79], v[36:39], v[60:63]
s_waitcnt vmcnt(3)
s_add_u32 s63, s7, 163840
buffer_load_dwordx4 v[144:147], v0, s[12:15], s63 offen offset:0 nt
s_waitcnt vmcnt(3)
s_add_u32 s63, s7, 163840
buffer_load_dwordx4 v[148:151], v0, s[12:15], s63 offen offset:1024 nt
s_waitcnt vmcnt(3)
s_add_u32 s63, s7, 163840
buffer_load_dwordx4 v[152:155], v0, s[12:15], s63 offen offset:2048 nt
s_waitcnt vmcnt(3)
s_add_u32 s63, s7, 163840
buffer_load_dwordx4 v[156:159], v0, s[12:15], s63 offen offset:3072 nt
s_waitcnt vmcnt(3)
s_add_u32 s63, s7, 196608
buffer_load_dwordx4 v[160:163], v0, s[12:15], s63 offen offset:0 nt
s_waitcnt vmcnt(3)
s_add_u32 s63, s7, 196608
buffer_load_dwordx4 v[164:167], v0, s[12:15], s63 offen offset:1024 nt
s_waitcnt vmcnt(3)
s_add_u32 s63, s7, 196608
buffer_load_dwordx4 v[168:171], v0, s[12:15], s63 offen offset:2048 nt
s_waitcnt vmcnt(3)
s_lshr_b32 s75, s5, 4
s_lshl_b32 s75, s75, 11
s_add_u32 s75, s75, 131072
v_lshrrev_b32 v2, 3, v1
v_lshlrev_b32 v2, 7, v2
v_and_b32 v3, 7, v1
v_lshl_add_u32 v2, v3, 3, v2
buffer_load_dwordx2 v[6:7], v2, s[16:19], s75 offen offset:0 sc1
buffer_load_dwordx2 v[8:9], v2, s[16:19], s75 offen offset:1024 sc1
v_perm_b32 v64, v132, v128, s64
v_perm_b32 v65, v140, v136, s64
v_perm_b32 v66, v148, v144, s64
v_perm_b32 v67, v156, v152, s64
v_perm_b32 v68, v132, v128, s65
v_perm_b32 v69, v140, v136, s65
v_perm_b32 v70, v148, v144, s65
v_perm_b32 v71, v156, v152, s65
v_mfma_f32_16x16x32_bf16 v[48:51], v[64:67], v[24:27], v[48:51]
s_nop 0
v_mfma_f32_16x16x32_bf16 v[52:55], v[68:71], v[24:27], v[52:55]
v_perm_b32 v72, v133, v129, s64
v_perm_b32 v73, v141, v137, s64
v_perm_b32 v74, v149, v145, s64
v_perm_b32 v75, v157, v153, s64
v_perm_b32 v76, v133, v129, s65
v_perm_b32 v77, v141, v137, s65
v_perm_b32 v78, v149, v145, s65
v_perm_b32 v79, v157, v153, s65
v_mfma_f32_16x16x32_bf16 v[56:59], v[72:75], v[24:27], v[56:59]
s_nop 0
v_mfma_f32_16x16x32_bf16 v[60:63], v[76:79], v[24:27], v[60:63]
v_perm_b32 v64, v134, v130, s64
v_perm_b32 v65, v142, v138, s64
v_perm_b32 v66, v150, v146, s64
v_perm_b32 v67, v158, v154, s64
v_perm_b32 v68, v134, v130, s65
v_perm_b32 v69, v142, v138, s65
v_perm_b32 v70, v150, v146, s65
v_perm_b32 v71, v158, v154, s65
v_mfma_f32_16x16x32_bf16 v[48:51], v[64:67], v[40:43], v[48:51]
s_nop 0
v_mfma_f32_16x16x32_bf16 v[52:55], v[68:71], v[40:43], v[52:55]
v_perm_b32 v72, v135, v131, s64
v_perm_b32 v73, v143, v139, s64
v_perm_b32 v74, v151, v147, s64
v_perm_b32 v75, v159, v155, s64
v_perm_b32 v76, v135, v131, s65
v_perm_b32 v77, v143, v139, s65
v_perm_b32 v78, v151, v147, s65
v_perm_b32 v79, v159, v155, s65
v_mfma_f32_16x16x32_bf16 v[56:59], v[72:75], v[40:43], v[56:59]
s_nop 0
v_mfma_f32_16x16x32_bf16 v[60:63], v[76:79], v[40:43], v[60:63]
s_waitcnt vmcnt(3)
s_add_u32 s63, s7, 196608
buffer_load_dwordx4 v[172:175], v0, s[12:15], s63 offen offset:3072 nt
s_waitcnt vmcnt(3)
s_add_u32 s63, s7, 229376
buffer_load_dwordx4 v[176:179], v0, s[12:15], s63 offen offset:0 nt
s_waitcnt vmcnt(3)
s_add_u32 s63, s7, 229376
buffer_load_dwordx4 v[180:183], v0, s[12:15], s63 offen offset:1024 nt
s_waitcnt vmcnt(3)
s_add_u32 s63, s7, 229376
buffer_load_dwordx4 v[184:187], v0, s[12:15], s63 offen offset:2048 nt
v_max_u32 v3, v6, v7
v_max3_u32 v3, v3, v8, v9
v_cmp_eq_u32 vcc, -1, v3
s_cbranch_vccz L_PR_ok10
s_mov_b32 s70, 0
L_PR_retry11:
buffer_load_dwordx2 v[6:7], v2, s[16:19], s75 offen offset:0 sc1
buffer_load_dwordx2 v[8:9], v2, s[16:19], s75 offen offset:1024 sc1
s_waitcnt vmcnt(0)
v_max_u32 v3, v6, v7
v_max3_u32 v3, v3, v8, v9
s_add_u32 s70, s70, 1
s_cmp_ge_u32 s70, 262144
s_cbranch_scc1 L_PR_ok10
v_cmp_eq_u32 vcc, -1, v3
s_cbranch_vccnz L_PR_retry11
L_PR_ok10:
v_max_f32 v3, v6, v8
v_sub_f32 v6, v6, v3
v_sub_f32 v8, v8, v3
v_mul_f32 v6, 0x3fb8aa3b, v6
v_mul_f32 v8, 0x3fb8aa3b, v8
v_exp_f32 v6, v6
v_exp_f32 v8, v8
v_mul_f32 v7, v7, v6
v_fmac_f32 v7, v9, v8
v_max_f32_dpp v6, v3, v3 row_ror:8 row_mask:0xf bank_mask:0xf
v_mov_b32 v9, v6
s_nop 1
v_permlane16_swap_b32 v6, v9
v_max_f32 v6, v6, v9
v_mov_b32 v9, v6
s_nop 1
v_permlane32_swap_b32 v6, v9
v_max_f32 v6, v6, v9
v_sub_f32 v9, v3, v6
v_mul_f32 v9, 0x3fb8aa3b, v9
v_exp_f32 v9, v9
s_nop 0
v_mul_f32 v8, v7, v9
s_nop 1
v_add_f32_dpp v8, v8, v8 row_ror:8 row_mask:0xf bank_mask:0xf
v_mov_b32 v9, v8
s_nop 1
v_permlane16_swap_b32 v8, v9
v_add_f32 v8, v8, v9
v_mov_b32 v9, v8
s_nop 1
v_permlane32_swap_b32 v8, v9
v_add_f32 v8, v8, v9
v_sub_f32 v4, v4, v6
v_mul_f32 v4, 0x3fb8aa3b, v4
v_exp_f32 v4, v4
v_rcp_f32 v8, v8
s_nop 0
v_mul_f32 v5, v4, v8
s_mul_i32 s60, s3, 4864
s_add_u32 s60, s60, 0
v_and_b32 v6, 7, v1
v_mul_u32_u24 v6, 592, v6
v_lshrrev_b32 v3, 4, v1
v_mul_u32_u24 v3, 144, v3
v_add_u32 v6, v3, v6
v_bfe_u32 v3, v1, 3, 1
v_lshl_add_u32 v6, v3, 6, v6
v_add_u32 v6, s60, v6
s_mul_i32 s60, s3, 592
s_add_u32 s60, s60, 0
v_lshrrev_b32 v7, 4, v1
v_mul_u32_u24 v7, 144, v7
v_bfe_u32 v3, v1, 1, 1
v_lshl_add_u32 v7, v3, 6, v7
v_and_b32 v3, 1, v1
v_lshl_add_u32 v7, v3, 5, v7
v_bfe_u32 v3, v1, 2, 2
v_lshl_add_u32 v7, v3, 2, v7
v_add_u32 v7, s60, v7
v_add_u32 v8, 16, v7
v_lshlrev_b32 v9, 2, v1
s_lshl_b32 s75, s5, 11
s_lshl_b32 s61, s3, 8
s_add_u32 s75, s75, s61
s_add_u32 s75, s75, 262144
s_waitcnt vmcnt(3)
s_add_u32 s63, s7, 229376
buffer_load_dwordx4 v[188:191], v0, s[12:15], s63 offen offset:3072 nt
s_waitcnt vmcnt(0)
v_perm_b32 v64, v164, v160, s64
v_perm_b32 v65, v172, v168, s64
v_perm_b32 v66, v180, v176, s64
v_perm_b32 v67, v188, v184, s64
v_perm_b32 v68, v164, v160, s65
v_perm_b32 v69, v172, v168, s65
v_perm_b32 v70, v180, v176, s65
v_perm_b32 v71, v188, v184, s65
v_mfma_f32_16x16x32_bf16 v[48:51], v[64:67], v[28:31], v[48:51]
s_nop 0
v_mfma_f32_16x16x32_bf16 v[52:55], v[68:71], v[28:31], v[52:55]
v_perm_b32 v72, v165, v161, s64
v_perm_b32 v73, v173, v169, s64
v_perm_b32 v74, v181, v177, s64
v_perm_b32 v75, v189, v185, s64
v_perm_b32 v76, v165, v161, s65
v_perm_b32 v77, v173, v169, s65
v_perm_b32 v78, v181, v177, s65
v_perm_b32 v79, v189, v185, s65
v_mfma_f32_16x16x32_bf16 v[56:59], v[72:75], v[28:31], v[56:59]
s_nop 0
v_mfma_f32_16x16x32_bf16 v[60:63], v[76:79], v[28:31], v[60:63]
v_perm_b32 v64, v166, v162, s64
v_perm_b32 v65, v174, v170, s64
v_perm_b32 v66, v182, v178, s64
v_perm_b32 v67, v190, v186, s64
v_perm_b32 v68, v166, v162, s65
v_perm_b32 v69, v174, v170, s65
v_perm_b32 v70, v182, v178, s65
v_perm_b32 v71, v190, v186, s65
v_mfma_f32_16x16x32_bf16 v[48:51], v[64:67], v[44:47], v[48:51]
s_nop 0
v_mfma_f32_16x16x32_bf16 v[52:55], v[68:71], v[44:47], v[52:55]
v_perm_b32 v72, v167, v163, s64
v_perm_b32 v73, v175, v171, s64
v_perm_b32 v74, v183, v179, s64
v_perm_b32 v75, v191, v187, s64
v_perm_b32 v76, v167, v163, s65
v_perm_b32 v77, v175, v171, s65
v_perm_b32 v78, v183, v179, s65
v_perm_b32 v79, v191, v187, s65
v_mfma_f32_16x16x32_bf16 v[56:59], v[72:75], v[44:47], v[56:59]
s_nop 0
v_mfma_f32_16x16x32_bf16 v[60:63], v[76:79], v[44:47], v[60:63]
v_pk_mul_f32 v[48:49], v[48:49], v[4:5] op_sel:[0,1] op_sel_hi:[1,1]
v_pk_mul_f32 v[50:51], v[50:51], v[4:5] op_sel:[0,1] op_sel_hi:[1,1]
ds_write_b128 v6, v[48:51] offset:0
v_pk_mul_f32 v[52:53], v[52:53], v[4:5] op_sel:[0,1] op_sel_hi:[1,1]
v_pk_mul_f32 v[54:55], v[54:55], v[4:5] op_sel:[0,1] op_sel_hi:[1,1]
ds_write_b128 v6, v[52:55] offset:16
v_pk_mul_f32 v[56:57], v[56:57], v[4:5] op_sel:[0,1] op_sel_hi:[1,1]
v_pk_mul_f32 v[58:59], v[58:59], v[4:5] op_sel:[0,1] op_sel_hi:[1,1]
ds_write_b128 v6, v[56:59] offset:32
v_pk_mul_f32 v[60:61], v[60:61], v[4:5] op_sel:[0,1] op_sel_hi:[1,1]
v_pk_mul_f32 v[62:63], v[62:63], v[4:5] op_sel:[0,1] op_sel_hi:[1,1]
ds_write_b128 v6, v[60:63] offset:48
s_waitcnt lgkmcnt(0)
s_barrier
ds_read2st64_b32 v[16:17], v7 offset0:0 offset1:19
ds_read2st64_b32 v[24:25], v8 offset0:0 offset1:19
ds_read2st64_b32 v[18:19], v7 offset0:38 offset1:57
ds_read2st64_b32 v[26:27], v8 offset0:38 offset1:57
ds_read2st64_b32 v[20:21], v7 offset0:76 offset1:95
ds_read2st64_b32 v[28:29], v8 offset0:76 offset1:95
ds_read2st64_b32 v[22:23], v7 offset0:114 offset1:133
ds_read2st64_b32 v[30:31], v8 offset0:114 offset1:133
s_waitcnt lgkmcnt(0)
v_pk_add_f32 v[16:17], v[16:17], v[20:21]
v_pk_add_f32 v[18:19], v[18:19], v[22:23]
v_pk_add_f32 v[24:25], v[24:25], v[28:29]
v_pk_add_f32 v[26:27], v[26:27], v[30:31]
v_pk_add_f32 v[16:17], v[16:17], v[18:19]
v_pk_add_f32 v[24:25], v[24:25], v[26:27]
v_add_f32 v16, v16, v17
v_add_f32 v24, v24, v25
v_cvt_pk_bf16_f32 v20, v16, v24
s_nop 1
v_mov_b32_dpp v21, v20 quad_perm:[1,1,1,1] row_mask:0xf bank_mask:0xf
v_mov_b32_dpp v22, v20 quad_perm:[2,2,2,2] row_mask:0xf bank_mask:0xf
v_mov_b32_dpp v23, v20 quad_perm:[3,3,3,3] row_mask:0xf bank_mask:0xf
s_mov_b32 exec_lo, 0x11111111
s_mov_b32 exec_hi, 0x11111111
buffer_store_dwordx4 v[20:23], v9, s[16:19], s75 offen sc1
s_mov_b64 exec, -1
s_add_u32 s63, s74, 0
buffer_load_dwordx4 v[192:195], v12, s[20:23], s63 offen nt
s_add_u32 s63, s74, 12288
buffer_load_dwordx4 v[196:199], v12, s[20:23], s63 offen nt
s_add_u32 s63, s74, 24576
buffer_load_dwordx4 v[200:203], v12, s[20:23], s63 offen nt
s_waitcnt vmcnt(3)
s_add_u32 s63, s74, 36864
buffer_load_dwordx4 v[204:207], v12, s[20:23], s63 offen nt
s_waitcnt vmcnt(3)
s_add_u32 s63, s74, 49152
buffer_load_dwordx4 v[208:211], v12, s[20:23], s63 offen nt
s_waitcnt vmcnt(3)
s_add_u32 s63, s74, 61440
buffer_load_dwordx4 v[212:215], v12, s[20:23], s63 offen nt
s_waitcnt vmcnt(3)
s_add_u32 s63, s74, 73728
buffer_load_dwordx4 v[216:219], v12, s[20:23], s63 offen nt
s_waitcnt vmcnt(3)
s_add_u32 s63, s74, 86016
buffer_load_dwordx4 v[220:223], v12, s[20:23], s63 offen nt
s_waitcnt vmcnt(3)
s_add_u32 s63, s78, 0
buffer_load_dwordx2 v[96:97], v13, s[24:27], s63 offen
s_add_u32 s63, s78, 4096
buffer_load_dwordx2 v[98:99], v13, s[24:27], s63 offen
s_waitcnt vmcnt(3)
s_add_u32 s63, s74, 786432
buffer_load_dwordx4 v[224:227], v12, s[20:23], s63 offen nt
s_waitcnt vmcnt(3)
s_add_u32 s63, s74, 798720
buffer_load_dwordx4 v[228:231], v12, s[20:23], s63 offen nt
s_waitcnt vmcnt(3)
s_add_u32 s63, s74, 811008
buffer_load_dwordx4 v[232:235], v12, s[20:23], s63 offen nt
s_waitcnt vmcnt(3)
s_add_u32 s63, s74, 823296
buffer_load_dwordx4 v[236:239], v12, s[20:23], s63 offen nt
s_lshl_b32 s60, s3, 10
s_add_u32 s60, s60, 40960
v_lshrrev_b32 v10, 5, v1
v_lshlrev_b32 v10, 8, v10
v_and_b32 v100, 15, v1
v_lshl_add_u32 v10, v100, 4, v10
v_bfe_u32 v100, v1, 4, 1
v_lshl_add_u32 v10, v100, 3, v10
v_add_u32 v10, s60, v10
v_lshlrev_b32 v100, 16, v96
v_and_b32 v101, 0xffff0000, v96
v_mul_f32 v102, 0xbfb8aa3b, v100
v_mul_f32 v103, 0xbfb8aa3b, v101
v_exp_f32 v102, v102
v_exp_f32 v103, v103
v_add_f32 v102, 1.0, v102
v_add_f32 v103, 1.0, v103
v_rcp_f32 v104, v102
v_rcp_f32 v105, v103
v_mul_f32 v106, v100, v104
v_mul_f32 v107, v101, v105
v_cvt_pk_bf16_f32 v96, v106, v107
v_lshlrev_b32 v100, 16, v97
v_and_b32 v101, 0xffff0000, v97
v_mul_f32 v102, 0xbfb8aa3b, v100
v_mul_f32 v103, 0xbfb8aa3b, v101
v_exp_f32 v102, v102
v_exp_f32 v103, v103
v_add_f32 v102, 1.0, v102
v_add_f32 v103, 1.0, v103
v_rcp_f32 v104, v102
v_rcp_f32 v105, v103
v_mul_f32 v106, v100, v104
v_mul_f32 v107, v101, v105
v_cvt_pk_bf16_f32 v97, v106, v107
v_lshlrev_b32 v100, 16, v98
v_and_b32 v101, 0xffff0000, v98
v_mul_f32 v102, 0xbfb8aa3b, v100
v_mul_f32 v103, 0xbfb8aa3b, v101
v_exp_f32 v102, v102
v_exp_f32 v103, v103
v_add_f32 v102, 1.0, v102
v_add_f32 v103, 1.0, v103
v_rcp_f32 v104, v102
v_rcp_f32 v105, v103
v_mul_f32 v106, v100, v104
v_mul_f32 v107, v101, v105
v_cvt_pk_bf16_f32 v98, v106, v107
v_lshlrev_b32 v100, 16, v99
v_and_b32 v101, 0xffff0000, v99
v_mul_f32 v102, 0xbfb8aa3b, v100
v_mul_f32 v103, 0xbfb8aa3b, v101
v_exp_f32 v102, v102
v_exp_f32 v103, v103
v_add_f32 v102, 1.0, v102
v_add_f32 v103, 1.0, v103
v_rcp_f32 v104, v102
v_rcp_f32 v105, v103
v_mul_f32 v106, v100, v104
v_mul_f32 v107, v101, v105
v_cvt_pk_bf16_f32 v99, v106, v107
ds_write_b64 v10, v[96:97]
ds_write_b64 v10, v[98:99] offset:512
v_perm_b32 v32, v196, v192, s64
v_perm_b32 v33, v204, v200, s64
v_perm_b32 v34, v212, v208, s64
v_perm_b32 v35, v220, v216, s64
v_perm_b32 v36, v196, v192, s65
v_perm_b32 v37, v204, v200, s65
v_perm_b32 v38, v212, v208, s65
v_perm_b32 v39, v220, v216, s65
v_perm_b32 v40, v197, v193, s64
v_perm_b32 v41, v205, v201, s64
v_perm_b32 v42, v213, v209, s64
v_perm_b32 v43, v221, v217, s64
v_perm_b32 v44, v197, v193, s65
v_perm_b32 v45, v205, v201, s65
v_perm_b32 v46, v213, v209, s65
v_perm_b32 v47, v221, v217, s65
v_perm_b32 v48, v198, v194, s64
v_perm_b32 v49, v206, v202, s64
v_perm_b32 v50, v214, v210, s64
v_perm_b32 v51, v222, v218, s64
v_perm_b32 v52, v198, v194, s65
v_perm_b32 v53, v206, v202, s65
v_perm_b32 v54, v214, v210, s65
v_perm_b32 v55, v222, v218, s65
v_perm_b32 v56, v199, v195, s64
v_perm_b32 v57, v207, v203, s64
v_perm_b32 v58, v215, v211, s64
v_perm_b32 v59, v223, v219, s64
v_perm_b32 v60, v199, v195, s65
v_perm_b32 v61, v207, v203, s65
v_perm_b32 v62, v215, v211, s65
v_perm_b32 v63, v223, v219, s65
s_waitcnt vmcnt(3)
s_add_u32 s63, s74, 835584
buffer_load_dwordx4 v[240:243], v12, s[20:23], s63 offen nt
s_waitcnt vmcnt(3)
s_add_u32 s63, s74, 847872
buffer_load_dwordx4 v[244:247], v12, s[20:23], s63 offen nt
s_waitcnt vmcnt(3)
s_add_u32 s63, s74, 860160
buffer_load_dwordx4 v[248:251], v12, s[20:23], s63 offen nt
s_waitcnt vmcnt(3)
s_add_u32 s63, s74, 872448
buffer_load_dwordx4 v[252:255], v12, s[20:23], s63 offen nt
s_waitcnt vmcnt(0)
v_perm_b32 v64, v228, v224, s64
v_perm_b32 v65, v236, v232, s64
v_perm_b32 v66, v244, v240, s64
v_perm_b32 v67, v252, v248, s64
v_perm_b32 v68, v228, v224, s65
v_perm_b32 v69, v236, v232, s65
v_perm_b32 v70, v244, v240, s65
v_perm_b32 v71, v252, v248, s65
v_perm_b32 v72, v229, v225, s64
v_perm_b32 v73, v237, v233, s64
v_perm_b32 v74, v245, v241, s64
v_perm_b32 v75, v253, v249, s64
v_perm_b32 v76, v229, v225, s65
v_perm_b32 v77, v237, v233, s65
v_perm_b32 v78, v245, v241, s65
v_perm_b32 v79, v253, v249, s65
v_perm_b32 v80, v230, v226, s64
v_perm_b32 v81, v238, v234, s64
v_perm_b32 v82, v246, v242, s64
v_perm_b32 v83, v254, v250, s64
v_perm_b32 v84, v230, v226, s65
v_perm_b32 v85, v238, v234, s65
v_perm_b32 v86, v246, v242, s65
v_perm_b32 v87, v254, v250, s65
v_perm_b32 v88, v231, v227, s64
v_perm_b32 v89, v239, v235, s64
v_perm_b32 v90, v247, v243, s64
v_perm_b32 v91, v255, v251, s64
v_perm_b32 v92, v231, v227, s65
v_perm_b32 v93, v239, v235, s65
v_perm_b32 v94, v247, v243, s65
v_perm_b32 v95, v255, v251, s65
s_lshl_b32 s60, s3, 10
s_add_u32 s60, s60, 40960
v_and_b32 v12, 3, v1
v_lshlrev_b32 v12, 8, v12
v_lshrrev_b32 v14, 4, v1
v_lshl_add_u32 v12, v14, 5, v12
v_bfe_u32 v14, v1, 3, 1
v_lshl_add_u32 v12, v14, 4, v12
v_add_u32 v12, s60, v12
s_mov_b32 s66, 0x0f0f0f0f
s_mov_b32 s67, 0x0f0f0f0f
v_mov_b32 v14, 49152
v_cndmask_b32 v13, v12, v14, s[66:67]
v_cndmask_b32 v12, v14, v12, s[66:67]
ds_read_b128 v[96:99], v12 offset:0
ds_read_b128 v[100:103], v13 offset:0
ds_read_b128 v[104:107], v12 offset:128
ds_read_b128 v[108:111], v13 offset:128
s_lshl_b32 s60, s3, 11
s_add_u32 s60, s60, 60416
v_lshrrev_b32 v12, 5, v1
v_lshlrev_b32 v12, 10, v12
v_and_b32 v14, 3, v1
v_lshl_add_u32 v12, v14, 8, v12
v_bfe_u32 v14, v1, 2, 1
v_lshl_add_u32 v12, v14, 7, v12
v_bfe_u32 v14, v1, 4, 1
v_lshl_add_u32 v12, v14, 4, v12
v_add_u32 v12, s60, v12
s_waitcnt lgkmcnt(0)
v_mfma_f32_16x16x32_bf16 v[112:115], v[32:35], v[96:99], 0
v_mfma_f32_16x16x32_bf16 v[116:119], v[36:39], v[96:99], 0
v_mfma_f32_16x16x32_bf16 v[120:123], v[40:43], v[96:99], 0
v_mfma_f32_16x16x32_bf16 v[124:127], v[44:47], v[96:99], 0
v_mfma_f32_16x16x32_bf16 v[112:115], v[48:51], v[100:103], v[112:115]
v_mfma_f32_16x16x32_bf16 v[116:119], v[52:55], v[100:103], v[116:119]
v_mfma_f32_16x16x32_bf16 v[120:123], v[56:59], v[100:103], v[120:123]
v_mfma_f32_16x16x32_bf16 v[124:127], v[60:63], v[100:103], v[124:127]
v_mfma_f32_16x16x32_bf16 v[112:115], v[64:67], v[104:107], v[112:115]
v_mfma_f32_16x16x32_bf16 v[116:119], v[68:71], v[104:107], v[116:119]
v_mfma_f32_16x16x32_bf16 v[120:123], v[72:75], v[104:107], v[120:123]
v_mfma_f32_16x16x32_bf16 v[124:127], v[76:79], v[104:107], v[124:127]
v_mfma_f32_16x16x32_bf16 v[112:115], v[80:83], v[108:111], v[112:115]
v_mfma_f32_16x16x32_bf16 v[116:119], v[84:87], v[108:111], v[116:119]
v_mfma_f32_16x16x32_bf16 v[120:123], v[88:91], v[108:111], v[120:123]
v_mfma_f32_16x16x32_bf16 v[124:127], v[92:95], v[108:111], v[124:127]
s_mov_b32 exec_lo, 0xff00ff
s_mov_b32 exec_hi, 0xff00ff00
s_nop 2
ds_write_b128 v12, v[112:115] offset:0
ds_write_b128 v12, v[116:119] offset:32
ds_write_b128 v12, v[120:123] offset:64
ds_write_b128 v12, v[124:127] offset:96
s_mov_b64 exec, -1
s_lshl_b32 s60, s3, 8
s_add_u32 s60, s60, 60416
v_bfe_u32 v13, v1, 2, 1
v_lshlrev_b32 v13, 7, v13
v_and_b32 v14, 3, v1
v_lshl_add_u32 v13, v14, 5, v13
v_lshrrev_b32 v14, 5, v1
v_lshl_add_u32 v13, v14, 4, v13
v_bfe_u32 v14, v1, 3, 2
v_lshl_add_u32 v13, v14, 2, v13
v_add_u32 v13, s60, v13
s_waitcnt lgkmcnt(0)
s_barrier
s_cmp_ge_u32 s3, 4
s_cbranch_scc1 L_PR_fin12
ds_read2st64_b32 v[96:97], v13 offset0:0 offset1:4
ds_read2st64_b32 v[98:99], v13 offset0:8 offset1:12
ds_read2st64_b32 v[100:101], v13 offset0:16 offset1:20
ds_read2st64_b32 v[102:103], v13 offset0:24 offset1:28
ds_read2st64_b32 v[104:105], v13 offset0:32 offset1:36
ds_read2st64_b32 v[106:107], v13 offset0:40 offset1:44
ds_read2st64_b32 v[108:109], v13 offset0:48 offset1:52
ds_read2st64_b32 v[110:111], v13 offset0:56 offset1:60
s_mul_i32 s60, s3, 2048
s_add_u32 s60, s60, s76
v_lshlrev_b32 v12, 1, v1
s_waitcnt lgkmcnt(0)
v_add_f32 v96, v96, v104
v_add_f32 v97, v97, v105
v_add_f32 v98, v98, v106
v_add_f32 v99, v99, v107
v_add_f32 v100, v100, v108
v_add_f32 v101, v101, v109
v_add_f32 v102, v102, v110
v_add_f32 v103, v103, v111
v_add_f32 v96, v96, v100
v_add_f32 v97, v97, v101
v_add_f32 v98, v98, v102
v_add_f32 v99, v99, v103
v_add_f32 v96, v96, v98
v_add_f32 v97, v97, v99
v_add_f32 v96, v96, v97
s_nop 1
v_mov_b32_dpp v97, v96 quad_perm:[1,1,3,3] row_mask:0xf bank_mask:0xf
v_cvt_pk_bf16_f32 v112, v96, v97
s_nop 1
v_mov_b32_dpp v113, v112 row_shl:2 row_mask:0xf bank_mask:0xf
v_mov_b32_dpp v114, v112 row_shl:4 row_mask:0xf bank_mask:0xf
v_mov_b32_dpp v115, v112 row_shl:6 row_mask:0xf bank_mask:0xf
s_mov_b32 exec_lo, 0x1010101
s_mov_b32 exec_hi, 0x1010101
buffer_store_dwordx4 v[112:115], v12, s[16:19], s60 offen sc1
s_mov_b64 exec, -1
L_PR_fin12:
s_endpgm
.p2align 6
L_class_R:
s_mov_b32 s16, s58
s_mov_b32 s17, s59
s_mov_b32 s18, 0x10000000
s_mov_b32 s19, 0x20000
v_mov_b32 v4, -1
v_mov_b32 v5, -1
v_mov_b32 v6, -1
v_mov_b32 v7, -1
s_sub_u32 s61, s2, 215
s_cmp_ge_u32 s61, 40
s_cselect_b32 s60, 40, 0
s_sub_u32 s61, s61, s60
s_add_u32 s61, s61, 32
s_lshl_b32 s77, s61, 7
s_lshr_b32 s76, s61, 4
s_lshl_b32 s76, s76, 13
s_and_b32 s60, s61, 15
s_lshl_b32 s60, s60, 7
s_add_u32 s76, s76, s60
s_sub_u32 s61, s2, 216
s_and_b32 s60, s61, 3
s_lshr_b32 s61, s61, 2
s_lshl_b32 s73, s60, 13
s_lshl_b32 s72, s61, 8
s_add_u32 s73, s73, s72
s_add_u32 s73, s73, 98304
s_mul_i32 s60, s60, 3145728
s_lshl_b32 s72, s61, 7
s_add_u32 s72, s72, s60
s_add_u32 s72, s72, 9216
s_cmp_lg_u32 s3, 0
s_cbranch_scc1 L_R_clr1
s_setprio 3
v_bfe_u32 v2, v1, 3, 2
v_lshlrev_b32 v2, 11, v2
v_and_b32 v3, 7, v1
v_lshl_add_u32 v2, v3, 4, v2
s_mov_b32 exec_lo, 0xffffffff
s_mov_b32 exec_hi, 0x0
buffer_store_dwordx4 v[4:7], v2, s[16:19], s76 offen sc1
s_mov_b64 exec, -1
s_cmp_ge_u32 s2, 248
s_cbranch_scc1 L_R_qclr2
v_lshrrev_b32 v2, 4, v1
v_lshlrev_b32 v2, 11, v2
v_and_b32 v3, 15, v1
v_lshl_add_u32 v2, v3, 4, v2
buffer_store_dwordx4 v[4:7], v2, s[16:19], s73 offen sc1
s_mov_b64 exec, -1
L_R_qclr2:
s_lshl_b32 s60, s5, 11
s_add_u32 s60, s60, 262144
buffer_store_dwordx4 v[4:7], v0, s[16:19], s60 offen sc1
buffer_store_dwordx4 v[4:7], v0, s[16:19], s60 offen offset:1024 sc1
s_lshl_b32 s60, s5, 7
s_add_u32 s60, s60, 131072
s_mov_b32 exec_lo, 0xff
s_mov_b32 exec_hi, 0x0
buffer_store_dwordx4 v[4:7], v0, s[16:19], s60 offen sc1
s_mov_b64 exec, -1
v_mov_b32 v8, 0
v_mov_b32 v9, 0
v_lshlrev_b32 v2, 3, v1
ds_write_b64 v2, v[8:9] offset:49152
ds_write_b32 v8, v8 offset:50176
s_setprio 0
L_R_clr1:
s_mov_b32 s12, s36
s_mov_b32 s13, s37
s_mov_b32 s14, 0x4000000
s_mov_b32 s15, 0x20000
s_mov_b32 s28, s56
s_mov_b32 s29, s57
s_mov_b32 s30, 0x100
s_mov_b32 s31, 0x20000
s_mov_b32 s64, 0x05040100
s_mov_b32 s65, 0x07060302
s_lshl_b32 s60, s3, 12
v_lshrrev_b32 v6, 4, v1
v_lshlrev_b32 v7, 2, v6
v_xor_b32 v7, v7, v1
v_and_b32 v7, 15, v7
v_lshlrev_b32 v7, 4, v7
v_lshl_add_u32 v2, v6, 8, v7
v_add_u32 v2, s60, v2
v_xor_b32 v3, 16, v2
v_xor_b32 v4, 32, v2
v_xor_b32 v5, 48, v2
v_xor_b32 v7, v6, v1
v_and_b32 v7, 15, v7
v_lshlrev_b32 v7, 4, v7
v_and_b32 v8, 3, v1
v_lshl_add_u32 v7, v8, 10, v7
v_bfe_u32 v8, v1, 2, 2
v_lshl_add_u32 v7, v8, 8, v7
v_add_u32 v6, s60, v7
v_xor_b32 v7, 64, v6
v_xor_b32 v8, 128, v6
v_xor_b32 v9, 192, v6
s_cmp_lg_u32 s3, 0
s_cbranch_scc1 L_R_arr3
s_waitcnt vmcnt(0) lgkmcnt(0)
L_R_arr3:
s_barrier
s_waitcnt vmcnt(1)
s_add_u32 s63, s7, 32768
buffer_load_dwordx4 v[144:147], v0, s[8:11], s63 offen offset:0 nt
s_waitcnt vmcnt(1)
s_add_u32 s63, s7, 32768
buffer_load_dwordx4 v[148:151], v0, s[8:11], s63 offen offset:1024 nt
ds_write_b128 v2, v[128:131] offset:0
ds_write_b128 v3, v[132:135] offset:1024
ds_write_b128 v4, v[136:139] offset:2048
ds_write_b128 v5, v[140:143] offset:3072
ds_read_b128 v[128:131], v6
ds_read_b128 v[132:135], v7
ds_read_b128 v[136:139], v8
ds_read_b128 v[140:143], v9
s_add_u32 s63, s7, 32768
buffer_load_dwordx4 v[152:155], v0, s[8:11], s63 offen offset:2048 nt
s_add_u32 s63, s7, 32768
buffer_load_dwordx4 v[156:159], v0, s[8:11], s63 offen offset:3072 nt
s_add_u32 s63, s7, 65536
buffer_load_dwordx4 v[160:163], v0, s[8:11], s63 offen offset:0 nt
s_waitcnt vmcnt(4)
s_add_u32 s63, s7, 65536
buffer_load_dwordx4 v[164:167], v0, s[8:11], s63 offen offset:1024 nt
s_waitcnt vmcnt(4)
s_add_u32 s63, s7, 65536
buffer_load_dwordx4 v[168:171], v0, s[8:11], s63 offen offset:2048 nt
s_waitcnt vmcnt(4)
s_add_u32 s63, s7, 65536
buffer_load_dwordx4 v[172:175], v0, s[8:11], s63 offen offset:3072 nt
s_waitcnt vmcnt(4)
s_add_u32 s63, s7, 98304
buffer_load_dwordx4 v[176:179], v0, s[8:11], s63 offen offset:0 nt
ds_write_b128 v2, v[144:147] offset:0
ds_write_b128 v3, v[148:151] offset:1024
ds_write_b128 v4, v[152:155] offset:2048
ds_write_b128 v5, v[156:159] offset:3072
ds_read_b128 v[144:147], v6
ds_read_b128 v[148:151], v7
ds_read_b128 v[152:155], v8
ds_read_b128 v[156:159], v9
s_cmp_lg_u32 s3, 0
s_cbranch_scc1 L_R_arr4
s_mov_b32 s60, 1
s_atomic_add s60, s[56:57], 0
L_R_arr4:
s_waitcnt vmcnt(4)
s_add_u32 s63, s7, 98304
buffer_load_dwordx4 v[180:183], v0, s[8:11], s63 offen offset:1024 nt
s_waitcnt vmcnt(4)
s_add_u32 s63, s7, 98304
buffer_load_dwordx4 v[184:187], v0, s[8:11], s63 offen offset:2048 nt
s_waitcnt vmcnt(4)
s_add_u32 s63, s7, 98304
buffer_load_dwordx4 v[188:191], v0, s[8:11], s63 offen offset:3072 nt
s_waitcnt vmcnt(4)
s_mov_b32 s20, s52
s_mov_b32 s21, s53
s_mov_b32 s22, 0xc00000
s_mov_b32 s23, 0x20000
s_mov_b32 s24, s50
s_mov_b32 s25, s51
s_mov_b32 s26, 0x2000
s_mov_b32 s27, 0x20000
v_lshrrev_b32 v12, 3, v1
v_mul_u32_u24 v12, 98304, v12
v_and_b32 v13, 7, v1
v_lshl_add_u32 v12, v13, 4, v12
s_mul_i32 s74, s3, 1572864
s_add_u32 s74, s74, s77
v_lshrrev_b32 v13, 5, v1
v_lshlrev_b32 v13, 11, v13
v_and_b32 v14, 15, v1
v_lshl_add_u32 v13, v14, 4, v13
v_bfe_u32 v14, v1, 4, 1
v_lshl_add_u32 v13, v14, 3, v13
s_lshl_b32 s78, s3, 8
ds_write_b128 v2, v[160:163] offset:0
ds_write_b128 v3, v[164:167] offset:1024
ds_write_b128 v4, v[168:171] offset:2048
ds_write_b128 v5, v[172:175] offset:3072
ds_read_b128 v[160:163], v6
ds_read_b128 v[164:167], v7
ds_read_b128 v[168:171], v8
ds_read_b128 v[172:175], v9
s_add_u32 s63, s78, 0
buffer_load_dwordx2 v[32:33], v13, s[24:27], s63 offen
s_add_u32 s63, s78, 4096
buffer_load_dwordx2 v[34:35], v13, s[24:27], s63 offen
s_waitcnt vmcnt(4)
s_add_u32 s63, s74, 0
buffer_load_dwordx4 v[64:67], v12, s[20:23], s63 offen nt
s_waitcnt vmcnt(4)
s_add_u32 s63, s74, 12288
buffer_load_dwordx4 v[68:71], v12, s[20:23], s63 offen nt
s_waitcnt vmcnt(4)
s_add_u32 s63, s74, 24576
buffer_load_dwordx4 v[72:75], v12, s[20:23], s63 offen nt
ds_write_b128 v2, v[176:179] offset:0
ds_write_b128 v3, v[180:183] offset:1024
ds_write_b128 v4, v[184:187] offset:2048
ds_write_b128 v5, v[188:191] offset:3072
ds_read_b128 v[176:179], v6
ds_read_b128 v[180:183], v7
ds_read_b128 v[184:187], v8
ds_read_b128 v[188:191], v9
s_waitcnt vmcnt(4)
s_add_u32 s63, s74, 36864
buffer_load_dwordx4 v[76:79], v12, s[20:23], s63 offen nt
s_waitcnt vmcnt(4)
s_add_u32 s63, s74, 49152
buffer_load_dwordx4 v[80:83], v12, s[20:23], s63 offen nt
s_lshl_b32 s60, s3, 10
s_add_u32 s60, s60, 40960
v_lshrrev_b32 v10, 5, v1
v_lshlrev_b32 v10, 8, v10
v_and_b32 v36, 15, v1
v_lshl_add_u32 v10, v36, 4, v10
v_bfe_u32 v36, v1, 4, 1
v_lshl_add_u32 v10, v36, 3, v10
v_add_u32 v10, s60, v10
v_lshlrev_b32 v36, 16, v32
v_and_b32 v37, 0xffff0000, v32
v_mul_f32 v38, 0xbfb8aa3b, v36
v_mul_f32 v39, 0xbfb8aa3b, v37
v_exp_f32 v38, v38
v_exp_f32 v39, v39
v_add_f32 v38, 1.0, v38
v_add_f32 v39, 1.0, v39
v_rcp_f32 v40, v38
v_rcp_f32 v41, v39
v_mul_f32 v42, v36, v40
v_mul_f32 v43, v37, v41
v_cvt_pk_bf16_f32 v32, v42, v43
v_lshlrev_b32 v36, 16, v33
v_and_b32 v37, 0xffff0000, v33
v_mul_f32 v38, 0xbfb8aa3b, v36
v_mul_f32 v39, 0xbfb8aa3b, v37
v_exp_f32 v38, v38
v_exp_f32 v39, v39
v_add_f32 v38, 1.0, v38
v_add_f32 v39, 1.0, v39
v_rcp_f32 v40, v38
v_rcp_f32 v41, v39
v_mul_f32 v42, v36, v40
v_mul_f32 v43, v37, v41
v_cvt_pk_bf16_f32 v33, v42, v43
v_lshlrev_b32 v36, 16, v34
v_and_b32 v37, 0xffff0000, v34
v_mul_f32 v38, 0xbfb8aa3b, v36
v_mul_f32 v39, 0xbfb8aa3b, v37
v_exp_f32 v38, v38
v_exp_f32 v39, v39
v_add_f32 v38, 1.0, v38
v_add_f32 v39, 1.0, v39
v_rcp_f32 v40, v38
v_rcp_f32 v41, v39
v_mul_f32 v42, v36, v40
v_mul_f32 v43, v37, v41
v_cvt_pk_bf16_f32 v34, v42, v43
v_lshlrev_b32 v36, 16, v35
v_and_b32 v37, 0xffff0000, v35
v_mul_f32 v38, 0xbfb8aa3b, v36
v_mul_f32 v39, 0xbfb8aa3b, v37
v_exp_f32 v38, v38
v_exp_f32 v39, v39
v_add_f32 v38, 1.0, v38
v_add_f32 v39, 1.0, v39
v_rcp_f32 v40, v38
v_rcp_f32 v41, v39
v_mul_f32 v42, v36, v40
v_mul_f32 v43, v37, v41
v_cvt_pk_bf16_f32 v35, v42, v43
ds_write_b64 v10, v[32:33]
ds_write_b64 v10, v[34:35] offset:512
s_waitcnt vmcnt(4)
s_add_u32 s63, s74, 61440
buffer_load_dwordx4 v[84:87], v12, s[20:23], s63 offen nt
s_waitcnt vmcnt(4)
s_add_u32 s63, s74, 73728
buffer_load_dwordx4 v[88:91], v12, s[20:23], s63 offen nt
s_waitcnt vmcnt(4)
s_add_u32 s63, s74, 86016
buffer_load_dwordx4 v[92:95], v12, s[20:23], s63 offen nt
s_waitcnt vmcnt(4)
s_add_u32 s63, s74, 786432
buffer_load_dwordx4 v[96:99], v12, s[20:23], s63 offen nt
s_waitcnt vmcnt(4)
s_add_u32 s63, s74, 798720
buffer_load_dwordx4 v[100:103], v12, s[20:23], s63 offen nt
s_waitcnt vmcnt(4)
s_add_u32 s63, s74, 811008
buffer_load_dwordx4 v[104:107], v12, s[20:23], s63 offen nt
s_waitcnt vmcnt(4)
s_add_u32 s63, s74, 823296
buffer_load_dwordx4 v[108:111], v12, s[20:23], s63 offen nt
s_waitcnt vmcnt(4)
s_add_u32 s63, s74, 835584
buffer_load_dwordx4 v[112:115], v12, s[20:23], s63 offen nt
v_perm_b32 v32, v68, v64, s64
v_perm_b32 v33, v76, v72, s64
v_perm_b32 v34, v84, v80, s64
v_perm_b32 v35, v92, v88, s64
v_perm_b32 v36, v68, v64, s65
v_perm_b32 v37, v76, v72, s65
v_perm_b32 v38, v84, v80, s65
v_perm_b32 v39, v92, v88, s65
v_perm_b32 v40, v69, v65, s64
v_perm_b32 v41, v77, v73, s64
v_perm_b32 v42, v85, v81, s64
v_perm_b32 v43, v93, v89, s64
v_perm_b32 v44, v69, v65, s65
v_perm_b32 v45, v77, v73, s65
v_perm_b32 v46, v85, v81, s65
v_perm_b32 v47, v93, v89, s65
v_perm_b32 v48, v70, v66, s64
v_perm_b32 v49, v78, v74, s64
v_perm_b32 v50, v86, v82, s64
v_perm_b32 v51, v94, v90, s64
v_perm_b32 v52, v70, v66, s65
v_perm_b32 v53, v78, v74, s65
v_perm_b32 v54, v86, v82, s65
v_perm_b32 v55, v94, v90, s65
v_perm_b32 v56, v71, v67, s64
v_perm_b32 v57, v79, v75, s64
v_perm_b32 v58, v87, v83, s64
v_perm_b32 v59, v95, v91, s64
v_perm_b32 v60, v71, v67, s65
v_perm_b32 v61, v79, v75, s65
v_perm_b32 v62, v87, v83, s65
v_perm_b32 v63, v95, v91, s65
s_waitcnt vmcnt(4)
s_add_u32 s63, s74, 847872
buffer_load_dwordx4 v[116:119], v12, s[20:23], s63 offen nt
s_waitcnt vmcnt(4)
s_add_u32 s63, s74, 860160
buffer_load_dwordx4 v[120:123], v12, s[20:23], s63 offen nt
s_waitcnt vmcnt(4)
s_add_u32 s63, s74, 872448
buffer_load_dwordx4 v[124:127], v12, s[20:23], s63 offen nt
s_waitcnt vmcnt(4)
v_lshrrev_b32 v15, 3, v1
v_mul_u32_u24 v15, 49152, v15
v_and_b32 v16, 7, v1
v_lshl_add_u32 v15, v16, 4, v15
s_mul_i32 s62, s3, 393216
s_add_u32 s62, s62, s72
s_add_u32 s63, s62, 0
buffer_load_dwordx4 v[16:19], v15, s[20:23], s63 offen nt
s_add_u32 s63, s62, 12288
s_waitcnt vmcnt(4)
buffer_load_dwordx4 v[20:23], v15, s[20:23], s63 offen nt
s_add_u32 s63, s62, 24576
s_waitcnt vmcnt(4)
buffer_load_dwordx4 v[24:27], v15, s[20:23], s63 offen nt
s_add_u32 s63, s62, 36864
s_waitcnt vmcnt(4)
buffer_load_dwordx4 v[28:31], v15, s[20:23], s63 offen nt
s_waitcnt vmcnt(4)
s_add_u32 s63, s7, 131072
buffer_load_dwordx4 v[192:195], v0, s[8:11], s63 offen offset:0 nt
v_perm_b32 v64, v100, v96, s64
v_perm_b32 v65, v108, v104, s64
v_perm_b32 v66, v116, v112, s64
v_perm_b32 v67, v124, v120, s64
v_perm_b32 v68, v100, v96, s65
v_perm_b32 v69, v108, v104, s65
v_perm_b32 v70, v116, v112, s65
v_perm_b32 v71, v124, v120, s65
v_perm_b32 v72, v101, v97, s64
v_perm_b32 v73, v109, v105, s64
v_perm_b32 v74, v117, v113, s64
v_perm_b32 v75, v125, v121, s64
v_perm_b32 v76, v101, v97, s65
v_perm_b32 v77, v109, v105, s65
v_perm_b32 v78, v117, v113, s65
v_perm_b32 v79, v125, v121, s65
v_perm_b32 v80, v102, v98, s64
v_perm_b32 v81, v110, v106, s64
v_perm_b32 v82, v118, v114, s64
v_perm_b32 v83, v126, v122, s64
v_perm_b32 v84, v102, v98, s65
v_perm_b32 v85, v110, v106, s65
v_perm_b32 v86, v118, v114, s65
v_perm_b32 v87, v126, v122, s65
v_perm_b32 v88, v103, v99, s64
v_perm_b32 v89, v111, v107, s64
v_perm_b32 v90, v119, v115, s64
v_perm_b32 v91, v127, v123, s64
v_perm_b32 v92, v103, v99, s65
v_perm_b32 v93, v111, v107, s65
v_perm_b32 v94, v119, v115, s65
v_perm_b32 v95, v127, v123, s65
s_add_u32 s63, s7, 131072
buffer_load_dwordx4 v[196:199], v0, s[8:11], s63 offen offset:1024 nt
s_add_u32 s63, s7, 131072
buffer_load_dwordx4 v[200:203], v0, s[8:11], s63 offen offset:2048 nt
s_lshl_b32 s60, s3, 10
s_add_u32 s60, s60, 40960
v_and_b32 v12, 3, v1
v_lshlrev_b32 v12, 8, v12
v_lshrrev_b32 v14, 4, v1
v_lshl_add_u32 v12, v14, 5, v12
v_bfe_u32 v14, v1, 3, 1
v_lshl_add_u32 v12, v14, 4, v12
v_add_u32 v12, s60, v12
s_mov_b32 s66, 0x0f0f0f0f
s_mov_b32 s67, 0x0f0f0f0f
v_mov_b32 v14, 49152
v_cndmask_b32 v13, v12, v14, s[66:67]
v_cndmask_b32 v12, v14, v12, s[66:67]
ds_read_b128 v[96:99], v12 offset:0
ds_read_b128 v[100:103], v13 offset:0
ds_read_b128 v[104:107], v12 offset:128
ds_read_b128 v[108:111], v13 offset:128
s_lshl_b32 s60, s3, 11
s_add_u32 s60, s60, 60416
v_lshrrev_b32 v12, 5, v1
v_lshlrev_b32 v12, 10, v12
v_and_b32 v14, 3, v1
v_lshl_add_u32 v12, v14, 8, v12
v_bfe_u32 v14, v1, 2, 1
v_lshl_add_u32 v12, v14, 7, v12
v_bfe_u32 v14, v1, 4, 1
v_lshl_add_u32 v12, v14, 4, v12
v_add_u32 v12, s60, v12
s_waitcnt lgkmcnt(0)
v_mfma_f32_16x16x32_bf16 v[112:115], v[32:35], v[96:99], 0
v_mfma_f32_16x16x32_bf16 v[116:119], v[36:39], v[96:99], 0
v_mfma_f32_16x16x32_bf16 v[120:123], v[40:43], v[96:99], 0
v_mfma_f32_16x16x32_bf16 v[124:127], v[44:47], v[96:99], 0
v_mfma_f32_16x16x32_bf16 v[112:115], v[48:51], v[100:103], v[112:115]
v_mfma_f32_16x16x32_bf16 v[116:119], v[52:55], v[100:103], v[116:119]
v_mfma_f32_16x16x32_bf16 v[120:123], v[56:59], v[100:103], v[120:123]
v_mfma_f32_16x16x32_bf16 v[124:127], v[60:63], v[100:103], v[124:127]
v_mfma_f32_16x16x32_bf16 v[112:115], v[64:67], v[104:107], v[112:115]
v_mfma_f32_16x16x32_bf16 v[116:119], v[68:71], v[104:107], v[116:119]
v_mfma_f32_16x16x32_bf16 v[120:123], v[72:75], v[104:107], v[120:123]
v_mfma_f32_16x16x32_bf16 v[124:127], v[76:79], v[104:107], v[124:127]
v_mfma_f32_16x16x32_bf16 v[112:115], v[80:83], v[108:111], v[112:115]
v_mfma_f32_16x16x32_bf16 v[116:119], v[84:87], v[108:111], v[116:119]
v_mfma_f32_16x16x32_bf16 v[120:123], v[88:91], v[108:111], v[120:123]
v_mfma_f32_16x16x32_bf16 v[124:127], v[92:95], v[108:111], v[124:127]
s_mov_b32 exec_lo, 0xff00ff
s_mov_b32 exec_hi, 0xff00ff00
s_nop 2
ds_write_b128 v12, v[112:115] offset:0
ds_write_b128 v12, v[116:119] offset:32
ds_write_b128 v12, v[120:123] offset:64
ds_write_b128 v12, v[124:127] offset:96
s_mov_b64 exec, -1
s_lshl_b32 s60, s3, 8
s_add_u32 s60, s60, 60416
v_bfe_u32 v13, v1, 2, 1
v_lshlrev_b32 v13, 7, v13
v_and_b32 v14, 3, v1
v_lshl_add_u32 v13, v14, 5, v13
v_lshrrev_b32 v14, 5, v1
v_lshl_add_u32 v13, v14, 4, v13
v_bfe_u32 v14, v1, 3, 2
v_lshl_add_u32 v13, v14, 2, v13
v_add_u32 v13, s60, v13
s_waitcnt lgkmcnt(0)
s_barrier
s_cmp_ge_u32 s3, 4
s_cbranch_scc1 L_R_fin5
ds_read2st64_b32 v[96:97], v13 offset0:0 offset1:4
ds_read2st64_b32 v[98:99], v13 offset0:8 offset1:12
ds_read2st64_b32 v[100:101], v13 offset0:16 offset1:20
ds_read2st64_b32 v[102:103], v13 offset0:24 offset1:28
ds_read2st64_b32 v[104:105], v13 offset0:32 offset1:36
ds_read2st64_b32 v[106:107], v13 offset0:40 offset1:44
ds_read2st64_b32 v[108:109], v13 offset0:48 offset1:52
ds_read2st64_b32 v[110:111], v13 offset0:56 offset1:60
s_mul_i32 s60, s3, 2048
s_add_u32 s60, s60, s76
v_lshlrev_b32 v12, 1, v1
s_waitcnt lgkmcnt(0)
v_add_f32 v96, v96, v104
v_add_f32 v97, v97, v105
v_add_f32 v98, v98, v106
v_add_f32 v99, v99, v107
v_add_f32 v100, v100, v108
v_add_f32 v101, v101, v109
v_add_f32 v102, v102, v110
v_add_f32 v103, v103, v111
v_add_f32 v96, v96, v100
v_add_f32 v97, v97, v101
v_add_f32 v98, v98, v102
v_add_f32 v99, v99, v103
v_add_f32 v96, v96, v98
v_add_f32 v97, v97, v99
v_add_f32 v96, v96, v97
s_nop 1
v_mov_b32_dpp v97, v96 quad_perm:[1,1,3,3] row_mask:0xf bank_mask:0xf
v_cvt_pk_bf16_f32 v112, v96, v97
s_nop 1
v_mov_b32_dpp v113, v112 row_shl:2 row_mask:0xf bank_mask:0xf
v_mov_b32_dpp v114, v112 row_shl:4 row_mask:0xf bank_mask:0xf
v_mov_b32_dpp v115, v112 row_shl:6 row_mask:0xf bank_mask:0xf
s_mov_b32 exec_lo, 0x1010101
s_mov_b32 exec_hi, 0x1010101
buffer_store_dwordx4 v[112:115], v12, s[16:19], s60 offen sc1
s_mov_b64 exec, -1
L_R_fin5:
s_and_b32 s60, s2, 3
s_lshl_b32 s60, s60, 1
s_lshr_b32 s61, s3, 2
s_add_u32 s60, s60, s61
s_lshl_b32 s60, s60, 10
s_and_b32 s61, s3, 3
s_lshl_b32 s61, s61, 6
s_add_u32 s60, s60, s61
s_add_u32 s60, s60, 40960
v_and_b32 v10, 3, v1
v_lshlrev_b32 v10, 8, v10
v_lshrrev_b32 v15, 4, v1
v_lshl_add_u32 v10, v15, 4, v10
v_bfe_u32 v15, v1, 3, 1
v_lshl_add_u32 v10, v15, 3, v10
v_add_u32 v10, s60, v10
s_mov_b32 s66, 0x0f0f0f0f
s_mov_b32 s67, 0x0f0f0f0f
v_mov_b32 v15, 49152
v_cndmask_b32 v11, v10, v15, s[66:67]
v_cndmask_b32 v10, v15, v10, s[66:67]
ds_read_b64 v[48:49], v10
ds_read_b64 v[50:51], v11
s_lshl_b32 s60, s3, 11
s_add_u32 s60, s60, 83968
v_lshrrev_b32 v10, 5, v1
v_lshlrev_b32 v10, 10, v10
v_and_b32 v15, 3, v1
v_lshl_add_u32 v10, v15, 8, v10
v_bfe_u32 v15, v1, 2, 1
v_lshl_add_u32 v10, v15, 7, v10
v_bfe_u32 v15, v1, 4, 1
v_lshl_add_u32 v10, v15, 4, v10
v_add_u32 v10, s60, v10
s_waitcnt vmcnt(4)
s_add_u32 s63, s7, 131072
buffer_load_dwordx4 v[204:207], v0, s[8:11], s63 offen offset:3072 nt
s_waitcnt vmcnt(4)
s_add_u32 s63, s7, 163840
buffer_load_dwordx4 v[208:211], v0, s[8:11], s63 offen offset:0 nt
v_perm_b32 v32, v20, v16, s64
v_perm_b32 v33, v28, v24, s64
v_perm_b32 v34, v20, v16, s65
v_perm_b32 v35, v28, v24, s65
v_perm_b32 v36, v21, v17, s64
v_perm_b32 v37, v29, v25, s64
v_perm_b32 v38, v21, v17, s65
v_perm_b32 v39, v29, v25, s65
v_perm_b32 v40, v22, v18, s64
v_perm_b32 v41, v30, v26, s64
v_perm_b32 v42, v22, v18, s65
v_perm_b32 v43, v30, v26, s65
v_perm_b32 v44, v23, v19, s64
v_perm_b32 v45, v31, v27, s64
v_perm_b32 v46, v23, v19, s65
v_perm_b32 v47, v31, v27, s65
s_waitcnt lgkmcnt(0)
v_mfma_f32_16x16x16_bf16 v[64:67], v[32:33], v[48:49], 0
v_mfma_f32_16x16x16_bf16 v[68:71], v[34:35], v[48:49], 0
v_mfma_f32_16x16x16_bf16 v[72:75], v[36:37], v[48:49], 0
v_mfma_f32_16x16x16_bf16 v[76:79], v[38:39], v[48:49], 0
v_mfma_f32_16x16x16_bf16 v[64:67], v[40:41], v[50:51], v[64:67]
v_mfma_f32_16x16x16_bf16 v[68:71], v[42:43], v[50:51], v[68:71]
v_mfma_f32_16x16x16_bf16 v[72:75], v[44:45], v[50:51], v[72:75]
v_mfma_f32_16x16x16_bf16 v[76:79], v[46:47], v[50:51], v[76:79]
s_lshl_b32 s60, s3, 8
s_add_u32 s60, s60, 82944
v_bfe_u32 v11, v1, 2, 1
v_lshlrev_b32 v11, 7, v11
v_and_b32 v15, 3, v1
v_lshl_add_u32 v11, v15, 5, v11
v_lshrrev_b32 v15, 5, v1
v_lshl_add_u32 v11, v15, 4, v11
v_bfe_u32 v15, v1, 3, 2
v_lshl_add_u32 v11, v15, 2, v11
v_add_u32 v11, s60, v11
s_mov_b32 exec_lo, 0xff00ff
s_mov_b32 exec_hi, 0xff00ff00
ds_write_b128 v10, v[64:67] offset:0
ds_write_b128 v10, v[68:71] offset:32
ds_write_b128 v10, v[72:75] offset:64
ds_write_b128 v10, v[76:79] offset:96
s_mov_b64 exec, -1
s_add_u32 s63, s7, 163840
buffer_load_dwordx4 v[212:215], v0, s[8:11], s63 offen offset:1024 nt
s_add_u32 s63, s7, 163840
buffer_load_dwordx4 v[216:219], v0, s[8:11], s63 offen offset:2048 nt
s_add_u32 s63, s7, 163840
buffer_load_dwordx4 v[220:223], v0, s[8:11], s63 offen offset:3072 nt
s_waitcnt lgkmcnt(0)
s_barrier
s_cmp_lt_u32 s3, 4
s_cbranch_scc1 L_R_qf6
s_cmp_ge_u32 s2, 248
s_cbranch_scc1 L_R_qend7
ds_read2st64_b32 v[48:49], v11 offset0:0 offset1:4
ds_read2st64_b32 v[50:51], v11 offset0:8 offset1:12
ds_read2st64_b32 v[52:53], v11 offset0:16 offset1:20
ds_read2st64_b32 v[54:55], v11 offset0:24 offset1:28
ds_read2st64_b32 v[56:57], v11 offset0:32 offset1:36
ds_read2st64_b32 v[58:59], v11 offset0:40 offset1:44
ds_read2st64_b32 v[60:61], v11 offset0:48 offset1:52
ds_read2st64_b32 v[62:63], v11 offset0:56 offset1:60
s_lshl_b32 s60, s3, 11
s_add_u32 s60, s60, s73
s_sub_u32 s60, s60, 8192
v_lshlrev_b32 v10, 2, v1
s_waitcnt lgkmcnt(0)
v_add_f32 v48, v48, v56
v_add_f32 v49, v49, v57
v_add_f32 v50, v50, v58
v_add_f32 v51, v51, v59
v_add_f32 v52, v52, v60
v_add_f32 v53, v53, v61
v_add_f32 v54, v54, v62
v_add_f32 v55, v55, v63
v_add_f32 v48, v48, v52
v_add_f32 v49, v49, v53
v_add_f32 v50, v50, v54
v_add_f32 v51, v51, v55
v_add_f32 v48, v48, v50
v_add_f32 v49, v49, v51
v_add_f32 v48, v48, v49
s_nop 1
v_mov_b32_dpp v49, v48 quad_perm:[1,1,1,1] row_mask:0xf bank_mask:0xf
v_mov_b32_dpp v50, v48 quad_perm:[2,2,2,2] row_mask:0xf bank_mask:0xf
v_mov_b32_dpp v51, v48 quad_perm:[3,3,3,3] row_mask:0xf bank_mask:0xf
s_mov_b32 exec_lo, 0x11111111
s_mov_b32 exec_hi, 0x11111111
buffer_store_dwordx4 v[48:51], v10, s[16:19], s60 offen sc1
s_mov_b64 exec, -1
L_R_qend7:
L_R_qf6:
s_waitcnt vmcnt(4)
buffer_load_dword v127, off, s[28:31], 0 offset:0 sc1
ds_write_b128 v2, v[192:195] offset:0
ds_write_b128 v3, v[196:199] offset:1024
ds_write_b128 v4, v[200:203] offset:2048
ds_write_b128 v5, v[204:207] offset:3072
ds_read_b128 v[192:195], v6
ds_read_b128 v[196:199], v7
ds_read_b128 v[200:203], v8
ds_read_b128 v[204:207], v9
s_waitcnt vmcnt(4)
s_add_u32 s63, s7, 196608
buffer_load_dwordx4 v[224:227], v0, s[8:11], s63 offen offset:0 nt
s_waitcnt vmcnt(4)
s_add_u32 s63, s7, 196608
buffer_load_dwordx4 v[228:231], v0, s[8:11], s63 offen offset:1024 nt
s_waitcnt vmcnt(4)
s_add_u32 s63, s7, 196608
buffer_load_dwordx4 v[232:235], v0, s[8:11], s63 offen offset:2048 nt
s_waitcnt vmcnt(4)
s_add_u32 s63, s7, 196608
buffer_load_dwordx4 v[236:239], v0, s[8:11], s63 offen offset:3072 nt
ds_write_b128 v2, v[208:211] offset:0
ds_write_b128 v3, v[212:215] offset:1024
ds_write_b128 v4, v[216:219] offset:2048
ds_write_b128 v5, v[220:223] offset:3072
ds_read_b128 v[208:211], v6
ds_read_b128 v[212:215], v7
ds_read_b128 v[216:219], v8
ds_read_b128 v[220:223], v9
s_waitcnt vmcnt(4)
s_add_u32 s63, s7, 229376
buffer_load_dwordx4 v[240:243], v0, s[8:11], s63 offen offset:0 nt
s_waitcnt vmcnt(4)
s_add_u32 s63, s7, 229376
buffer_load_dwordx4 v[244:247], v0, s[8:11], s63 offen offset:1024 nt
s_waitcnt vmcnt(4)
s_add_u32 s63, s7, 229376
buffer_load_dwordx4 v[248:251], v0, s[8:11], s63 offen offset:2048 nt
s_waitcnt vmcnt(4)
s_add_u32 s63, s7, 229376
buffer_load_dwordx4 v[252:255], v0, s[8:11], s63 offen offset:3072 nt
s_waitcnt vmcnt(4)
ds_write_b128 v2, v[224:227] offset:0
ds_write_b128 v3, v[228:231] offset:1024
ds_write_b128 v4, v[232:235] offset:2048
ds_write_b128 v5, v[236:239] offset:3072
ds_read_b128 v[224:227], v6
ds_read_b128 v[228:231], v7
ds_read_b128 v[232:235], v8
ds_read_b128 v[236:239], v9
v_readfirstlane_b32 s60, v127
s_mov_b32 s70, 0
s_cmp_ge_u32 s60, 256
s_cbranch_scc1 L_R_cok8
L_R_cretry9:
buffer_load_dword v127, off, s[28:31], 0 offset:0 sc1
s_waitcnt vmcnt(0)
v_readfirstlane_b32 s60, v127
s_add_u32 s70, s70, 1
s_cmp_ge_u32 s70, 262144
s_cbranch_scc1 L_R_cok8
s_cmp_lt_u32 s60, 256
s_cbranch_scc1 L_R_cretry9
L_R_cok8:
s_lshr_b32 s75, s5, 4
s_lshl_b32 s75, s75, 11
s_add_u32 s75, s75, 65536
buffer_load_dwordx4 v[16:19], v0, s[16:19], s75 offen offset:0 sc1
buffer_load_dwordx4 v[20:23], v0, s[16:19], s75 offen offset:1024 sc1
s_waitcnt vmcnt(4)
s_add_u32 s63, s7, 0
buffer_load_dwordx4 v[64:67], v0, s[12:15], s63 offen offset:0 nt
s_waitcnt vmcnt(4)
s_add_u32 s63, s7, 0
buffer_load_dwordx4 v[68:71], v0, s[12:15], s63 offen offset:1024 nt
s_waitcnt vmcnt(4)
s_add_u32 s63, s7, 0
buffer_load_dwordx4 v[72:75], v0, s[12:15], s63 offen offset:2048 nt
ds_write_b128 v2, v[240:243] offset:0
ds_write_b128 v3, v[244:247] offset:1024
ds_write_b128 v4, v[248:251] offset:2048
ds_write_b128 v5, v[252:255] offset:3072
ds_read_b128 v[240:243], v6
ds_read_b128 v[244:247], v7
ds_read_b128 v[248:251], v8
ds_read_b128 v[252:255], v9
s_cmp_lt_u32 s3, 4
s_cbranch_scc1 L_R_pr10
s_setprio 1
L_R_pr10:
s_lshl_b32 s60, s3, 12
v_and_b32 v10, 3, v1
v_lshlrev_b32 v10, 2, v10
v_bfe_u32 v11, v1, 2, 1
v_or_b32 v10, v10, v11
v_lshrrev_b32 v11, 4, v1
v_xor_b32 v10, v10, v11
v_lshlrev_b32 v10, 4, v10
v_and_b32 v11, 7, v1
v_lshl_add_u32 v10, v11, 8, v10
v_add_u32 v6, s60, v10
v_xor_b32 v7, 64, v6
v_xor_b32 v8, 128, v6
v_xor_b32 v9, 192, v6
s_waitcnt vmcnt(4)
s_add_u32 s63, s7, 0
buffer_load_dwordx4 v[76:79], v0, s[12:15], s63 offen offset:3072 nt
s_waitcnt vmcnt(4)
s_add_u32 s63, s7, 32768
buffer_load_dwordx4 v[80:83], v0, s[12:15], s63 offen offset:0 nt
v_max_u32 v10, v16, v17
v_max3_u32 v10, v10, v18, v19
v_max3_u32 v10, v10, v20, v21
v_max3_u32 v10, v10, v22, v23
v_cmp_eq_u32 vcc, -1, v10
s_cbranch_vccz L_R_ok11
s_mov_b32 s70, 0
L_R_retry12:
buffer_load_dwordx4 v[16:19], v0, s[16:19], s75 offen offset:0 sc1
buffer_load_dwordx4 v[20:23], v0, s[16:19], s75 offen offset:1024 sc1
s_waitcnt vmcnt(0)
v_max_u32 v10, v16, v17
v_max3_u32 v10, v10, v18, v19
v_max3_u32 v10, v10, v20, v21
v_max3_u32 v10, v10, v22, v23
s_add_u32 s70, s70, 1
s_cmp_ge_u32 s70, 262144
s_cbranch_scc1 L_R_ok11
v_cmp_eq_u32 vcc, -1, v10
s_cbranch_vccnz L_R_retry12
L_R_ok11:
ds_write_b128 v2, v[16:19] offset:0
ds_write_b128 v3, v[20:23] offset:1024
ds_read_b128 v[16:19], v6
ds_read_b128 v[20:23], v7
ds_read_b128 v[24:27], v8
ds_read_b128 v[28:31], v9
s_waitcnt lgkmcnt(0)
v_mfma_f32_16x16x32_bf16 v[32:35], v[128:131], v[16:19], 0
v_mfma_f32_16x16x32_bf16 v[32:35], v[132:135], v[20:23], v[32:35]
v_mfma_f32_16x16x32_bf16 v[32:35], v[136:139], v[24:27], v[32:35]
v_mfma_f32_16x16x32_bf16 v[32:35], v[140:143], v[28:31], v[32:35]
v_mfma_f32_16x16x32_bf16 v[36:39], v[144:147], v[16:19], 0
v_mfma_f32_16x16x32_bf16 v[36:39], v[148:151], v[20:23], v[36:39]
v_mfma_f32_16x16x32_bf16 v[36:39], v[152:155], v[24:27], v[36:39]
v_mfma_f32_16x16x32_bf16 v[36:39], v[156:159], v[28:31], v[36:39]
s_add_u32 s63, s7, 32768
buffer_load_dwordx4 v[84:87], v0, s[12:15], s63 offen offset:1024 nt
s_add_u32 s63, s7, 32768
buffer_load_dwordx4 v[88:91], v0, s[12:15], s63 offen offset:2048 nt
v_mfma_f32_16x16x32_bf16 v[40:43], v[160:163], v[16:19], 0
v_mfma_f32_16x16x32_bf16 v[40:43], v[164:167], v[20:23], v[40:43]
v_mfma_f32_16x16x32_bf16 v[40:43], v[168:171], v[24:27], v[40:43]
v_mfma_f32_16x16x32_bf16 v[40:43], v[172:175], v[28:31], v[40:43]
v_mfma_f32_16x16x32_bf16 v[44:47], v[176:179], v[16:19], 0
v_mfma_f32_16x16x32_bf16 v[44:47], v[180:183], v[20:23], v[44:47]
v_mfma_f32_16x16x32_bf16 v[44:47], v[184:187], v[24:27], v[44:47]
v_mfma_f32_16x16x32_bf16 v[44:47], v[188:191], v[28:31], v[44:47]
v_mfma_f32_16x16x32_bf16 v[48:51], v[192:195], v[16:19], 0
v_mfma_f32_16x16x32_bf16 v[48:51], v[196:199], v[20:23], v[48:51]
v_mfma_f32_16x16x32_bf16 v[48:51], v[200:203], v[24:27], v[48:51]
v_mfma_f32_16x16x32_bf16 v[48:51], v[204:207], v[28:31], v[48:51]
v_mfma_f32_16x16x32_bf16 v[52:55], v[208:211], v[16:19], 0
v_mfma_f32_16x16x32_bf16 v[52:55], v[212:215], v[20:23], v[52:55]
v_mfma_f32_16x16x32_bf16 v[52:55], v[216:219], v[24:27], v[52:55]
v_mfma_f32_16x16x32_bf16 v[52:55], v[220:223], v[28:31], v[52:55]
v_mfma_f32_16x16x32_bf16 v[56:59], v[224:227], v[16:19], 0
v_mfma_f32_16x16x32_bf16 v[56:59], v[228:231], v[20:23], v[56:59]
v_mfma_f32_16x16x32_bf16 v[56:59], v[232:235], v[24:27], v[56:59]
v_mfma_f32_16x16x32_bf16 v[56:59], v[236:239], v[28:31], v[56:59]
v_mfma_f32_16x16x32_bf16 v[60:63], v[240:243], v[16:19], 0
v_mfma_f32_16x16x32_bf16 v[60:63], v[244:247], v[20:23], v[60:63]
v_mfma_f32_16x16x32_bf16 v[60:63], v[248:251], v[24:27], v[60:63]
v_mfma_f32_16x16x32_bf16 v[60:63], v[252:255], v[28:31], v[60:63]
s_add_u32 s63, s7, 32768
buffer_load_dwordx4 v[92:95], v0, s[12:15], s63 offen offset:3072 nt
v_cvt_pk_bf16_f32 v2, v32, v33
v_lshlrev_b32 v32, 16, v2
v_and_b32 v33, 0xffff0000, v2
v_cvt_pk_bf16_f32 v3, v34, v35
v_lshlrev_b32 v34, 16, v3
v_and_b32 v35, 0xffff0000, v3
v_mul_f32 v32, 0x3db504f3, v32
v_mul_f32 v33, 0x3db504f3, v33
v_mul_f32 v34, 0x3db504f3, v34
v_mul_f32 v35, 0x3db504f3, v35
v_cvt_pk_bf16_f32 v2, v32, v33
v_lshlrev_b32 v32, 16, v2
v_and_b32 v33, 0xffff0000, v2
v_cvt_pk_bf16_f32 v3, v34, v35
v_lshlrev_b32 v34, 16, v3
v_and_b32 v35, 0xffff0000, v3
v_max_f32 v4, v32, v33
v_max3_f32 v4, v4, v34, v35
v_cvt_pk_bf16_f32 v2, v36, v37
v_lshlrev_b32 v36, 16, v2
v_and_b32 v37, 0xffff0000, v2
v_cvt_pk_bf16_f32 v3, v38, v39
v_lshlrev_b32 v38, 16, v3
v_and_b32 v39, 0xffff0000, v3
v_mul_f32 v36, 0x3db504f3, v36
v_mul_f32 v37, 0x3db504f3, v37
v_mul_f32 v38, 0x3db504f3, v38
v_mul_f32 v39, 0x3db504f3, v39
v_cvt_pk_bf16_f32 v2, v36, v37
v_lshlrev_b32 v36, 16, v2
v_and_b32 v37, 0xffff0000, v2
v_cvt_pk_bf16_f32 v3, v38, v39
v_lshlrev_b32 v38, 16, v3
v_and_b32 v39, 0xffff0000, v3
v_max3_f32 v4, v4, v36, v37
v_max3_f32 v4, v4, v38, v39
v_cvt_pk_bf16_f32 v2, v40, v41
v_lshlrev_b32 v40, 16, v2
v_and_b32 v41, 0xffff0000, v2
v_cvt_pk_bf16_f32 v3, v42, v43
v_lshlrev_b32 v42, 16, v3
v_and_b32 v43, 0xffff0000, v3
v_mul_f32 v40, 0x3db504f3, v40
v_mul_f32 v41, 0x3db504f3, v41
v_mul_f32 v42, 0x3db504f3, v42
v_mul_f32 v43, 0x3db504f3, v43
v_cvt_pk_bf16_f32 v2, v40, v41
v_lshlrev_b32 v40, 16, v2
v_and_b32 v41, 0xffff0000, v2
v_cvt_pk_bf16_f32 v3, v42, v43
v_lshlrev_b32 v42, 16, v3
v_and_b32 v43, 0xffff0000, v3
v_max3_f32 v4, v4, v40, v41
v_max3_f32 v4, v4, v42, v43
v_cvt_pk_bf16_f32 v2, v44, v45
v_lshlrev_b32 v44, 16, v2
v_and_b32 v45, 0xffff0000, v2
v_cvt_pk_bf16_f32 v3, v46, v47
v_lshlrev_b32 v46, 16, v3
v_and_b32 v47, 0xffff0000, v3
v_mul_f32 v44, 0x3db504f3, v44
v_mul_f32 v45, 0x3db504f3, v45
v_mul_f32 v46, 0x3db504f3, v46
v_mul_f32 v47, 0x3db504f3, v47
v_cvt_pk_bf16_f32 v2, v44, v45
v_lshlrev_b32 v44, 16, v2
v_and_b32 v45, 0xffff0000, v2
v_cvt_pk_bf16_f32 v3, v46, v47
v_lshlrev_b32 v46, 16, v3
v_and_b32 v47, 0xffff0000, v3
v_max3_f32 v4, v4, v44, v45
v_max3_f32 v4, v4, v46, v47
v_cvt_pk_bf16_f32 v2, v48, v49
v_lshlrev_b32 v48, 16, v2
v_and_b32 v49, 0xffff0000, v2
v_cvt_pk_bf16_f32 v3, v50, v51
v_lshlrev_b32 v50, 16, v3
v_and_b32 v51, 0xffff0000, v3
v_mul_f32 v48, 0x3db504f3, v48
v_mul_f32 v49, 0x3db504f3, v49
v_mul_f32 v50, 0x3db504f3, v50
v_mul_f32 v51, 0x3db504f3, v51
v_cvt_pk_bf16_f32 v2, v48, v49
v_lshlrev_b32 v48, 16, v2
v_and_b32 v49, 0xffff0000, v2
v_cvt_pk_bf16_f32 v3, v50, v51
v_lshlrev_b32 v50, 16, v3
v_and_b32 v51, 0xffff0000, v3
v_max3_f32 v4, v4, v48, v49
v_max3_f32 v4, v4, v50, v51
v_cvt_pk_bf16_f32 v2, v52, v53
v_lshlrev_b32 v52, 16, v2
v_and_b32 v53, 0xffff0000, v2
v_cvt_pk_bf16_f32 v3, v54, v55
v_lshlrev_b32 v54, 16, v3
v_and_b32 v55, 0xffff0000, v3
v_mul_f32 v52, 0x3db504f3, v52
v_mul_f32 v53, 0x3db504f3, v53
v_mul_f32 v54, 0x3db504f3, v54
v_mul_f32 v55, 0x3db504f3, v55
v_cvt_pk_bf16_f32 v2, v52, v53
v_lshlrev_b32 v52, 16, v2
v_and_b32 v53, 0xffff0000, v2
v_cvt_pk_bf16_f32 v3, v54, v55
v_lshlrev_b32 v54, 16, v3
v_and_b32 v55, 0xffff0000, v3
v_max3_f32 v4, v4, v52, v53
v_max3_f32 v4, v4, v54, v55
v_cvt_pk_bf16_f32 v2, v56, v57
v_lshlrev_b32 v56, 16, v2
v_and_b32 v57, 0xffff0000, v2
v_cvt_pk_bf16_f32 v3, v58, v59
v_lshlrev_b32 v58, 16, v3
v_and_b32 v59, 0xffff0000, v3
v_mul_f32 v56, 0x3db504f3, v56
v_mul_f32 v57, 0x3db504f3, v57
v_mul_f32 v58, 0x3db504f3, v58
v_mul_f32 v59, 0x3db504f3, v59
v_cvt_pk_bf16_f32 v2, v56, v57
v_lshlrev_b32 v56, 16, v2
v_and_b32 v57, 0xffff0000, v2
v_cvt_pk_bf16_f32 v3, v58, v59
v_lshlrev_b32 v58, 16, v3
v_and_b32 v59, 0xffff0000, v3
v_max3_f32 v4, v4, v56, v57
v_max3_f32 v4, v4, v58, v59
v_cvt_pk_bf16_f32 v2, v60, v61
v_lshlrev_b32 v60, 16, v2
v_and_b32 v61, 0xffff0000, v2
v_cvt_pk_bf16_f32 v3, v62, v63
v_lshlrev_b32 v62, 16, v3
v_and_b32 v63, 0xffff0000, v3
v_mul_f32 v60, 0x3db504f3, v60
v_mul_f32 v61, 0x3db504f3, v61
v_mul_f32 v62, 0x3db504f3, v62
v_mul_f32 v63, 0x3db504f3, v63
v_cvt_pk_bf16_f32 v2, v60, v61
v_lshlrev_b32 v60, 16, v2
v_and_b32 v61, 0xffff0000, v2
v_cvt_pk_bf16_f32 v3, v62, v63
v_lshlrev_b32 v62, 16, v3
v_and_b32 v63, 0xffff0000, v3
v_max3_f32 v4, v4, v60, v61
v_max3_f32 v4, v4, v62, v63
s_waitcnt vmcnt(5)
s_add_u32 s63, s7, 65536
buffer_load_dwordx4 v[96:99], v0, s[12:15], s63 offen offset:0 nt
s_waitcnt vmcnt(5)
s_add_u32 s63, s7, 65536
buffer_load_dwordx4 v[100:103], v0, s[12:15], s63 offen offset:1024 nt
v_mov_b32 v5, v4
s_nop 1
v_permlane16_swap_b32 v4, v5
v_max_f32 v4, v4, v5
v_mov_b32 v5, v4
s_nop 1
v_permlane32_swap_b32 v4, v5
v_max_f32 v4, v4, v5
v_mul_f32 v6, 0xbfb8aa3b, v4
s_mov_b32 s60, 0x3fb8aa3b
s_mov_b32 s66, 0x00ff00ff
s_mov_b32 s67, 0x00ff00ff
v_mov_b32 v5, 0
v_fma_f32 v32, v32, s60, v6
v_fma_f32 v33, v33, s60, v6
v_fma_f32 v34, v34, s60, v6
v_fma_f32 v35, v35, s60, v6
v_exp_f32 v32, v32
v_exp_f32 v33, v33
v_exp_f32 v34, v34
v_exp_f32 v35, v35
v_add_f32 v7, v32, v33
v_add_f32 v8, v34, v35
v_cvt_pk_bf16_f32 v2, v32, v33
v_cvt_pk_bf16_f32 v3, v34, v35
v_add_f32 v5, v5, v7
v_add_f32 v5, v5, v8
v_cndmask_b32 v16, 0, v2, s[66:67]
v_cndmask_b32 v32, v2, 0, s[66:67]
v_cndmask_b32 v17, 0, v3, s[66:67]
v_cndmask_b32 v33, v3, 0, s[66:67]
v_fma_f32 v36, v36, s60, v6
v_fma_f32 v37, v37, s60, v6
v_fma_f32 v38, v38, s60, v6
v_fma_f32 v39, v39, s60, v6
v_exp_f32 v36, v36
v_exp_f32 v37, v37
v_exp_f32 v38, v38
v_exp_f32 v39, v39
v_add_f32 v7, v36, v37
v_add_f32 v8, v38, v39
v_cvt_pk_bf16_f32 v2, v36, v37
v_cvt_pk_bf16_f32 v3, v38, v39
v_add_f32 v5, v5, v7
v_add_f32 v5, v5, v8
v_cndmask_b32 v18, 0, v2, s[66:67]
v_cndmask_b32 v34, v2, 0, s[66:67]
v_cndmask_b32 v19, 0, v3, s[66:67]
v_cndmask_b32 v35, v3, 0, s[66:67]
v_fma_f32 v40, v40, s60, v6
v_fma_f32 v41, v41, s60, v6
v_fma_f32 v42, v42, s60, v6
v_fma_f32 v43, v43, s60, v6
v_exp_f32 v40, v40
v_exp_f32 v41, v41
v_exp_f32 v42, v42
v_exp_f32 v43, v43
v_add_f32 v7, v40, v41
v_add_f32 v8, v42, v43
v_cvt_pk_bf16_f32 v2, v40, v41
v_cvt_pk_bf16_f32 v3, v42, v43
v_add_f32 v5, v5, v7
v_add_f32 v5, v5, v8
v_cndmask_b32 v20, 0, v2, s[66:67]
v_cndmask_b32 v36, v2, 0, s[66:67]
v_cndmask_b32 v21, 0, v3, s[66:67]
v_cndmask_b32 v37, v3, 0, s[66:67]
v_fma_f32 v44, v44, s60, v6
v_fma_f32 v45, v45, s60, v6
v_fma_f32 v46, v46, s60, v6
v_fma_f32 v47, v47, s60, v6
v_exp_f32 v44, v44
v_exp_f32 v45, v45
v_exp_f32 v46, v46
v_exp_f32 v47, v47
v_add_f32 v7, v44, v45
v_add_f32 v8, v46, v47
v_cvt_pk_bf16_f32 v2, v44, v45
v_cvt_pk_bf16_f32 v3, v46, v47
v_add_f32 v5, v5, v7
v_add_f32 v5, v5, v8
v_cndmask_b32 v22, 0, v2, s[66:67]
v_cndmask_b32 v38, v2, 0, s[66:67]
v_cndmask_b32 v23, 0, v3, s[66:67]
v_cndmask_b32 v39, v3, 0, s[66:67]
v_fma_f32 v48, v48, s60, v6
v_fma_f32 v49, v49, s60, v6
v_fma_f32 v50, v50, s60, v6
v_fma_f32 v51, v51, s60, v6
v_exp_f32 v48, v48
v_exp_f32 v49, v49
v_exp_f32 v50, v50
v_exp_f32 v51, v51
v_add_f32 v7, v48, v49
v_add_f32 v8, v50, v51
v_cvt_pk_bf16_f32 v2, v48, v49
v_cvt_pk_bf16_f32 v3, v50, v51
v_add_f32 v5, v5, v7
v_add_f32 v5, v5, v8
v_cndmask_b32 v24, 0, v2, s[66:67]
v_cndmask_b32 v40, v2, 0, s[66:67]
v_cndmask_b32 v25, 0, v3, s[66:67]
v_cndmask_b32 v41, v3, 0, s[66:67]
v_fma_f32 v52, v52, s60, v6
v_fma_f32 v53, v53, s60, v6
v_fma_f32 v54, v54, s60, v6
v_fma_f32 v55, v55, s60, v6
v_exp_f32 v52, v52
v_exp_f32 v53, v53
v_exp_f32 v54, v54
v_exp_f32 v55, v55
v_add_f32 v7, v52, v53
v_add_f32 v8, v54, v55
v_cvt_pk_bf16_f32 v2, v52, v53
v_cvt_pk_bf16_f32 v3, v54, v55
v_add_f32 v5, v5, v7
v_add_f32 v5, v5, v8
v_cndmask_b32 v26, 0, v2, s[66:67]
v_cndmask_b32 v42, v2, 0, s[66:67]
v_cndmask_b32 v27, 0, v3, s[66:67]
v_cndmask_b32 v43, v3, 0, s[66:67]
v_fma_f32 v56, v56, s60, v6
v_fma_f32 v57, v57, s60, v6
v_fma_f32 v58, v58, s60, v6
v_fma_f32 v59, v59, s60, v6
v_exp_f32 v56, v56
v_exp_f32 v57, v57
v_exp_f32 v58, v58
v_exp_f32 v59, v59
v_add_f32 v7, v56, v57
v_add_f32 v8, v58, v59
v_cvt_pk_bf16_f32 v2, v56, v57
v_cvt_pk_bf16_f32 v3, v58, v59
v_add_f32 v5, v5, v7
v_add_f32 v5, v5, v8
v_cndmask_b32 v28, 0, v2, s[66:67]
v_cndmask_b32 v44, v2, 0, s[66:67]
v_cndmask_b32 v29, 0, v3, s[66:67]
v_cndmask_b32 v45, v3, 0, s[66:67]
v_fma_f32 v60, v60, s60, v6
v_fma_f32 v61, v61, s60, v6
v_fma_f32 v62, v62, s60, v6
v_fma_f32 v63, v63, s60, v6
v_exp_f32 v60, v60
v_exp_f32 v61, v61
v_exp_f32 v62, v62
v_exp_f32 v63, v63
v_add_f32 v7, v60, v61
v_add_f32 v8, v62, v63
v_cvt_pk_bf16_f32 v2, v60, v61
v_cvt_pk_bf16_f32 v3, v62, v63
v_add_f32 v5, v5, v7
v_add_f32 v5, v5, v8
v_cndmask_b32 v30, 0, v2, s[66:67]
v_cndmask_b32 v46, v2, 0, s[66:67]
v_cndmask_b32 v31, 0, v3, s[66:67]
v_cndmask_b32 v47, v3, 0, s[66:67]
v_mov_b32 v6, v5
s_nop 1
v_permlane16_swap_b32 v5, v6
v_add_f32 v5, v5, v6
v_mov_b32 v6, v5
s_nop 1
v_permlane32_swap_b32 v5, v6
v_add_f32 v5, v5, v6
s_lshl_b32 s60, s3, 6
s_add_u32 s60, s60, 49664
v_lshlrev_b32 v6, 3, v1
v_add_u32 v7, s60, v6
v_mov_b32 v8, 1
v_mov_b32 v9, 50176
s_mov_b32 exec_lo, 0xff
s_mov_b32 exec_hi, 0x0
ds_write_b64 v7, v[4:5]
s_mov_b64 exec, 1
ds_add_rtn_u32 v8, v9, v8
s_mov_b64 exec, -1
s_waitcnt lgkmcnt(0)
v_readfirstlane_b32 s60, v8
s_cmp_lg_u32 s60, 7
s_cbranch_scc1 L_R_ml13
ds_read_b64 v[8:9], v6 offset:49664
s_waitcnt lgkmcnt(0)
v_max_f32_dpp v2, v8, v8 row_ror:8 row_mask:0xf bank_mask:0xf
v_mov_b32 v7, v2
s_nop 1
v_permlane16_swap_b32 v2, v7
v_max_f32 v2, v2, v7
v_mov_b32 v7, v2
s_nop 1
v_permlane32_swap_b32 v2, v7
v_max_f32 v2, v2, v7
v_sub_f32 v7, v8, v2
v_mul_f32 v7, 0x3fb8aa3b, v7
v_exp_f32 v7, v7
s_nop 0
v_mul_f32 v3, v9, v7
s_nop 1
v_add_f32_dpp v3, v3, v3 row_ror:8 row_mask:0xf bank_mask:0xf
v_mov_b32 v7, v3
s_nop 1
v_permlane16_swap_b32 v3, v7
v_add_f32 v3, v3, v7
v_mov_b32 v7, v3
s_nop 1
v_permlane32_swap_b32 v3, v7
v_add_f32 v3, v3, v7
s_lshl_b32 s60, s5, 7
s_add_u32 s60, s60, 131072
s_mov_b32 exec_lo, 0xff
s_mov_b32 exec_hi, 0x0
buffer_store_dwordx2 v[2:3], v6, s[16:19], s60 offen sc1
s_mov_b64 exec, -1
L_R_ml13:
s_setprio 0
s_waitcnt vmcnt(4)
s_add_u32 s63, s7, 65536
buffer_load_dwordx4 v[104:107], v0, s[12:15], s63 offen offset:2048 nt
s_waitcnt vmcnt(4)
s_add_u32 s63, s7, 65536
buffer_load_dwordx4 v[108:111], v0, s[12:15], s63 offen offset:3072 nt
s_waitcnt vmcnt(4)
s_add_u32 s63, s7, 98304
buffer_load_dwordx4 v[112:115], v0, s[12:15], s63 offen offset:0 nt
v_perm_b32 v160, v68, v64, s64
v_perm_b32 v161, v76, v72, s64
v_perm_b32 v162, v84, v80, s64
v_perm_b32 v163, v92, v88, s64
v_perm_b32 v164, v68, v64, s65
v_perm_b32 v165, v76, v72, s65
v_perm_b32 v166, v84, v80, s65
v_perm_b32 v167, v92, v88, s65
v_mfma_f32_16x16x32_bf16 v[48:51], v[160:163], v[16:19], 0
s_nop 0
v_mfma_f32_16x16x32_bf16 v[52:55], v[164:167], v[16:19], 0
v_perm_b32 v168, v69, v65, s64
v_perm_b32 v169, v77, v73, s64
v_perm_b32 v170, v85, v81, s64
v_perm_b32 v171, v93, v89, s64
v_perm_b32 v172, v69, v65, s65
v_perm_b32 v173, v77, v73, s65
v_perm_b32 v174, v85, v81, s65
v_perm_b32 v175, v93, v89, s65
v_mfma_f32_16x16x32_bf16 v[56:59], v[168:171], v[16:19], 0
s_nop 0
v_mfma_f32_16x16x32_bf16 v[60:63], v[172:175], v[16:19], 0
v_perm_b32 v160, v70, v66, s64
v_perm_b32 v161, v78, v74, s64
v_perm_b32 v162, v86, v82, s64
v_perm_b32 v163, v94, v90, s64
v_perm_b32 v164, v70, v66, s65
v_perm_b32 v165, v78, v74, s65
v_perm_b32 v166, v86, v82, s65
v_perm_b32 v167, v94, v90, s65
v_mfma_f32_16x16x32_bf16 v[48:51], v[160:163], v[32:35], v[48:51]
s_nop 0
v_mfma_f32_16x16x32_bf16 v[52:55], v[164:167], v[32:35], v[52:55]
v_perm_b32 v168, v71, v67, s64
v_perm_b32 v169, v79, v75, s64
v_perm_b32 v170, v87, v83, s64
v_perm_b32 v171, v95, v91, s64
v_perm_b32 v172, v71, v67, s65
v_perm_b32 v173, v79, v75, s65
v_perm_b32 v174, v87, v83, s65
v_perm_b32 v175, v95, v91, s65
v_mfma_f32_16x16x32_bf16 v[56:59], v[168:171], v[32:35], v[56:59]
s_nop 0
v_mfma_f32_16x16x32_bf16 v[60:63], v[172:175], v[32:35], v[60:63]
s_waitcnt vmcnt(4)
s_add_u32 s63, s7, 98304
buffer_load_dwordx4 v[116:119], v0, s[12:15], s63 offen offset:1024 nt
s_waitcnt vmcnt(4)
s_add_u32 s63, s7, 98304
buffer_load_dwordx4 v[120:123], v0, s[12:15], s63 offen offset:2048 nt
s_waitcnt vmcnt(4)
s_add_u32 s63, s7, 98304
buffer_load_dwordx4 v[124:127], v0, s[12:15], s63 offen offset:3072 nt
s_waitcnt vmcnt(4)
s_add_u32 s63, s7, 131072
buffer_load_dwordx4 v[128:131], v0, s[12:15], s63 offen offset:0 nt
s_waitcnt vmcnt(4)
s_add_u32 s63, s7, 131072
buffer_load_dwordx4 v[132:135], v0, s[12:15], s63 offen offset:1024 nt
s_waitcnt vmcnt(4)
s_add_u32 s63, s7, 131072
buffer_load_dwordx4 v[136:139], v0, s[12:15], s63 offen offset:2048 nt
s_waitcnt vmcnt(4)
s_add_u32 s63, s7, 131072
buffer_load_dwordx4 v[140:143], v0, s[12:15], s63 offen offset:3072 nt
s_waitcnt vmcnt(4)
s_add_u32 s63, s7, 163840
buffer_load_dwordx4 v[144:147], v0, s[12:15], s63 offen offset:0 nt
v_perm_b32 v64, v100, v96, s64
v_perm_b32 v65, v108, v104, s64
v_perm_b32 v66, v116, v112, s64
v_perm_b32 v67, v124, v120, s64
v_perm_b32 v68, v100, v96, s65
v_perm_b32 v69, v108, v104, s65
v_perm_b32 v70, v116, v112, s65
v_perm_b32 v71, v124, v120, s65
v_mfma_f32_16x16x32_bf16 v[48:51], v[64:67], v[20:23], v[48:51]
s_nop 0
v_mfma_f32_16x16x32_bf16 v[52:55], v[68:71], v[20:23], v[52:55]
v_perm_b32 v72, v101, v97, s64
v_perm_b32 v73, v109, v105, s64
v_perm_b32 v74, v117, v113, s64
v_perm_b32 v75, v125, v121, s64
v_perm_b32 v76, v101, v97, s65
v_perm_b32 v77, v109, v105, s65
v_perm_b32 v78, v117, v113, s65
v_perm_b32 v79, v125, v121, s65
v_mfma_f32_16x16x32_bf16 v[56:59], v[72:75], v[20:23], v[56:59]
s_nop 0
v_mfma_f32_16x16x32_bf16 v[60:63], v[76:79], v[20:23], v[60:63]
v_perm_b32 v64, v102, v98, s64
v_perm_b32 v65, v110, v106, s64
v_perm_b32 v66, v118, v114, s64
v_perm_b32 v67, v126, v122, s64
v_perm_b32 v68, v102, v98, s65
v_perm_b32 v69, v110, v106, s65
v_perm_b32 v70, v118, v114, s65
v_perm_b32 v71, v126, v122, s65
v_mfma_f32_16x16x32_bf16 v[48:51], v[64:67], v[36:39], v[48:51]
s_nop 0
v_mfma_f32_16x16x32_bf16 v[52:55], v[68:71], v[36:39], v[52:55]
v_perm_b32 v72, v103, v99, s64
v_perm_b32 v73, v111, v107, s64
v_perm_b32 v74, v119, v115, s64
v_perm_b32 v75, v127, v123, s64
v_perm_b32 v76, v103, v99, s65
v_perm_b32 v77, v111, v107, s65
v_perm_b32 v78, v119, v115, s65
v_perm_b32 v79, v127, v123, s65
v_mfma_f32_16x16x32_bf16 v[56:59], v[72:75], v[36:39], v[56:59]
s_nop 0
v_mfma_f32_16x16x32_bf16 v[60:63], v[76:79], v[36:39], v[60:63]
s_waitcnt vmcnt(4)
s_add_u32 s63, s7, 163840
buffer_load_dwordx4 v[148:151], v0, s[12:15], s63 offen offset:1024 nt
s_waitcnt vmcnt(4)
s_add_u32 s63, s7, 163840
buffer_load_dwordx4 v[152:155], v0, s[12:15], s63 offen offset:2048 nt
s_waitcnt vmcnt(4)
s_add_u32 s63, s7, 163840
buffer_load_dwordx4 v[156:159], v0, s[12:15], s63 offen offset:3072 nt
s_waitcnt vmcnt(4)
s_add_u32 s63, s7, 196608
buffer_load_dwordx4 v[160:163], v0, s[12:15], s63 offen offset:0 nt
s_waitcnt vmcnt(4)
s_add_u32 s63, s7, 196608
buffer_load_dwordx4 v[164:167], v0, s[12:15], s63 offen offset:1024 nt
s_waitcnt vmcnt(4)
s_add_u32 s63, s7, 196608
buffer_load_dwordx4 v[168:171], v0, s[12:15], s63 offen offset:2048 nt
s_waitcnt vmcnt(4)
s_lshr_b32 s75, s5, 4
s_lshl_b32 s75, s75, 11
s_add_u32 s75, s75, 131072
v_lshrrev_b32 v2, 3, v1
v_lshlrev_b32 v2, 7, v2
v_and_b32 v3, 7, v1
v_lshl_add_u32 v2, v3, 3, v2
buffer_load_dwordx2 v[6:7], v2, s[16:19], s75 offen offset:0 sc1
buffer_load_dwordx2 v[8:9], v2, s[16:19], s75 offen offset:1024 sc1
s_waitcnt vmcnt(5)
v_perm_b32 v64, v132, v128, s64
v_perm_b32 v65, v140, v136, s64
v_perm_b32 v66, v148, v144, s64
v_perm_b32 v67, v156, v152, s64
v_perm_b32 v68, v132, v128, s65
v_perm_b32 v69, v140, v136, s65
v_perm_b32 v70, v148, v144, s65
v_perm_b32 v71, v156, v152, s65
v_mfma_f32_16x16x32_bf16 v[48:51], v[64:67], v[24:27], v[48:51]
s_nop 0
v_mfma_f32_16x16x32_bf16 v[52:55], v[68:71], v[24:27], v[52:55]
v_perm_b32 v72, v133, v129, s64
v_perm_b32 v73, v141, v137, s64
v_perm_b32 v74, v149, v145, s64
v_perm_b32 v75, v157, v153, s64
v_perm_b32 v76, v133, v129, s65
v_perm_b32 v77, v141, v137, s65
v_perm_b32 v78, v149, v145, s65
v_perm_b32 v79, v157, v153, s65
v_mfma_f32_16x16x32_bf16 v[56:59], v[72:75], v[24:27], v[56:59]
s_nop 0
v_mfma_f32_16x16x32_bf16 v[60:63], v[76:79], v[24:27], v[60:63]
v_perm_b32 v64, v134, v130, s64
v_perm_b32 v65, v142, v138, s64
v_perm_b32 v66, v150, v146, s64
v_perm_b32 v67, v158, v154, s64
v_perm_b32 v68, v134, v130, s65
v_perm_b32 v69, v142, v138, s65
v_perm_b32 v70, v150, v146, s65
v_perm_b32 v71, v158, v154, s65
v_mfma_f32_16x16x32_bf16 v[48:51], v[64:67], v[40:43], v[48:51]
s_nop 0
v_mfma_f32_16x16x32_bf16 v[52:55], v[68:71], v[40:43], v[52:55]
v_perm_b32 v72, v135, v131, s64
v_perm_b32 v73, v143, v139, s64
v_perm_b32 v74, v151, v147, s64
v_perm_b32 v75, v159, v155, s64
v_perm_b32 v76, v135, v131, s65
v_perm_b32 v77, v143, v139, s65
v_perm_b32 v78, v151, v147, s65
v_perm_b32 v79, v159, v155, s65
v_mfma_f32_16x16x32_bf16 v[56:59], v[72:75], v[40:43], v[56:59]
s_nop 0
v_mfma_f32_16x16x32_bf16 v[60:63], v[76:79], v[40:43], v[60:63]
s_waitcnt vmcnt(4)
s_add_u32 s63, s7, 196608
buffer_load_dwordx4 v[172:175], v0, s[12:15], s63 offen offset:3072 nt
s_waitcnt vmcnt(4)
s_add_u32 s63, s7, 229376
buffer_load_dwordx4 v[176:179], v0, s[12:15], s63 offen offset:0 nt
s_waitcnt vmcnt(4)
s_add_u32 s63, s7, 229376
buffer_load_dwordx4 v[180:183], v0, s[12:15], s63 offen offset:1024 nt
s_waitcnt vmcnt(4)
s_add_u32 s63, s7, 229376
buffer_load_dwordx4 v[184:187], v0, s[12:15], s63 offen offset:2048 nt
s_waitcnt vmcnt(4)
s_add_u32 s63, s7, 229376
buffer_load_dwordx4 v[188:191], v0, s[12:15], s63 offen offset:3072 nt
v_max_u32 v3, v6, v7
v_max3_u32 v3, v3, v8, v9
v_cmp_eq_u32 vcc, -1, v3
s_cbranch_vccz L_R_ok14
s_mov_b32 s70, 0
L_R_retry15:
buffer_load_dwordx2 v[6:7], v2, s[16:19], s75 offen offset:0 sc1
buffer_load_dwordx2 v[8:9], v2, s[16:19], s75 offen offset:1024 sc1
s_waitcnt vmcnt(0)
v_max_u32 v3, v6, v7
v_max3_u32 v3, v3, v8, v9
s_add_u32 s70, s70, 1
s_cmp_ge_u32 s70, 262144
s_cbranch_scc1 L_R_ok14
v_cmp_eq_u32 vcc, -1, v3
s_cbranch_vccnz L_R_retry15
L_R_ok14:
v_max_f32 v3, v6, v8
v_sub_f32 v6, v6, v3
v_sub_f32 v8, v8, v3
v_mul_f32 v6, 0x3fb8aa3b, v6
v_mul_f32 v8, 0x3fb8aa3b, v8
v_exp_f32 v6, v6
v_exp_f32 v8, v8
v_mul_f32 v7, v7, v6
v_fmac_f32 v7, v9, v8
v_max_f32_dpp v6, v3, v3 row_ror:8 row_mask:0xf bank_mask:0xf
v_mov_b32 v9, v6
s_nop 1
v_permlane16_swap_b32 v6, v9
v_max_f32 v6, v6, v9
v_mov_b32 v9, v6
s_nop 1
v_permlane32_swap_b32 v6, v9
v_max_f32 v6, v6, v9
v_sub_f32 v9, v3, v6
v_mul_f32 v9, 0x3fb8aa3b, v9
v_exp_f32 v9, v9
s_nop 0
v_mul_f32 v8, v7, v9
s_nop 1
v_add_f32_dpp v8, v8, v8 row_ror:8 row_mask:0xf bank_mask:0xf
v_mov_b32 v9, v8
s_nop 1
v_permlane16_swap_b32 v8, v9
v_add_f32 v8, v8, v9
v_mov_b32 v9, v8
s_nop 1
v_permlane32_swap_b32 v8, v9
v_add_f32 v8, v8, v9
v_sub_f32 v4, v4, v6
v_mul_f32 v4, 0x3fb8aa3b, v4
v_exp_f32 v4, v4
v_rcp_f32 v8, v8
s_nop 0
v_mul_f32 v5, v4, v8
s_mul_i32 s60, s3, 4864
s_add_u32 s60, s60, 0
v_and_b32 v6, 7, v1
v_mul_u32_u24 v6, 592, v6
v_lshrrev_b32 v3, 4, v1
v_mul_u32_u24 v3, 144, v3
v_add_u32 v6, v3, v6
v_bfe_u32 v3, v1, 3, 1
v_lshl_add_u32 v6, v3, 6, v6
v_add_u32 v6, s60, v6
s_mul_i32 s60, s3, 592
s_add_u32 s60, s60, 0
v_lshrrev_b32 v7, 4, v1
v_mul_u32_u24 v7, 144, v7
v_bfe_u32 v3, v1, 1, 1
v_lshl_add_u32 v7, v3, 6, v7
v_and_b32 v3, 1, v1
v_lshl_add_u32 v7, v3, 5, v7
v_bfe_u32 v3, v1, 2, 2
v_lshl_add_u32 v7, v3, 2, v7
v_add_u32 v7, s60, v7
v_add_u32 v8, 16, v7
v_lshlrev_b32 v9, 2, v1
s_lshl_b32 s75, s5, 11
s_lshl_b32 s61, s3, 8
s_add_u32 s75, s75, s61
s_add_u32 s75, s75, 262144
s_waitcnt vmcnt(0)
v_perm_b32 v64, v164, v160, s64
v_perm_b32 v65, v172, v168, s64
v_perm_b32 v66, v180, v176, s64
v_perm_b32 v67, v188, v184, s64
v_perm_b32 v68, v164, v160, s65
v_perm_b32 v69, v172, v168, s65
v_perm_b32 v70, v180, v176, s65
v_perm_b32 v71, v188, v184, s65
v_mfma_f32_16x16x32_bf16 v[48:51], v[64:67], v[28:31], v[48:51]
s_nop 0
v_mfma_f32_16x16x32_bf16 v[52:55], v[68:71], v[28:31], v[52:55]
v_perm_b32 v72, v165, v161, s64
v_perm_b32 v73, v173, v169, s64
v_perm_b32 v74, v181, v177, s64
v_perm_b32 v75, v189, v185, s64
v_perm_b32 v76, v165, v161, s65
v_perm_b32 v77, v173, v169, s65
v_perm_b32 v78, v181, v177, s65
v_perm_b32 v79, v189, v185, s65
v_mfma_f32_16x16x32_bf16 v[56:59], v[72:75], v[28:31], v[56:59]
s_nop 0
v_mfma_f32_16x16x32_bf16 v[60:63], v[76:79], v[28:31], v[60:63]
v_perm_b32 v64, v166, v162, s64
v_perm_b32 v65, v174, v170, s64
v_perm_b32 v66, v182, v178, s64
v_perm_b32 v67, v190, v186, s64
v_perm_b32 v68, v166, v162, s65
v_perm_b32 v69, v174, v170, s65
v_perm_b32 v70, v182, v178, s65
v_perm_b32 v71, v190, v186, s65
v_mfma_f32_16x16x32_bf16 v[48:51], v[64:67], v[44:47], v[48:51]
s_nop 0
v_mfma_f32_16x16x32_bf16 v[52:55], v[68:71], v[44:47], v[52:55]
v_perm_b32 v72, v167, v163, s64
v_perm_b32 v73, v175, v171, s64
v_perm_b32 v74, v183, v179, s64
v_perm_b32 v75, v191, v187, s64
v_perm_b32 v76, v167, v163, s65
v_perm_b32 v77, v175, v171, s65
v_perm_b32 v78, v183, v179, s65
v_perm_b32 v79, v191, v187, s65
v_mfma_f32_16x16x32_bf16 v[56:59], v[72:75], v[44:47], v[56:59]
s_nop 0
v_mfma_f32_16x16x32_bf16 v[60:63], v[76:79], v[44:47], v[60:63]
v_pk_mul_f32 v[48:49], v[48:49], v[4:5] op_sel:[0,1] op_sel_hi:[1,1]
v_pk_mul_f32 v[50:51], v[50:51], v[4:5] op_sel:[0,1] op_sel_hi:[1,1]
ds_write_b128 v6, v[48:51] offset:0
v_pk_mul_f32 v[52:53], v[52:53], v[4:5] op_sel:[0,1] op_sel_hi:[1,1]
v_pk_mul_f32 v[54:55], v[54:55], v[4:5] op_sel:[0,1] op_sel_hi:[1,1]
ds_write_b128 v6, v[52:55] offset:16
v_pk_mul_f32 v[56:57], v[56:57], v[4:5] op_sel:[0,1] op_sel_hi:[1,1]
v_pk_mul_f32 v[58:59], v[58:59], v[4:5] op_sel:[0,1] op_sel_hi:[1,1]
ds_write_b128 v6, v[56:59] offset:32
v_pk_mul_f32 v[60:61], v[60:61], v[4:5] op_sel:[0,1] op_sel_hi:[1,1]
v_pk_mul_f32 v[62:63], v[62:63], v[4:5] op_sel:[0,1] op_sel_hi:[1,1]
ds_write_b128 v6, v[60:63] offset:48
s_waitcnt lgkmcnt(0)
s_barrier
ds_read2st64_b32 v[16:17], v7 offset0:0 offset1:19
ds_read2st64_b32 v[24:25], v8 offset0:0 offset1:19
ds_read2st64_b32 v[18:19], v7 offset0:38 offset1:57
ds_read2st64_b32 v[26:27], v8 offset0:38 offset1:57
ds_read2st64_b32 v[20:21], v7 offset0:76 offset1:95
ds_read2st64_b32 v[28:29], v8 offset0:76 offset1:95
ds_read2st64_b32 v[22:23], v7 offset0:114 offset1:133
ds_read2st64_b32 v[30:31], v8 offset0:114 offset1:133
s_waitcnt lgkmcnt(0)
v_pk_add_f32 v[16:17], v[16:17], v[20:21]
v_pk_add_f32 v[18:19], v[18:19], v[22:23]
v_pk_add_f32 v[24:25], v[24:25], v[28:29]
v_pk_add_f32 v[26:27], v[26:27], v[30:31]
v_pk_add_f32 v[16:17], v[16:17], v[18:19]
v_pk_add_f32 v[24:25], v[24:25], v[26:27]
v_add_f32 v16, v16, v17
v_add_f32 v24, v24, v25
v_cvt_pk_bf16_f32 v20, v16, v24
s_nop 1
v_mov_b32_dpp v21, v20 quad_perm:[1,1,1,1] row_mask:0xf bank_mask:0xf
v_mov_b32_dpp v22, v20 quad_perm:[2,2,2,2] row_mask:0xf bank_mask:0xf
v_mov_b32_dpp v23, v20 quad_perm:[3,3,3,3] row_mask:0xf bank_mask:0xf
s_mov_b32 exec_lo, 0x11111111
s_mov_b32 exec_hi, 0x11111111
buffer_store_dwordx4 v[20:23], v9, s[16:19], s75 offen sc1
s_mov_b64 exec, -1
s_mov_b32 s24, s44
s_mov_b32 s25, s45
s_mov_b32 s26, 0x700000
s_mov_b32 s27, 0x20000
s_mov_b32 s20, s46
s_mov_b32 s21, s47
s_mov_b32 s22, 0x700000
s_mov_b32 s23, 0x20000
s_sub_u32 s60, s4, 17
s_cmp_ge_u32 s60, 14
s_cbranch_scc1 L_R_h616
s_lshl_b32 s60, s60, 3
s_add_u32 s60, s60, s3
s_add_u32 s61, s2, 1
s_and_b32 s61, s61, 7
s_lshl_b32 s61, s61, 7
v_lshrrev_b32 v15, 3, v1
v_lshlrev_b32 v15, 10, v15
v_and_b32 v14, 7, v1
v_lshl_add_u32 v15, v14, 4, v15
v_add_u32 v15, s61, v15
s_add_u32 s61, s60, 0
s_mul_i32 s62, s61, 2341
s_lshr_b32 s62, s62, 16
s_mul_i32 s62, s62, 672
s_lshl_b32 s61, s61, 3
s_add_u32 s62, s62, s61
s_add_u32 s62, s62, 672
s_lshl_b32 s62, s62, 10
s_waitcnt vmcnt(4)
buffer_load_dwordx4 v[252:255], v15, s[24:27], s62 offen
buffer_load_dwordx4 v[252:255], v15, s[20:23], s62 offen
s_add_u32 s61, s60, 112
s_mul_i32 s62, s61, 2341
s_lshr_b32 s62, s62, 16
s_mul_i32 s62, s62, 672
s_lshl_b32 s61, s61, 3
s_add_u32 s62, s62, s61
s_add_u32 s62, s62, 672
s_lshl_b32 s62, s62, 10
s_waitcnt vmcnt(4)
buffer_load_dwordx4 v[252:255], v15, s[24:27], s62 offen
buffer_load_dwordx4 v[252:255], v15, s[20:23], s62 offen
L_R_h616:
s_mov_b32 s24, s48
s_mov_b32 s25, s49
s_mov_b32 s26, 0x700000
s_mov_b32 s27, 0x20000
s_sub_u32 s60, s4, 17
s_lshr_b32 s62, s60, 1
s_lshl_b32 s62, s62, 3
s_add_u32 s61, s2, 1
s_and_b32 s61, s61, 7
s_add_u32 s62, s62, s61
s_lshl_b32 s62, s62, 17
s_and_b32 s60, s60, 1
s_lshl_b32 s60, s60, 15
s_add_u32 s62, s62, s60
s_add_u32 s62, s62, s6
s_cmp_ge_u32 s62, 7340032
s_cbranch_scc1 L_R_h517
s_add_u32 s63, s62, 0
buffer_load_dwordx4 v[252:255], v0, s[24:27], s63 offen offset:0
s_waitcnt vmcnt(1)
buffer_load_dwordx4 v[252:255], v0, s[24:27], s63 offen offset:1024
s_waitcnt vmcnt(1)
buffer_load_dwordx4 v[252:255], v0, s[24:27], s63 offen offset:2048
s_waitcnt vmcnt(1)
buffer_load_dwordx4 v[252:255], v0, s[24:27], s63 offen offset:3072
s_add_u32 s63, s62, 65536
s_waitcnt vmcnt(1)
buffer_load_dwordx4 v[252:255], v0, s[24:27], s63 offen offset:0
s_waitcnt vmcnt(1)
buffer_load_dwordx4 v[252:255], v0, s[24:27], s63 offen offset:1024
s_waitcnt vmcnt(1)
buffer_load_dwordx4 v[252:255], v0, s[24:27], s63 offen offset:2048
s_waitcnt vmcnt(1)
buffer_load_dwordx4 v[252:255], v0, s[24:27], s63 offen offset:3072
L_R_h517:
s_endpgm
L_end:
s_endpgm
.fill 64, 4, 0xbf800000
.p2align 8
L_code_end:
.section .rodata,"a"
.p2align 6
.amdhsa_kernel adaLN_cond__gqa_block_cached__glu_gated_swiglu__decode_kernel
  .amdhsa_next_free_vgpr 256
  .amdhsa_next_free_sgpr 102
  .amdhsa_accum_offset 256
  .amdhsa_group_segment_fixed_size 0
  .amdhsa_kernarg_size 112
  .amdhsa_user_sgpr_count 2
  .amdhsa_user_sgpr_kernarg_segment_ptr 1
  .amdhsa_system_sgpr_workgroup_id_x 1
  .amdhsa_float_denorm_mode_32 3
.end_amdhsa_kernel
```
